```python
import torch

def _softmax(x, axis=-1):
    return torch.softmax(x, dim=axis)
def _gelu(x):
    return torch.nn.functional.gelu(x, approximate="tanh")
def _silu(x):
    return torch.nn.functional.silu(x)
def _sigmoid(x):
    return torch.sigmoid(x)
def _layernorm(x, axis=-1, eps=1e-5):
    m = x.mean(dim=axis, keepdim=True)
    v = x.var(dim=axis, keepdim=True, unbiased=False)
    return (x - m) / torch.sqrt(v + eps)
def _scatter_add(tgt, idx, src, axis=0):
    return tgt.clone().index_add_(axis, idx, src)
def _segment_sum(src, seg, n):
    out = torch.zeros((n,) + src.shape[1:], dtype=src.dtype)
    return out.index_add_(0, seg, src)
def _pad(x, pw):
    flat = tuple(v for pair in reversed(pw) for v in pair)
    return torch.nn.functional.pad(x, flat)

kernel_name = 'concat_heads__sliding_local_dilated__linear_kernel_hedgehog__prompt'

def setup_inputs():

    _w = (lambda a: (lambda t: t.to(torch.bfloat16) if t.is_floating_point() else t)(torch.as_tensor(a)))
    def _A_setup():
        B, S, D = 1, 2048, 640
        return {
            "x": _w((lambda *s: torch.randn(*s, dtype=torch.bfloat16) * 0.2)(B, S, D)),
            "wqkv": _w((lambda *s: torch.randn(*s, dtype=torch.bfloat16) * 0.2)(D, 3 * D)),
            "wo": _w((lambda *s: torch.randn(*s, dtype=torch.bfloat16) * 0.05)(D, D)),
        }
    _A_in = _A_setup()

    def _B_setup():
        B, S, D, H = 1, 2048, 640, 32
        Dh = D // H
        return {
            "x": _w((lambda *s: torch.randn(*s, dtype=torch.bfloat16) * 0.2)(B, S, D)),
            "wqkv": _w((lambda *s: torch.randn(*s, dtype=torch.bfloat16) * 0.8)(D, 3 * D)),
            "w_phi": _w((lambda *s: torch.randn(*s, dtype=torch.bfloat16) * 0.8)(H, Dh, Dh) * (Dh ** -0.5)),
            "wo": _w((lambda *s: torch.randn(*s, dtype=torch.bfloat16) * 0.2)(D, D)),
        }
    _B_in = _B_setup()

    return {
        "A_x": _A_in["x"],
        "A_wqkv": _A_in["wqkv"],
        "A_wo": _A_in["wo"],
        "B_x": _B_in["x"],
        "B_wqkv": _B_in["wqkv"],
        "B_w_phi": _B_in["w_phi"],
        "B_wo": _B_in["wo"],
    }

def reference(A_x, A_wqkv, A_wo, B_x, B_wqkv, B_w_phi, B_wo):
    def _A_ref(x, wqkv, wo):
        B, S, D = x.shape
        H = 32; Dh = D // H
        W, dil = 8, 2
        qkv = (lambda x, *d: x.permute(*d))((x @ wqkv).reshape(B, S, 3, H, Dh), 2, 0, 3, 1, 4)
        q, k, v = qkv[0], qkv[1], qkv[2]
        scale = Dh ** -0.5
        pos = torch.arange(S)
        off = torch.arange(W) * dil
        idx = pos[:, None] - off[None, :]
        mask = idx >= 0
        idx_c = torch.where(mask, idx, 0).reshape(-1)
        kg = k[:, :, idx_c, :].reshape(B, H, S, W, Dh)
        vg = v[:, :, idx_c, :].reshape(B, H, S, W, Dh)
        logits = torch.einsum("bhsd,bhswd->bhsw", q, kg) * scale
        logits = torch.where(mask[None, None, :, :], logits, -1e9)
        attn = _softmax(logits, axis=-1)
        o = torch.einsum("bhsw,bhswd->bhsd", attn, vg)
        return (lambda x, *d: x.permute(*d))(o, 0, 2, 1, 3).reshape(B, S, D) @ wo

    def _B_ref(x, wqkv, w_phi, wo):
        B, S, D = x.shape
        H = 32; Dh = D // H
        qkv = (lambda x, *d: x.permute(*d))((x @ wqkv).reshape(B, S, 3, H, Dh), 2, 0, 3, 1, 4)
        q, k, v = qkv[0], qkv[1], qkv[2]
        pq = torch.einsum("bhsd,hdf->bhsf", q, w_phi)
        pk = torch.einsum("bhsd,hdf->bhsf", k, w_phi)
        phi_q = torch.concatenate([_softmax(pq, axis=-1), _softmax(-pq, axis=-1)], axis=-1)
        phi_k = torch.concatenate([_softmax(pk, axis=-1), _softmax(-pk, axis=-1)], axis=-1)
        kv = torch.einsum("bhsf,bhsd->bhfd", phi_k, v)
        z  = torch.einsum("bhsf->bhf", phi_k)
        num = torch.einsum("bhqf,bhfd->bhqd", phi_q, kv)
        den = torch.einsum("bhqf,bhf->bhq", phi_q, z)[..., None] + 1e-6
        o = num / den
        return (lambda x, *d: x.permute(*d))(o, 0, 2, 1, 3).reshape(B, S, D) @ wo

    a = _A_ref(A_x, A_wqkv, A_wo)
    b = _B_ref(B_x, B_wqkv, B_w_phi, B_wo)
    return torch.concatenate([a, b], axis=-1)
```

```asm
; @launch grid=(256,1,1) block=(256,1,1) lds=163840
.amdgcn_target "amdgcn-amd-amdhsa--gfx950"
.text
.globl concat_heads__sliding_local_dilated__linear_kernel_hedgehog__prompt_kernel
.p2align 8
.type concat_heads__sliding_local_dilated__linear_kernel_hedgehog__prompt_kernel,@function
concat_heads__sliding_local_dilated__linear_kernel_hedgehog__prompt_kernel:
    s_cmp_ge_u32 s2, 256
    s_cbranch_scc1 L_END
    s_load_dwordx16 s[44:59], s[0:1], 0
    s_load_dwordx4 s[60:63], s[0:1], 64
    s_memrealtime s[94:95]
L_PC:
    s_getpc_b64 s[64:65]
    s_lshr_b32 s3, s2, 3
    v_lshl_add_u32 v1, s3, 4, v0
    v_cmp_gt_u32 vcc, (L_CODE_END-L_PC)/128, v1
    v_cmp_gt_u32_e64 s[66:67], 16, v0
    s_and_b64 vcc, vcc, s[66:67]
    v_lshlrev_b32 v1, 7, v1
    v_mov_b32 v3, s65
    v_add_co_u32 v2, s[66:67], s64, v1
    s_nop 1
    v_addc_co_u32 v3, s[66:67], 0, v3, s[66:67]
    s_and_saveexec_b64 s[66:67], vcc
    s_cbranch_execz L_CPF
    global_load_dword v255, v[2:3], off
L_CPF:
    s_mov_b64 exec, -1
    s_bitcmp0_b32 s2, 3
    s_cbranch_scc1 L_A
    s_mov_b32 s31, 1
    s_and_b32 s29, s2, 3
    s_lshl_b32 s29, s29, 2
    s_bfe_u32 s5, s2, 0x20004
    s_add_u32 s29, s29, s5
    s_and_b32 s30, s2, 4
    s_bfe_u32 s6, s2, 0x20006
    s_add_u32 s30, s30, s6
    v_lshrrev_b32 v13, 6, v0
    s_nop 0
    v_readfirstlane_b32 s28, v13
    v_and_b32 v0, 63, v0
    s_add_u32 s5, s5, s6
    s_and_b32 s6, s2, 3
    s_add_u32 s5, s5, s6
    s_bfe_u32 s6, s2, 0x10002
    s_mul_i32 s6, s6, 2
    s_add_u32 s5, s5, s6
    s_cmp_ge_u32 s5, 10
    s_cselect_b32 s6, 10, 0
    s_sub_u32 s5, s5, s6
    s_cmp_ge_u32 s5, 5
    s_cselect_b32 s6, 5, 0
    s_sub_u32 s5, s5, s6
    s_lshl_b32 s3, s29, 2
    s_add_u32 s3, s3, s28
    s_mul_i32 s3, s3, 40960
    s_mul_i32 s4, s30, 160
    s_lshl_b32 s32, s5, 8
    s_add_u32 s32, s32, s3
    s_mul_i32 s37, s5, 491520
    s_add_u32 s37, s37, s4
    s_add_u32 s5, s5, 1
    s_cmp_ge_u32 s5, 5
    s_cselect_b32 s5, 0, s5
    s_lshl_b32 s33, s5, 8
    s_add_u32 s33, s33, s3
    s_mul_i32 s38, s5, 491520
    s_add_u32 s38, s38, s4
    s_add_u32 s5, s5, 1
    s_cmp_ge_u32 s5, 5
    s_cselect_b32 s5, 0, s5
    s_lshl_b32 s34, s5, 8
    s_add_u32 s34, s34, s3
    s_mul_i32 s39, s5, 491520
    s_add_u32 s39, s39, s4
    s_add_u32 s5, s5, 1
    s_cmp_ge_u32 s5, 5
    s_cselect_b32 s5, 0, s5
    s_lshl_b32 s35, s5, 8
    s_add_u32 s35, s35, s3
    s_mul_i32 s40, s5, 491520
    s_add_u32 s40, s40, s4
    s_add_u32 s5, s5, 1
    s_cmp_ge_u32 s5, 5
    s_cselect_b32 s5, 0, s5
    s_lshl_b32 s36, s5, 8
    s_add_u32 s36, s36, s3
    s_mul_i32 s41, s5, 491520
    s_add_u32 s41, s41, s4
    s_mul_i32 s42, s28, 5120
    s_lshl_b32 s92, s28, 13
    v_lshrrev_b32 v16, 3, v0
    v_lshrrev_b32 v17, 4, v0
    v_and_b32 v18, 7, v0
    v_xor_b32 v17, v17, v18
    v_mul_u32_u24 v16, 1280, v16
    v_lshl_add_u32 v9, v17, 4, v16
    v_xor_b32 v10, 64, v9
    v_add_u32 v10, 10240, v10
    s_mul_i32 s3, s28, 122880
    v_add_u32 v16, 0, v0
    v_mul_u32_u24 v17, 6554, v16
    v_lshrrev_b32 v17, 16, v17
    v_mul_u32_u24 v18, 10, v17
    v_sub_u32 v18, v16, v18
    v_and_b32 v19, 12, v17
    v_lshrrev_b32 v20, 2, v17
    v_and_b32 v20, 4, v20
    v_and_b32 v17, 3, v17
    v_lshl_add_u32 v17, v19, 1, v17
    v_add_u32 v17, v17, v20
    v_mul_u32_u24 v17, 3840, v17
    v_lshlrev_b32 v18, 4, v18
    v_add3_u32 v4, v17, v18, s3
    v_add_u32 v16, 64, v0
    v_mul_u32_u24 v17, 6554, v16
    v_lshrrev_b32 v17, 16, v17
    v_mul_u32_u24 v18, 10, v17
    v_sub_u32 v18, v16, v18
    v_and_b32 v19, 12, v17
    v_lshrrev_b32 v20, 2, v17
    v_and_b32 v20, 4, v20
    v_and_b32 v17, 3, v17
    v_lshl_add_u32 v17, v19, 1, v17
    v_add_u32 v17, v17, v20
    v_mul_u32_u24 v17, 3840, v17
    v_lshlrev_b32 v18, 4, v18
    v_add3_u32 v5, v17, v18, s3
    v_add_u32 v16, 128, v0
    v_mul_u32_u24 v17, 6554, v16
    v_lshrrev_b32 v17, 16, v17
    v_mul_u32_u24 v18, 10, v17
    v_sub_u32 v18, v16, v18
    v_and_b32 v19, 12, v17
    v_lshrrev_b32 v20, 2, v17
    v_and_b32 v20, 4, v20
    v_and_b32 v17, 3, v17
    v_lshl_add_u32 v17, v19, 1, v17
    v_add_u32 v17, v17, v20
    v_mul_u32_u24 v17, 3840, v17
    v_lshlrev_b32 v18, 4, v18
    v_add3_u32 v6, v17, v18, s3
    v_add_u32 v16, 192, v0
    v_mul_u32_u24 v17, 6554, v16
    v_lshrrev_b32 v17, 16, v17
    v_mul_u32_u24 v18, 10, v17
    v_sub_u32 v18, v16, v18
    v_and_b32 v19, 12, v17
    v_lshrrev_b32 v20, 2, v17
    v_and_b32 v20, 4, v20
    v_and_b32 v17, 3, v17
    v_lshl_add_u32 v17, v19, 1, v17
    v_add_u32 v17, v17, v20
    v_mul_u32_u24 v17, 3840, v17
    v_lshlrev_b32 v18, 4, v18
    v_add3_u32 v7, v17, v18, s3
    v_add_u32 v16, 256, v0
    v_mul_u32_u24 v17, 6554, v16
    v_lshrrev_b32 v17, 16, v17
    v_mul_u32_u24 v18, 10, v17
    v_sub_u32 v18, v16, v18
    v_and_b32 v19, 12, v17
    v_lshrrev_b32 v20, 2, v17
    v_and_b32 v20, 4, v20
    v_and_b32 v17, 3, v17
    v_lshl_add_u32 v17, v19, 1, v17
    v_add_u32 v17, v17, v20
    v_mul_u32_u24 v17, 3840, v17
    v_lshlrev_b32 v18, 4, v18
    v_add3_u32 v8, v17, v18, s3
    s_waitcnt lgkmcnt(0)
    s_mov_b32 s8, s50
    s_mov_b32 s9, s51
    s_mov_b32 s10, 2621440
    s_mov_b32 s11, 0x20000
    s_mov_b32 s12, s52
    s_mov_b32 s13, s53
    s_mov_b32 s14, 2457600
    s_mov_b32 s15, 0x20000
    s_add_u32 m0, s42, 0
    s_add_u32 s7, s37, 1280
    buffer_load_dwordx4 v4, s[12:15], s7 offen lds
    s_add_u32 m0, s42, 1024
    s_add_u32 s7, s37, 1280
    buffer_load_dwordx4 v5, s[12:15], s7 offen lds
    s_add_u32 m0, s42, 2048
    s_add_u32 s7, s37, 1280
    buffer_load_dwordx4 v6, s[12:15], s7 offen lds
    s_add_u32 m0, s42, 3072
    s_add_u32 s7, s37, 1280
    buffer_load_dwordx4 v7, s[12:15], s7 offen lds
    s_add_u32 m0, s42, 4096
    s_add_u32 s7, s37, 1280
    buffer_load_dwordx4 v8, s[12:15], s7 offen lds
    s_add_u32 m0, s92, 81920
    s_nop 0
    buffer_load_dwordx4 v9, s[8:11], s32 offen lds
    s_add_u32 m0, s92, 82944
    s_nop 0
    buffer_load_dwordx4 v10, s[8:11], s32 offen lds
    s_add_u32 m0, s92, 83968
    s_add_u32 s7, s32, 20480
    buffer_load_dwordx4 v9, s[8:11], s7 offen lds
    s_add_u32 m0, s92, 84992
    s_add_u32 s7, s32, 20480
    buffer_load_dwordx4 v10, s[8:11], s7 offen lds
    s_add_u32 m0, s92, 86016
    s_add_u32 s7, s32, 128
    buffer_load_dwordx4 v9, s[8:11], s7 offen lds
    s_add_u32 m0, s92, 87040
    s_add_u32 s7, s32, 128
    buffer_load_dwordx4 v10, s[8:11], s7 offen lds
    s_add_u32 m0, s92, 88064
    s_add_u32 s7, s32, 20608
    buffer_load_dwordx4 v9, s[8:11], s7 offen lds
    s_add_u32 m0, s92, 89088
    s_add_u32 s7, s32, 20608
    buffer_load_dwordx4 v10, s[8:11], s7 offen lds
    s_mov_b32 s20, s60
    s_mov_b32 s21, s61
    s_mov_b32 s22, 256
    s_mov_b32 s23, 0x20000
    s_mov_b32 s16, s62
    s_mov_b32 s17, s63
    s_mov_b32 s18, 33554432
    s_mov_b32 s19, 0x20000
    s_mov_b32 s24, s54
    s_mov_b32 s25, s55
    s_mov_b32 s26, 25600
    s_mov_b32 s27, 0x20000
    s_mov_b32 s44, s56
    s_mov_b32 s45, s57
    s_mov_b32 s46, 819200
    s_mov_b32 s47, 0x20000
    s_mov_b32 s96, s58
    s_mov_b32 s97, s59
    s_mov_b32 s98, 5242880
    s_mov_b32 s99, 0x20000
    v_and_b32 v16, 15, v0
    v_lshrrev_b32 v17, 1, v16
    v_lshrrev_b32 v18, 4, v0
    v_xor_b32 v17, v17, v18
    v_lshlrev_b32 v16, 7, v16
    v_lshl_add_u32 v16, v17, 4, v16
    s_add_u32 s3, s92, 81920
    v_add_u32 v11, s3, v16
    v_xor_b32 v12, 64, v11
    v_lshrrev_b32 v16, 2, v0
    v_mul_u32_u24 v16, 160, v16
    v_and_b32 v17, 3, v0
    v_lshl_add_u32 v1, v17, 3, v16
    v_add_u32 v2, 61440, v1
    v_add_u32 v3, 122880, v1
    s_mov_b32 s54, 0xffff0000
    s_mov_b32 s55, 0xffffffff
    s_mov_b32 s56, 0x0
    s_mov_b32 s57, 0xffffffff
    s_mov_b32 s58, 0x0
    s_mov_b32 s59, 0xffff0000
    s_mov_b32 s60, 0xffff
    s_mov_b32 s61, 0x0
    s_mov_b32 s62, 0xffffffff
    s_mov_b32 s63, 0x0
    s_mov_b32 s64, 0xffffffff
    s_mov_b32 s65, 0xffff
    s_mov_b32 s48, 0x3fb8aa3b
    s_mov_b32 s49, 0x3fb8aa3b
    v_and_b32 v252, 15, v0
    v_lshrrev_b32 v253, 4, v0
    v_mul_u32_u24 v220, 160, v252
    v_lshrrev_b32 v16, 2, v252
    v_xor_b32 v16, v16, v253
    v_lshl_add_u32 v220, v16, 3, v220
    v_lshlrev_b32 v16, 3, v253
    v_xor_b32 v32, v16, v1
    v_add_u32 v220, s42, v220
    v_mul_u32_u24 v221, 160, v252
    v_and_b32 v16, 1, v253
    v_mul_u32_u24 v16, 80, v16
    v_add3_u32 v221, v221, v16, s42
    v_mov_b32 v16, 143424
    v_mov_b32 v17, 61504
    v_cndmask_b32_e64 v18, v16, v17, s[56:57]
    v_add_u32 v221, v221, v18
    s_mov_b32 s3, 143360
    s_cmp_ge_u32 s28, 2
    s_cselect_b32 s3, 61440, s3
    s_and_b32 s4, s28, 1
    s_mul_i32 s4, s4, 80
    s_add_u32 s3, s3, s4
    v_add_u32 v222, s3, v32
    v_lshrrev_b32 v223, 2, v0
    v_mul_u32_u24 v223, 160, v223
    v_and_b32 v18, 1, v0
    v_mul_u32_u24 v18, 80, v18
    v_add_u32 v223, v223, v18
    v_and_b32 v18, 2, v0
    v_cmp_eq_u32 vcc, 0, v18
    s_nop 1
    v_cndmask_b32 v18, v17, v16, vcc
    v_add_u32 v223, v223, v18
    s_lshl_b32 s4, s28, 5
    s_add_u32 s4, s4, 102400
    v_add_u32 v224, s4, v32
    v_mov_b32 v20, 0x7ffffff0
    v_lshlrev_b32 v21, 2, v253
    v_lshl_add_u32 v21, v252, 4, v21
    s_lshl_b32 s3, s28, 2
    s_lshl_b32 s4, s28, 10
    v_add_u32 v16, s4, v21
    v_cmp_le_u32 s[50:51], s3, v252
    s_nop 1
    v_cndmask_b32_e64 v225, v20, v16, s[50:51]
    v_add_u32 v16, 1024, v16
    s_add_u32 s3, s3, 4
    v_cmp_gt_u32 vcc, s3, v252
    s_nop 1
    v_cndmask_b32 v226, v20, v16, vcc
    v_lshlrev_b32 v22, 2, v252
    v_lshl_add_u32 v22, v253, 4, v22
    s_lshl_b32 s4, s28, 6
    s_add_u32 s4, s4, 12800
    v_add_u32 v16, s4, v22
    v_cmp_gt_u32 s[52:53], 4, v252
    s_nop 1
    v_cndmask_b32_e64 v227, v20, v16, s[52:53]
    v_mov_b32 v17, s28
    v_subrev_u32 v18, 1, v17
    v_cndmask_b32_e64 v17, v18, v17, s[50:51]
    v_cmp_eq_u32 vcc, v17, v253
    s_nop 1
    v_cndmask_b32_e64 v230, 0, -1, vcc
    s_lshl_b32 s3, s28, 8
    s_add_u32 s3, s3, 10240
    v_add_u32 v228, s3, v21
    s_cmp_eq_u32 s28, 3
    s_cselect_b64 s[100:101], -1, 0
    v_add_u32 v16, 11264, v21
    v_add_u32 v17, 13312, v21
    v_cndmask_b32_e64 v17, v20, v17, s[52:53]
    s_cmp_eq_u32 s28, 0
    s_cselect_b64 s[50:51], -1, 0
    v_cndmask_b32_e64 v17, v20, v17, s[50:51]
    v_cndmask_b32_e64 v229, v17, v16, s[100:101]
    v_mov_b32 v16, 3
    v_cndmask_b32_e64 v16, v252, v16, s[100:101]
    v_cmp_eq_u32 vcc, v16, v253
    s_nop 1
    v_cndmask_b32_e64 v231, 0, -1, vcc
    s_lshl_b32 s3, s28, 6
    s_add_u32 s3, s3, 0
    v_add_u32 v16, s3, v0
    v_lshlrev_b32 v232, 4, v16
    v_mov_b32 v18, 0
    v_mov_b32 v19, 320
    v_mov_b32 v21, 102400
    v_sub_u32 v18, v16, v18
    v_cmp_ge_u32 vcc, v18, v19
    v_sub_u32 v22, v18, v19
    s_nop 0
    v_cndmask_b32 v18, v18, v22, vcc
    v_lshl_add_u32 v21, v18, 4, v21
    v_add_u32 v22, 8, v21
    v_cndmask_b32 v236, v21, v22, vcc
    s_lshl_b32 s3, s28, 6
    s_add_u32 s3, s3, 256
    v_add_u32 v16, s3, v0
    v_lshlrev_b32 v233, 4, v16
    v_mov_b32 v18, 0
    v_mov_b32 v19, 320
    v_mov_b32 v21, 102400
    v_sub_u32 v18, v16, v18
    v_cmp_ge_u32 vcc, v18, v19
    v_sub_u32 v22, v18, v19
    s_nop 0
    v_cndmask_b32 v18, v18, v22, vcc
    v_lshl_add_u32 v21, v18, 4, v21
    v_add_u32 v22, 8, v21
    v_cndmask_b32 v237, v21, v22, vcc
    s_lshl_b32 s3, s28, 6
    s_add_u32 s3, s3, 512
    v_add_u32 v16, s3, v0
    v_lshlrev_b32 v234, 4, v16
    v_mov_b32 v18, 0
    v_mov_b32 v19, 320
    v_mov_b32 v21, 102400
    v_cmp_le_u32 vcc, 640, v16
    v_mov_b32 v22, 640
    s_nop 0
    v_cndmask_b32 v18, v18, v22, vcc
    v_mov_b32 v22, 80
    v_cndmask_b32 v19, v19, v22, vcc
    v_mov_b32 v22, 107520
    v_cndmask_b32 v21, v21, v22, vcc
    v_sub_u32 v18, v16, v18
    v_cmp_ge_u32 vcc, v18, v19
    v_sub_u32 v22, v18, v19
    s_nop 0
    v_cndmask_b32 v18, v18, v22, vcc
    v_lshl_add_u32 v21, v18, 4, v21
    v_add_u32 v22, 8, v21
    v_cndmask_b32 v238, v21, v22, vcc
    s_lshl_b32 s3, s28, 6
    s_add_u32 s3, s3, 768
    v_add_u32 v16, s3, v0
    v_lshlrev_b32 v235, 4, v16
    v_mov_b32 v18, 0
    v_mov_b32 v19, 320
    v_mov_b32 v21, 102400
    v_cmp_le_u32 vcc, 640, v16
    v_mov_b32 v22, 640
    s_nop 0
    v_cndmask_b32 v18, v18, v22, vcc
    v_mov_b32 v22, 80
    v_cndmask_b32 v19, v19, v22, vcc
    v_mov_b32 v22, 107520
    v_cndmask_b32 v21, v21, v22, vcc
    v_cmp_le_u32 vcc, 800, v16
    v_mov_b32 v22, 800
    s_nop 0
    v_cndmask_b32 v18, v18, v22, vcc
    v_mov_b32 v22, 16
    v_cndmask_b32 v19, v19, v22, vcc
    v_mov_b32 v22, 108800
    v_cndmask_b32 v21, v21, v22, vcc
    v_cmp_le_u32 vcc, 832, v16
    v_mov_b32 v22, 832
    s_nop 0
    v_cndmask_b32 v18, v18, v22, vcc
    v_mov_b32 v22, 4
    v_cndmask_b32 v19, v19, v22, vcc
    v_mov_b32 v22, 109056
    v_cndmask_b32 v21, v21, v22, vcc
    v_sub_u32 v18, v16, v18
    v_cmp_ge_u32 vcc, v18, v19
    v_sub_u32 v22, v18, v19
    s_nop 0
    v_cndmask_b32 v18, v18, v22, vcc
    v_lshl_add_u32 v21, v18, 4, v21
    v_add_u32 v22, 8, v21
    v_cndmask_b32 v239, v21, v22, vcc
    v_subrev_u32 v21, 800, v16
    v_subrev_u32 v22, 832, v16
    v_cmp_gt_u32 vcc, 16, v21
    v_cmp_gt_u32_e64 s[50:51], 4, v22
    s_or_b64 vcc, vcc, s[50:51]
    v_mov_b32 v21, 0x358637bd
    v_cndmask_b32_e64 v251, 0, v21, vcc
    v_cmp_gt_u32 vcc, 840, v16
    s_nop 1
    v_cndmask_b32 v235, v20, v235, vcc
    v_and_b32 v21, 1, v16
    v_lshlrev_b32 v21, 3, v21
    v_add_u32 v21, 109120, v21
    v_cndmask_b32 v239, v21, v239, vcc
    v_lshlrev_b32 v240, 4, v0
    v_add_u32 v240, 102400, v240
    v_lshlrev_b32 v241, 4, v253
    v_add_u32 v241, 102400, v241
    v_lshlrev_b32 v18, 4, v252
    v_mov_b32 v20, 109120
    s_mov_b32 s50, 0xffff
    s_mov_b32 s51, 0x0
    v_add_u32 v19, 107520, v18
    v_cndmask_b32_e64 v242, v20, v19, s[50:51]
    s_mov_b32 s50, 0xfff0000f
    s_mov_b32 s51, 0x0
    v_add_u32 v19, 107776, v18
    v_cndmask_b32_e64 v243, v20, v19, s[50:51]
    s_mov_b32 s50, 0xff0000
    s_mov_b32 s51, 0xff00
    v_add_u32 v19, 108032, v18
    v_cndmask_b32_e64 v244, v20, v19, s[50:51]
    s_mov_b32 s50, 0x0
    s_mov_b32 s51, 0xf0000fff
    v_add_u32 v19, 108288, v18
    v_cndmask_b32_e64 v245, v20, v19, s[50:51]
    s_mov_b32 s50, 0x0
    s_mov_b32 s51, 0xffff0000
    v_add_u32 v19, 108544, v18
    v_cndmask_b32_e64 v246, v20, v19, s[50:51]
    s_mov_b32 s50, 0xffff
    s_mov_b32 s51, 0x0
    v_mov_b32 v19, 109056
    v_cndmask_b32_e64 v247, v20, v19, s[50:51]
    s_mov_b32 s50, 0xffff0000
    s_mov_b32 s51, 0x0
    v_mov_b32 v19, 109072
    v_cndmask_b32_e64 v248, v20, v19, s[50:51]
    s_mov_b32 s50, 0x0
    s_mov_b32 s51, 0xffff
    v_mov_b32 v19, 109088
    v_cndmask_b32_e64 v249, v20, v19, s[50:51]
    s_mov_b32 s50, 0x0
    s_mov_b32 s51, 0xffff0000
    v_mov_b32 v19, 109104
    v_cndmask_b32_e64 v250, v20, v19, s[50:51]
    s_barrier
    s_add_u32 m0, s42, 20480
    s_add_u32 s7, s38, 1280
    buffer_load_dwordx4 v4, s[12:15], s7 offen lds
    s_add_u32 m0, s42, 21504
    s_add_u32 s7, s38, 1280
    buffer_load_dwordx4 v5, s[12:15], s7 offen lds
    s_add_u32 m0, s42, 22528
    s_add_u32 s7, s38, 1280
    buffer_load_dwordx4 v6, s[12:15], s7 offen lds
    s_add_u32 m0, s42, 23552
    s_add_u32 s7, s38, 1280
    buffer_load_dwordx4 v7, s[12:15], s7 offen lds
    s_add_u32 m0, s42, 24576
    s_add_u32 s7, s38, 1280
    buffer_load_dwordx4 v8, s[12:15], s7 offen lds
    s_add_u32 m0, s92, 122880
    s_nop 0
    buffer_load_dwordx4 v9, s[8:11], s33 offen lds
    s_add_u32 m0, s92, 123904
    s_nop 0
    buffer_load_dwordx4 v10, s[8:11], s33 offen lds
    s_add_u32 m0, s92, 124928
    s_add_u32 s7, s33, 20480
    buffer_load_dwordx4 v9, s[8:11], s7 offen lds
    s_add_u32 m0, s92, 125952
    s_add_u32 s7, s33, 20480
    buffer_load_dwordx4 v10, s[8:11], s7 offen lds
    s_add_u32 m0, s92, 126976
    s_add_u32 s7, s33, 128
    buffer_load_dwordx4 v9, s[8:11], s7 offen lds
    s_add_u32 m0, s92, 128000
    s_add_u32 s7, s33, 128
    buffer_load_dwordx4 v10, s[8:11], s7 offen lds
    s_add_u32 m0, s92, 129024
    s_add_u32 s7, s33, 20608
    buffer_load_dwordx4 v9, s[8:11], s7 offen lds
    s_add_u32 m0, s92, 130048
    s_add_u32 s7, s33, 20608
    buffer_load_dwordx4 v10, s[8:11], s7 offen lds
    s_waitcnt vmcnt(17)
    s_barrier
    ds_read_b128 a[0:3], v11 offset:0
    ds_read_b128 a[4:7], v11 offset:2048
    ds_read_b128 a[8:11], v12 offset:0
    ds_read_b128 a[12:15], v12 offset:2048
    ds_read_b64_tr_b16 a[160:161], v1 offset:0
    ds_read_b64_tr_b16 a[162:163], v1 offset:2560
    s_add_u32 m0, s42, 40960
    s_add_u32 s7, s39, 1280
    buffer_load_dwordx4 v4, s[12:15], s7 offen lds
    ds_read_b64_tr_b16 a[164:165], v1 offset:32
    ds_read_b64_tr_b16 a[166:167], v1 offset:2592
    s_add_u32 m0, s42, 41984
    s_add_u32 s7, s39, 1280
    buffer_load_dwordx4 v5, s[12:15], s7 offen lds
    ds_read_b64_tr_b16 a[168:169], v1 offset:64
    ds_read_b64_tr_b16 a[170:171], v1 offset:2624
    ds_read_b64_tr_b16 a[172:173], v1 offset:96
    ds_read_b64_tr_b16 a[174:175], v1 offset:2656
    s_add_u32 m0, s42, 43008
    s_add_u32 s7, s39, 1280
    buffer_load_dwordx4 v6, s[12:15], s7 offen lds
    ds_read_b64_tr_b16 a[176:177], v1 offset:128
    ds_read_b64_tr_b16 a[178:179], v1 offset:2688
    s_add_u32 m0, s42, 44032
    s_add_u32 s7, s39, 1280
    buffer_load_dwordx4 v7, s[12:15], s7 offen lds
    ds_read_b64_tr_b16 a[180:181], v1 offset:5120
    ds_read_b64_tr_b16 a[182:183], v1 offset:7680
    ds_read_b64_tr_b16 a[184:185], v1 offset:5152
    ds_read_b64_tr_b16 a[186:187], v1 offset:7712
    s_add_u32 m0, s42, 45056
    s_add_u32 s7, s39, 1280
    buffer_load_dwordx4 v8, s[12:15], s7 offen lds
    ds_read_b64_tr_b16 a[188:189], v1 offset:5184
    ds_read_b64_tr_b16 a[190:191], v1 offset:7744
    s_waitcnt lgkmcnt(14)
    v_mfma_f32_16x16x32_bf16 v[48:51], a[160:163], a[0:3], 0
    v_mfma_f32_16x16x32_bf16 v[68:71], a[160:163], a[4:7], 0
    s_waitcnt lgkmcnt(10)
    ds_read_b64_tr_b16 a[160:161], v1 offset:5216
    ds_read_b64_tr_b16 a[162:163], v1 offset:7776
    v_mfma_f32_16x16x32_bf16 v[52:55], a[164:167], a[0:3], 0
    v_mfma_f32_16x16x32_bf16 v[72:75], a[164:167], a[4:7], 0
    s_waitcnt vmcnt(18)
    ds_read_b128 a[16:19], v11 offset:4096
    ds_read_b128 a[20:23], v11 offset:6144
    ds_read_b128 a[24:27], v12 offset:4096
    ds_read_b128 a[28:31], v12 offset:6144
    ds_read_b64_tr_b16 a[164:165], v1 offset:5248
    ds_read_b64_tr_b16 a[166:167], v1 offset:7808
    v_mfma_f32_16x16x32_bf16 v[56:59], a[168:171], a[0:3], 0
    v_mfma_f32_16x16x32_bf16 v[76:79], a[168:171], a[4:7], 0
    s_waitcnt lgkmcnt(14)
    ds_read_b64_tr_b16 a[168:169], v1 offset:10240
    ds_read_b64_tr_b16 a[170:171], v1 offset:12800
    v_mfma_f32_16x16x32_bf16 v[60:63], a[172:175], a[0:3], 0
    v_mfma_f32_16x16x32_bf16 v[80:83], a[172:175], a[4:7], 0
    s_waitcnt lgkmcnt(4)
    s_add_u32 m0, s92, 81920
    s_nop 0
    buffer_load_dwordx4 v9, s[8:11], s34 offen lds
    ds_read_b64_tr_b16 a[172:173], v1 offset:10272
    ds_read_b64_tr_b16 a[174:175], v1 offset:12832
    v_mfma_f32_16x16x32_bf16 v[64:67], a[176:179], a[0:3], 0
    v_mfma_f32_16x16x32_bf16 v[84:87], a[176:179], a[4:7], 0
    s_add_u32 m0, s92, 82944
    s_nop 0
    buffer_load_dwordx4 v10, s[8:11], s34 offen lds
    ds_read_b64_tr_b16 a[176:177], v1 offset:10304
    ds_read_b64_tr_b16 a[178:179], v1 offset:12864
    v_mfma_f32_16x16x32_bf16 v[48:51], a[180:183], a[8:11], v[48:51]
    v_mfma_f32_16x16x32_bf16 v[68:71], a[180:183], a[12:15], v[68:71]
    s_add_u32 m0, s92, 83968
    s_add_u32 s7, s34, 20480
    buffer_load_dwordx4 v9, s[8:11], s7 offen lds
    ds_read_b64_tr_b16 a[180:181], v1 offset:10336
    ds_read_b64_tr_b16 a[182:183], v1 offset:12896
    v_mfma_f32_16x16x32_bf16 v[52:55], a[184:187], a[8:11], v[52:55]
    v_mfma_f32_16x16x32_bf16 v[72:75], a[184:187], a[12:15], v[72:75]
    s_add_u32 m0, s92, 84992
    s_add_u32 s7, s34, 20480
    buffer_load_dwordx4 v10, s[8:11], s7 offen lds
    s_waitcnt vmcnt(9)
    ds_read_b128 a[32:35], v11 offset:40960
    ds_read_b128 a[36:39], v11 offset:43008
    ds_read_b128 a[40:43], v12 offset:40960
    ds_read_b128 a[44:47], v12 offset:43008
    ds_read_b128 a[48:51], v11 offset:45056
    ds_read_b128 a[52:55], v11 offset:47104
    ds_read_b128 a[56:59], v12 offset:45056
    ds_read_b128 a[60:63], v12 offset:47104
    ds_read_b64_tr_b16 a[184:185], v1 offset:10368
    ds_read_b64_tr_b16 a[186:187], v1 offset:12928
    v_mfma_f32_16x16x32_bf16 v[56:59], a[188:191], a[8:11], v[56:59]
    v_mfma_f32_16x16x32_bf16 v[76:79], a[188:191], a[12:15], v[76:79]
    s_add_u32 m0, s92, 86016
    s_add_u32 s7, s34, 128
    buffer_load_dwordx4 v9, s[8:11], s7 offen lds
    ds_read_b64_tr_b16 a[188:189], v1 offset:15360
    ds_read_b64_tr_b16 a[190:191], v1 offset:17920
    v_mfma_f32_16x16x32_bf16 v[60:63], a[160:163], a[8:11], v[60:63]
    v_mfma_f32_16x16x32_bf16 v[80:83], a[160:163], a[12:15], v[80:83]
    s_waitcnt lgkmcnt(15)
    s_add_u32 m0, s92, 87040
    s_add_u32 s7, s34, 128
    buffer_load_dwordx4 v10, s[8:11], s7 offen lds
    ds_read_b64_tr_b16 a[160:161], v1 offset:15392
    ds_read_b64_tr_b16 a[162:163], v1 offset:17952
    v_mfma_f32_16x16x32_bf16 v[64:67], a[164:167], a[8:11], v[64:67]
    v_mfma_f32_16x16x32_bf16 v[84:87], a[164:167], a[12:15], v[84:87]
    s_add_u32 m0, s92, 88064
    s_add_u32 s7, s34, 20608
    buffer_load_dwordx4 v9, s[8:11], s7 offen lds
    ds_read_b64_tr_b16 a[164:165], v1 offset:15424
    ds_read_b64_tr_b16 a[166:167], v1 offset:17984
    v_mfma_f32_16x16x32_bf16 v[48:51], a[168:171], a[16:19], v[48:51]
    v_mfma_f32_16x16x32_bf16 v[68:71], a[168:171], a[20:23], v[68:71]
    s_add_u32 m0, s92, 89088
    s_add_u32 s7, s34, 20608
    buffer_load_dwordx4 v10, s[8:11], s7 offen lds
    ds_read_b64_tr_b16 a[168:169], v1 offset:15456
    ds_read_b64_tr_b16 a[170:171], v1 offset:18016
    v_mfma_f32_16x16x32_bf16 v[52:55], a[172:175], a[16:19], v[52:55]
    v_mfma_f32_16x16x32_bf16 v[72:75], a[172:175], a[20:23], v[72:75]
    s_waitcnt lgkmcnt(15)
    s_waitcnt lgkmcnt(10)
    s_add_u32 m0, s92, 122880
    s_nop 0
    buffer_load_dwordx4 v9, s[8:11], s35 offen lds
    ds_read_b64_tr_b16 a[172:173], v1 offset:15488
    ds_read_b64_tr_b16 a[174:175], v1 offset:18048
    v_mfma_f32_16x16x32_bf16 v[56:59], a[176:179], a[16:19], v[56:59]
    v_mfma_f32_16x16x32_bf16 v[76:79], a[176:179], a[20:23], v[76:79]
    s_add_u32 m0, s92, 123904
    s_nop 0
    buffer_load_dwordx4 v10, s[8:11], s35 offen lds
    s_waitcnt vmcnt(23)
    s_barrier
    ds_read_b64_tr_b16 a[176:177], v1 offset:20480
    ds_read_b64_tr_b16 a[178:179], v1 offset:23040
    v_mfma_f32_16x16x32_bf16 v[60:63], a[180:183], a[16:19], v[60:63]
    v_mfma_f32_16x16x32_bf16 v[80:83], a[180:183], a[20:23], v[80:83]
    s_waitcnt lgkmcnt(10)
    s_add_u32 m0, s92, 124928
    s_add_u32 s7, s35, 20480
    buffer_load_dwordx4 v9, s[8:11], s7 offen lds
    ds_read_b64_tr_b16 a[180:181], v1 offset:20512
    ds_read_b64_tr_b16 a[182:183], v1 offset:23072
    v_mfma_f32_16x16x32_bf16 v[64:67], a[184:187], a[16:19], v[64:67]
    v_mfma_f32_16x16x32_bf16 v[84:87], a[184:187], a[20:23], v[84:87]
    s_add_u32 m0, s92, 125952
    s_add_u32 s7, s35, 20480
    buffer_load_dwordx4 v10, s[8:11], s7 offen lds
    ds_read_b64_tr_b16 a[184:185], v1 offset:20544
    ds_read_b64_tr_b16 a[186:187], v1 offset:23104
    v_mfma_f32_16x16x32_bf16 v[48:51], a[188:191], a[24:27], v[48:51]
    v_mfma_f32_16x16x32_bf16 v[68:71], a[188:191], a[28:31], v[68:71]
    s_waitcnt lgkmcnt(10)
    s_add_u32 m0, s92, 126976
    s_add_u32 s7, s35, 128
    buffer_load_dwordx4 v9, s[8:11], s7 offen lds
    ds_read_b64_tr_b16 a[188:189], v1 offset:20576
    ds_read_b64_tr_b16 a[190:191], v1 offset:23136
    v_mfma_f32_16x16x32_bf16 v[52:55], a[160:163], a[24:27], v[52:55]
    v_mfma_f32_16x16x32_bf16 v[72:75], a[160:163], a[28:31], v[72:75]
    s_add_u32 m0, s92, 128000
    s_add_u32 s7, s35, 128
    buffer_load_dwordx4 v10, s[8:11], s7 offen lds
    ds_read_b64_tr_b16 a[160:161], v1 offset:20608
    ds_read_b64_tr_b16 a[162:163], v1 offset:23168
    v_mfma_f32_16x16x32_bf16 v[56:59], a[164:167], a[24:27], v[56:59]
    v_mfma_f32_16x16x32_bf16 v[76:79], a[164:167], a[28:31], v[76:79]
    s_waitcnt lgkmcnt(10)
    s_add_u32 m0, s92, 129024
    s_add_u32 s7, s35, 20608
    buffer_load_dwordx4 v9, s[8:11], s7 offen lds
    ds_read_b64_tr_b16 a[164:165], v1 offset:25600
    ds_read_b64_tr_b16 a[166:167], v1 offset:28160
    v_mfma_f32_16x16x32_bf16 v[60:63], a[168:171], a[24:27], v[60:63]
    v_mfma_f32_16x16x32_bf16 v[80:83], a[168:171], a[28:31], v[80:83]
    s_add_u32 m0, s92, 130048
    s_add_u32 s7, s35, 20608
    buffer_load_dwordx4 v10, s[8:11], s7 offen lds
    ds_read_b64_tr_b16 a[168:169], v1 offset:25632
    ds_read_b64_tr_b16 a[170:171], v1 offset:28192
    v_mfma_f32_16x16x32_bf16 v[64:67], a[172:175], a[24:27], v[64:67]
    v_mfma_f32_16x16x32_bf16 v[84:87], a[172:175], a[28:31], v[84:87]
    s_waitcnt lgkmcnt(10)
    s_add_u32 m0, s42, 61440
    s_add_u32 s7, s40, 1280
    buffer_load_dwordx4 v4, s[12:15], s7 offen lds
    ds_read_b64_tr_b16 a[172:173], v1 offset:25664
    ds_read_b64_tr_b16 a[174:175], v1 offset:28224
    v_mfma_f32_16x16x32_bf16 v[48:51], a[176:179], a[32:35], v[48:51]
    v_mfma_f32_16x16x32_bf16 v[68:71], a[176:179], a[36:39], v[68:71]
    s_add_u32 m0, s42, 62464
    s_add_u32 s7, s40, 1280
    buffer_load_dwordx4 v5, s[12:15], s7 offen lds
    ds_read_b64_tr_b16 a[176:177], v1 offset:25696
    ds_read_b64_tr_b16 a[178:179], v1 offset:28256
    v_mfma_f32_16x16x32_bf16 v[52:55], a[180:183], a[32:35], v[52:55]
    v_mfma_f32_16x16x32_bf16 v[72:75], a[180:183], a[36:39], v[72:75]
    s_waitcnt lgkmcnt(10)
    s_add_u32 m0, s42, 63488
    s_add_u32 s7, s40, 1280
    buffer_load_dwordx4 v6, s[12:15], s7 offen lds
    ds_read_b64_tr_b16 a[180:181], v1 offset:25728
    ds_read_b64_tr_b16 a[182:183], v1 offset:28288
    v_mfma_f32_16x16x32_bf16 v[56:59], a[184:187], a[32:35], v[56:59]
    v_mfma_f32_16x16x32_bf16 v[76:79], a[184:187], a[36:39], v[76:79]
    s_add_u32 m0, s42, 64512
    s_add_u32 s7, s40, 1280
    buffer_load_dwordx4 v7, s[12:15], s7 offen lds
    ds_read_b64_tr_b16 a[184:185], v1 offset:30720
    ds_read_b64_tr_b16 a[186:187], v1 offset:33280
    v_mfma_f32_16x16x32_bf16 v[60:63], a[188:191], a[32:35], v[60:63]
    v_mfma_f32_16x16x32_bf16 v[80:83], a[188:191], a[36:39], v[80:83]
    s_waitcnt lgkmcnt(10)
    s_add_u32 m0, s42, 65536
    s_add_u32 s7, s40, 1280
    buffer_load_dwordx4 v8, s[12:15], s7 offen lds
    ds_read_b64_tr_b16 a[188:189], v1 offset:30752
    ds_read_b64_tr_b16 a[190:191], v1 offset:33312
    v_mfma_f32_16x16x32_bf16 v[64:67], a[160:163], a[32:35], v[64:67]
    v_mfma_f32_16x16x32_bf16 v[84:87], a[160:163], a[36:39], v[84:87]
    ds_read_b64_tr_b16 a[160:161], v1 offset:30784
    ds_read_b64_tr_b16 a[162:163], v1 offset:33344
    v_mfma_f32_16x16x32_bf16 v[48:51], a[164:167], a[40:43], v[48:51]
    v_mfma_f32_16x16x32_bf16 v[68:71], a[164:167], a[44:47], v[68:71]
    s_waitcnt lgkmcnt(10)
    ds_read_b64_tr_b16 a[164:165], v1 offset:30816
    ds_read_b64_tr_b16 a[166:167], v1 offset:33376
    v_mfma_f32_16x16x32_bf16 v[52:55], a[168:171], a[40:43], v[52:55]
    v_mfma_f32_16x16x32_bf16 v[72:75], a[168:171], a[44:47], v[72:75]
    s_waitcnt vmcnt(13)
    ds_read_b128 a[64:67], v11 offset:0
    ds_read_b128 a[68:71], v11 offset:2048
    ds_read_b128 a[72:75], v12 offset:0
    ds_read_b128 a[76:79], v12 offset:2048
    ds_read_b128 a[80:83], v11 offset:4096
    ds_read_b128 a[84:87], v11 offset:6144
    ds_read_b128 a[88:91], v12 offset:4096
    ds_read_b128 a[92:95], v12 offset:6144
    ds_read_b64_tr_b16 a[168:169], v1 offset:30848
    ds_read_b64_tr_b16 a[170:171], v1 offset:33408
    v_mfma_f32_16x16x32_bf16 v[56:59], a[172:175], a[40:43], v[56:59]
    v_mfma_f32_16x16x32_bf16 v[76:79], a[172:175], a[44:47], v[76:79]
    s_waitcnt lgkmcnt(15)
    ds_read_b64_tr_b16 a[172:173], v1 offset:35840
    ds_read_b64_tr_b16 a[174:175], v1 offset:38400
    v_mfma_f32_16x16x32_bf16 v[60:63], a[176:179], a[40:43], v[60:63]
    v_mfma_f32_16x16x32_bf16 v[80:83], a[176:179], a[44:47], v[80:83]
    s_lshl_b32 s4, s28, 10
    s_mul_i32 s3, s30, 3200
    s_add_u32 s3, s3, s4
    s_add_u32 m0, s4, 155648
    v_lshlrev_b32 v13, 4, v0
    buffer_load_dwordx4 v13, s[24:27], s3 offen lds
    ds_read_b64_tr_b16 a[176:177], v1 offset:35872
    ds_read_b64_tr_b16 a[178:179], v1 offset:38432
    v_mfma_f32_16x16x32_bf16 v[64:67], a[180:183], a[40:43], v[64:67]
    v_mfma_f32_16x16x32_bf16 v[84:87], a[180:183], a[44:47], v[84:87]
    ds_read_b64_tr_b16 a[180:181], v1 offset:35904
    ds_read_b64_tr_b16 a[182:183], v1 offset:38464
    v_mfma_f32_16x16x32_bf16 v[48:51], a[184:187], a[48:51], v[48:51]
    v_mfma_f32_16x16x32_bf16 v[68:71], a[184:187], a[52:55], v[68:71]
    s_waitcnt lgkmcnt(15)
    ds_read_b64_tr_b16 a[184:185], v1 offset:35936
    ds_read_b64_tr_b16 a[186:187], v1 offset:38496
    v_mfma_f32_16x16x32_bf16 v[52:55], a[188:191], a[48:51], v[52:55]
    v_mfma_f32_16x16x32_bf16 v[72:75], a[188:191], a[52:55], v[72:75]
    s_waitcnt lgkmcnt(10)
    s_add_u32 m0, s92, 81920
    s_nop 0
    buffer_load_dwordx4 v9, s[8:11], s36 offen lds
    ds_read_b64_tr_b16 a[188:189], v1 offset:35968
    ds_read_b64_tr_b16 a[190:191], v1 offset:38528
    v_mfma_f32_16x16x32_bf16 v[56:59], a[160:163], a[48:51], v[56:59]
    v_mfma_f32_16x16x32_bf16 v[76:79], a[160:163], a[52:55], v[76:79]
    s_add_u32 m0, s92, 82944
    s_nop 0
    buffer_load_dwordx4 v10, s[8:11], s36 offen lds
    s_waitcnt vmcnt(24)
    s_barrier
    ds_read_b64_tr_b16 a[160:161], v1 offset:40960
    ds_read_b64_tr_b16 a[162:163], v1 offset:43520
    v_mfma_f32_16x16x32_bf16 v[60:63], a[164:167], a[48:51], v[60:63]
    v_mfma_f32_16x16x32_bf16 v[80:83], a[164:167], a[52:55], v[80:83]
    s_waitcnt lgkmcnt(10)
    s_add_u32 m0, s92, 83968
    s_add_u32 s7, s36, 20480
    buffer_load_dwordx4 v9, s[8:11], s7 offen lds
    ds_read_b64_tr_b16 a[164:165], v1 offset:40992
    ds_read_b64_tr_b16 a[166:167], v1 offset:43552
    v_mfma_f32_16x16x32_bf16 v[64:67], a[168:171], a[48:51], v[64:67]
    v_mfma_f32_16x16x32_bf16 v[84:87], a[168:171], a[52:55], v[84:87]
    s_add_u32 m0, s92, 84992
    s_add_u32 s7, s36, 20480
    buffer_load_dwordx4 v10, s[8:11], s7 offen lds
    ds_read_b64_tr_b16 a[168:169], v1 offset:41024
    ds_read_b64_tr_b16 a[170:171], v1 offset:43584
    v_mfma_f32_16x16x32_bf16 v[48:51], a[172:175], a[56:59], v[48:51]
    v_mfma_f32_16x16x32_bf16 v[68:71], a[172:175], a[60:63], v[68:71]
    s_waitcnt lgkmcnt(10)
    s_add_u32 m0, s92, 86016
    s_add_u32 s7, s36, 128
    buffer_load_dwordx4 v9, s[8:11], s7 offen lds
    ds_read_b64_tr_b16 a[172:173], v1 offset:41056
    ds_read_b64_tr_b16 a[174:175], v1 offset:43616
    v_mfma_f32_16x16x32_bf16 v[52:55], a[176:179], a[56:59], v[52:55]
    v_mfma_f32_16x16x32_bf16 v[72:75], a[176:179], a[60:63], v[72:75]
    s_add_u32 m0, s92, 87040
    s_add_u32 s7, s36, 128
    buffer_load_dwordx4 v10, s[8:11], s7 offen lds
    ds_read_b64_tr_b16 a[176:177], v1 offset:41088
    ds_read_b64_tr_b16 a[178:179], v1 offset:43648
    v_mfma_f32_16x16x32_bf16 v[56:59], a[180:183], a[56:59], v[56:59]
    v_mfma_f32_16x16x32_bf16 v[76:79], a[180:183], a[60:63], v[76:79]
    s_waitcnt lgkmcnt(10)
    s_add_u32 m0, s92, 88064
    s_add_u32 s7, s36, 20608
    buffer_load_dwordx4 v9, s[8:11], s7 offen lds
    ds_read_b64_tr_b16 a[180:181], v1 offset:46080
    ds_read_b64_tr_b16 a[182:183], v1 offset:48640
    v_mfma_f32_16x16x32_bf16 v[60:63], a[184:187], a[56:59], v[60:63]
    v_mfma_f32_16x16x32_bf16 v[80:83], a[184:187], a[60:63], v[80:83]
    s_add_u32 m0, s92, 89088
    s_add_u32 s7, s36, 20608
    buffer_load_dwordx4 v10, s[8:11], s7 offen lds
    ds_read_b64_tr_b16 a[184:185], v1 offset:46112
    ds_read_b64_tr_b16 a[186:187], v1 offset:48672
    v_mfma_f32_16x16x32_bf16 v[64:67], a[188:191], a[56:59], v[64:67]
    v_mfma_f32_16x16x32_bf16 v[84:87], a[188:191], a[60:63], v[84:87]
    s_waitcnt lgkmcnt(10)
    s_add_u32 m0, s42, 0
    s_add_u32 s7, s41, 1280
    buffer_load_dwordx4 v4, s[12:15], s7 offen lds
    ds_read_b64_tr_b16 a[188:189], v1 offset:46144
    ds_read_b64_tr_b16 a[190:191], v1 offset:48704
    v_mfma_f32_16x16x32_bf16 v[48:51], a[160:163], a[64:67], v[48:51]
    v_mfma_f32_16x16x32_bf16 v[68:71], a[160:163], a[68:71], v[68:71]
    s_add_u32 m0, s42, 1024
    s_add_u32 s7, s41, 1280
    buffer_load_dwordx4 v5, s[12:15], s7 offen lds
    ds_read_b64_tr_b16 a[160:161], v1 offset:46176
    ds_read_b64_tr_b16 a[162:163], v1 offset:48736
    v_mfma_f32_16x16x32_bf16 v[52:55], a[164:167], a[64:67], v[52:55]
    v_mfma_f32_16x16x32_bf16 v[72:75], a[164:167], a[68:71], v[72:75]
    s_waitcnt lgkmcnt(10)
    s_add_u32 m0, s42, 2048
    s_add_u32 s7, s41, 1280
    buffer_load_dwordx4 v6, s[12:15], s7 offen lds
    ds_read_b64_tr_b16 a[164:165], v1 offset:46208
    ds_read_b64_tr_b16 a[166:167], v1 offset:48768
    v_mfma_f32_16x16x32_bf16 v[56:59], a[168:171], a[64:67], v[56:59]
    v_mfma_f32_16x16x32_bf16 v[76:79], a[168:171], a[68:71], v[76:79]
    s_add_u32 m0, s42, 3072
    s_add_u32 s7, s41, 1280
    buffer_load_dwordx4 v7, s[12:15], s7 offen lds
    ds_read_b64_tr_b16 a[168:169], v1 offset:51200
    ds_read_b64_tr_b16 a[170:171], v1 offset:53760
    v_mfma_f32_16x16x32_bf16 v[60:63], a[172:175], a[64:67], v[60:63]
    v_mfma_f32_16x16x32_bf16 v[80:83], a[172:175], a[68:71], v[80:83]
    s_waitcnt lgkmcnt(10)
    s_add_u32 m0, s42, 4096
    s_add_u32 s7, s41, 1280
    buffer_load_dwordx4 v8, s[12:15], s7 offen lds
    ds_read_b64_tr_b16 a[172:173], v1 offset:51232
    ds_read_b64_tr_b16 a[174:175], v1 offset:53792
    v_mfma_f32_16x16x32_bf16 v[64:67], a[176:179], a[64:67], v[64:67]
    v_mfma_f32_16x16x32_bf16 v[84:87], a[176:179], a[68:71], v[84:87]
    ds_read_b64_tr_b16 a[176:177], v1 offset:51264
    ds_read_b64_tr_b16 a[178:179], v1 offset:53824
    v_mfma_f32_16x16x32_bf16 v[48:51], a[180:183], a[72:75], v[48:51]
    v_mfma_f32_16x16x32_bf16 v[68:71], a[180:183], a[76:79], v[68:71]
    s_waitcnt lgkmcnt(10)
    ds_read_b64_tr_b16 a[180:181], v1 offset:51296
    ds_read_b64_tr_b16 a[182:183], v1 offset:53856
    v_mfma_f32_16x16x32_bf16 v[52:55], a[184:187], a[72:75], v[52:55]
    v_mfma_f32_16x16x32_bf16 v[72:75], a[184:187], a[76:79], v[72:75]
    s_waitcnt vmcnt(19)
    ds_read_b128 a[96:99], v11 offset:40960
    ds_read_b128 a[100:103], v11 offset:43008
    ds_read_b128 a[104:107], v12 offset:40960
    ds_read_b128 a[108:111], v12 offset:43008
    ds_read_b128 a[112:115], v11 offset:45056
    ds_read_b128 a[116:119], v11 offset:47104
    ds_read_b128 a[120:123], v12 offset:45056
    ds_read_b128 a[124:127], v12 offset:47104
    ds_read_b64_tr_b16 a[184:185], v1 offset:51328
    ds_read_b64_tr_b16 a[186:187], v1 offset:53888
    v_mfma_f32_16x16x32_bf16 v[56:59], a[188:191], a[72:75], v[56:59]
    v_mfma_f32_16x16x32_bf16 v[76:79], a[188:191], a[76:79], v[76:79]
    s_waitcnt lgkmcnt(15)
    ds_read_b64_tr_b16 a[188:189], v1 offset:56320
    ds_read_b64_tr_b16 a[190:191], v1 offset:58880
    v_mfma_f32_16x16x32_bf16 v[60:63], a[160:163], a[72:75], v[60:63]
    v_mfma_f32_16x16x32_bf16 v[80:83], a[160:163], a[76:79], v[80:83]
    ds_read_b64_tr_b16 a[160:161], v1 offset:56352
    ds_read_b64_tr_b16 a[162:163], v1 offset:58912
    v_mfma_f32_16x16x32_bf16 v[64:67], a[164:167], a[72:75], v[64:67]
    v_mfma_f32_16x16x32_bf16 v[84:87], a[164:167], a[76:79], v[84:87]
    v_mov_b32 v88, 0
    s_mov_b64 exec, 1
    buffer_load_dword v89, v88, s[20:23], 0 offen sc1
    s_mov_b64 exec, -1
    ds_read_b64_tr_b16 a[164:165], v1 offset:56384
    ds_read_b64_tr_b16 a[166:167], v1 offset:58944
    v_mfma_f32_16x16x32_bf16 v[48:51], a[168:171], a[80:83], v[48:51]
    v_mfma_f32_16x16x32_bf16 v[68:71], a[168:171], a[84:87], v[68:71]
    s_waitcnt lgkmcnt(15)
    ds_read_b64_tr_b16 a[168:169], v1 offset:56416
    ds_read_b64_tr_b16 a[170:171], v1 offset:58976
    v_mfma_f32_16x16x32_bf16 v[52:55], a[172:175], a[80:83], v[52:55]
    v_mfma_f32_16x16x32_bf16 v[72:75], a[172:175], a[84:87], v[72:75]
    ds_read_b64_tr_b16 a[172:173], v1 offset:56448
    ds_read_b64_tr_b16 a[174:175], v1 offset:59008
    v_mfma_f32_16x16x32_bf16 v[56:59], a[176:179], a[80:83], v[56:59]
    v_mfma_f32_16x16x32_bf16 v[76:79], a[176:179], a[84:87], v[76:79]
    s_waitcnt vmcnt(14)
    s_barrier
    v_lshrrev_b32 v16, 2, v0
    v_mul_u32_u24 v16, 40, v16
    v_add_u32 v16, 155648, v16
    v_and_b32 v17, 3, v0
    v_lshl_add_u32 v17, v17, 3, v16
    ds_read_b64_tr_b16 v[140:141], v17 offset:0
    ds_read_b64_tr_b16 v[150:151], v16 offset:32
    ds_read_b64_tr_b16 v[142:143], v17 offset:640
    ds_read_b64_tr_b16 v[152:153], v16 offset:672
    ds_read_b64_tr_b16 v[144:145], v17 offset:1280
    ds_read_b64_tr_b16 v[154:155], v16 offset:1312
    ds_read_b64_tr_b16 v[146:147], v17 offset:1920
    ds_read_b64_tr_b16 v[156:157], v16 offset:1952
    ds_read_b64_tr_b16 v[148:149], v17 offset:2560
    ds_read_b64_tr_b16 v[158:159], v16 offset:2592
    ds_read_b64_tr_b16 a[176:177], v2 offset:0
    ds_read_b64_tr_b16 a[178:179], v2 offset:2560
    v_mfma_f32_16x16x32_bf16 v[60:63], a[180:183], a[80:83], v[60:63]
    v_mfma_f32_16x16x32_bf16 v[80:83], a[180:183], a[84:87], v[80:83]
    s_waitcnt lgkmcnt(15)
    s_add_u32 m0, s42, 20480
    s_add_u32 s7, s37, 2560
    buffer_load_dwordx4 v4, s[12:15], s7 offen lds
    ds_read_b64_tr_b16 a[180:181], v2 offset:32
    ds_read_b64_tr_b16 a[182:183], v2 offset:2592
    v_mfma_f32_16x16x32_bf16 v[64:67], a[184:187], a[80:83], v[64:67]
    v_mfma_f32_16x16x32_bf16 v[84:87], a[184:187], a[84:87], v[84:87]
    ds_read_b64_tr_b16 a[184:185], v2 offset:64
    ds_read_b64_tr_b16 a[186:187], v2 offset:2624
    v_mfma_f32_16x16x32_bf16 v[48:51], a[188:191], a[88:91], v[48:51]
    v_mfma_f32_16x16x32_bf16 v[68:71], a[188:191], a[92:95], v[68:71]
    s_add_u32 m0, s42, 21504
    s_add_u32 s7, s37, 2560
    buffer_load_dwordx4 v5, s[12:15], s7 offen lds
    ds_read_b64_tr_b16 a[188:189], v2 offset:96
    ds_read_b64_tr_b16 a[190:191], v2 offset:2656
    v_mfma_f32_16x16x32_bf16 v[52:55], a[160:163], a[88:91], v[52:55]
    v_mfma_f32_16x16x32_bf16 v[72:75], a[160:163], a[92:95], v[72:75]
    ds_read_b64_tr_b16 a[160:161], v2 offset:128
    ds_read_b64_tr_b16 a[162:163], v2 offset:2688
    v_mfma_f32_16x16x32_bf16 v[56:59], a[164:167], a[88:91], v[56:59]
    v_mfma_f32_16x16x32_bf16 v[76:79], a[164:167], a[92:95], v[76:79]
    s_waitcnt lgkmcnt(15)
    s_add_u32 m0, s42, 22528
    s_add_u32 s7, s37, 2560
    buffer_load_dwordx4 v6, s[12:15], s7 offen lds
    ds_read_b64_tr_b16 a[164:165], v2 offset:5120
    ds_read_b64_tr_b16 a[166:167], v2 offset:7680
    v_mfma_f32_16x16x32_bf16 v[60:63], a[168:171], a[88:91], v[60:63]
    v_mfma_f32_16x16x32_bf16 v[80:83], a[168:171], a[92:95], v[80:83]
    ds_read_b64_tr_b16 a[168:169], v2 offset:5152
    ds_read_b64_tr_b16 a[170:171], v2 offset:7712
    v_mfma_f32_16x16x32_bf16 v[64:67], a[172:175], a[88:91], v[64:67]
    v_mfma_f32_16x16x32_bf16 v[84:87], a[172:175], a[92:95], v[84:87]
    s_waitcnt lgkmcnt(10)
    s_add_u32 m0, s42, 23552
    s_add_u32 s7, s37, 2560
    buffer_load_dwordx4 v7, s[12:15], s7 offen lds
    ds_read_b64_tr_b16 a[172:173], v2 offset:5184
    ds_read_b64_tr_b16 a[174:175], v2 offset:7744
    v_mfma_f32_16x16x32_bf16 v[48:51], a[176:179], a[96:99], v[48:51]
    v_mfma_f32_16x16x32_bf16 v[68:71], a[176:179], a[100:103], v[68:71]
    v_mov_b32 v112, v140
    v_mov_b32 v113, v141
    v_cndmask_b32_e64 v114, 0, v142, s[60:61]
    ds_read_b64_tr_b16 a[176:177], v2 offset:5216
    ds_read_b64_tr_b16 a[178:179], v2 offset:7776
    v_mfma_f32_16x16x32_bf16 v[52:55], a[180:183], a[96:99], v[52:55]
    v_mfma_f32_16x16x32_bf16 v[72:75], a[180:183], a[100:103], v[72:75]
    s_waitcnt lgkmcnt(10)
    s_add_u32 m0, s42, 24576
    s_add_u32 s7, s37, 2560
    buffer_load_dwordx4 v8, s[12:15], s7 offen lds
    v_cndmask_b32_e64 v115, 0, v143, s[60:61]
    v_cndmask_b32_e64 v116, 0, v142, s[54:55]
    v_cndmask_b32_e64 v117, 0, v143, s[54:55]
    v_cndmask_b32_e64 v118, 0, v144, s[62:63]
    ds_read_b64_tr_b16 a[180:181], v2 offset:5248
    ds_read_b64_tr_b16 a[182:183], v2 offset:7808
    v_mfma_f32_16x16x32_bf16 v[56:59], a[184:187], a[96:99], v[56:59]
    v_mfma_f32_16x16x32_bf16 v[76:79], a[184:187], a[100:103], v[76:79]
    v_cndmask_b32_e64 v119, 0, v145, s[62:63]
    v_cndmask_b32_e64 v120, 0, v144, s[56:57]
    v_cndmask_b32_e64 v121, 0, v145, s[56:57]
    ds_read_b64_tr_b16 a[184:185], v2 offset:10240
    ds_read_b64_tr_b16 a[186:187], v2 offset:12800
    v_mfma_f32_16x16x32_bf16 v[60:63], a[188:191], a[96:99], v[60:63]
    v_mfma_f32_16x16x32_bf16 v[80:83], a[188:191], a[100:103], v[80:83]
    s_waitcnt lgkmcnt(10)
    v_cndmask_b32_e64 v122, 0, v146, s[64:65]
    v_cndmask_b32_e64 v123, 0, v147, s[64:65]
    v_cndmask_b32_e64 v124, 0, v146, s[58:59]
    v_cndmask_b32_e64 v125, 0, v147, s[58:59]
    ds_read_b64_tr_b16 a[188:189], v2 offset:10272
    ds_read_b64_tr_b16 a[190:191], v2 offset:12832
    v_mfma_f32_16x16x32_bf16 v[64:67], a[160:163], a[96:99], v[64:67]
    v_mfma_f32_16x16x32_bf16 v[84:87], a[160:163], a[100:103], v[84:87]
    v_mov_b32 v126, v148
    v_mov_b32 v127, v149
    s_mov_b32 s50, 0xf000f
    ds_read_b64_tr_b16 a[160:161], v2 offset:10304
    ds_read_b64_tr_b16 a[162:163], v2 offset:12864
    v_mfma_f32_16x16x32_bf16 v[48:51], a[164:167], a[104:107], v[48:51]
    v_mfma_f32_16x16x32_bf16 v[68:71], a[164:167], a[108:111], v[68:71]
    s_waitcnt lgkmcnt(10)
    s_waitcnt vmcnt(11)
    ds_read_b128 a[128:131], v11 offset:0
    ds_read_b128 a[132:135], v11 offset:2048
    ds_read_b128 a[136:139], v12 offset:0
    ds_read_b128 a[140:143], v12 offset:2048
    ds_read_b128 a[144:147], v11 offset:4096
    ds_read_b128 a[148:151], v11 offset:6144
    ds_read_b128 a[152:155], v12 offset:4096
    ds_read_b128 a[156:159], v12 offset:6144
    s_mov_b32 s51, 0xf000f
    v_cndmask_b32_e64 v128, 0, v150, s[50:51]
    v_cndmask_b32_e64 v129, 0, v151, s[50:51]
    s_mov_b32 s50, 0xf0000f
    ds_read_b64_tr_b16 a[164:165], v2 offset:10336
    ds_read_b64_tr_b16 a[166:167], v2 offset:12896
    v_mfma_f32_16x16x32_bf16 v[52:55], a[168:171], a[104:107], v[52:55]
    v_mfma_f32_16x16x32_bf16 v[72:75], a[168:171], a[108:111], v[72:75]
    s_mov_b32 s51, 0xf000f0
    v_cndmask_b32_e64 v130, 0, v152, s[50:51]
    v_cndmask_b32_e64 v131, 0, v153, s[50:51]
    ds_read_b64_tr_b16 a[168:169], v2 offset:10368
    ds_read_b64_tr_b16 a[170:171], v2 offset:12928
    v_mfma_f32_16x16x32_bf16 v[56:59], a[172:175], a[104:107], v[56:59]
    v_mfma_f32_16x16x32_bf16 v[76:79], a[172:175], a[108:111], v[76:79]
    s_waitcnt lgkmcnt(15)
    s_mov_b32 s50, 0xf000f0
    s_mov_b32 s51, 0xf000f00
    v_cndmask_b32_e64 v132, 0, v154, s[50:51]
    v_cndmask_b32_e64 v133, 0, v155, s[50:51]
    ds_read_b64_tr_b16 a[172:173], v2 offset:15360
    ds_read_b64_tr_b16 a[174:175], v2 offset:17920
    v_mfma_f32_16x16x32_bf16 v[60:63], a[176:179], a[104:107], v[60:63]
    v_mfma_f32_16x16x32_bf16 v[80:83], a[176:179], a[108:111], v[80:83]
    s_mov_b32 s50, 0xf000f00
    s_mov_b32 s51, 0xf0000f00
    v_cndmask_b32_e64 v134, 0, v156, s[50:51]
    ds_read_b64_tr_b16 a[176:177], v2 offset:15392
    ds_read_b64_tr_b16 a[178:179], v2 offset:17952
    v_mfma_f32_16x16x32_bf16 v[64:67], a[180:183], a[104:107], v[64:67]
    v_mfma_f32_16x16x32_bf16 v[84:87], a[180:183], a[108:111], v[84:87]
    v_cndmask_b32_e64 v135, 0, v157, s[50:51]
    s_mov_b32 s50, 0xf000f000
    s_mov_b32 s51, 0xf000f000
    v_cndmask_b32_e64 v136, 0, v158, s[50:51]
    ds_read_b64_tr_b16 a[180:181], v2 offset:15424
    ds_read_b64_tr_b16 a[182:183], v2 offset:17984
    v_mfma_f32_16x16x32_bf16 v[48:51], a[184:187], a[112:115], v[48:51]
    v_mfma_f32_16x16x32_bf16 v[68:71], a[184:187], a[116:119], v[68:71]
    s_waitcnt lgkmcnt(15)
    v_cndmask_b32_e64 v137, 0, v159, s[50:51]
    v_mov_b32 v138, 0
    v_mov_b32 v139, 0
    ds_read_b64_tr_b16 a[184:185], v2 offset:15456
    ds_read_b64_tr_b16 a[186:187], v2 offset:18016
    v_mfma_f32_16x16x32_bf16 v[52:55], a[188:191], a[112:115], v[52:55]
    v_mfma_f32_16x16x32_bf16 v[72:75], a[188:191], a[116:119], v[72:75]
    v_mov_b32 v98, 0
    v_mov_b32 v99, 0
    v_mov_b32 v110, 0
    v_mov_b32 v111, 0
    ds_read_b64_tr_b16 a[188:189], v2 offset:15488
    ds_read_b64_tr_b16 a[190:191], v2 offset:18048
    v_mfma_f32_16x16x32_bf16 v[56:59], a[160:163], a[112:115], v[56:59]
    v_mfma_f32_16x16x32_bf16 v[76:79], a[160:163], a[116:119], v[76:79]
    s_waitcnt lgkmcnt(10)
    s_waitcnt vmcnt(6)
    s_barrier
    ds_read_b64_tr_b16 a[160:161], v1 offset:0
    ds_read_b64_tr_b16 a[162:163], v1 offset:2560
    v_mfma_f32_16x16x32_bf16 v[60:63], a[164:167], a[112:115], v[60:63]
    v_mfma_f32_16x16x32_bf16 v[80:83], a[164:167], a[116:119], v[80:83]
    s_add_u32 m0, s42, 40960
    s_add_u32 s7, s38, 2560
    buffer_load_dwordx4 v4, s[12:15], s7 offen lds
    ds_read_b64_tr_b16 a[164:165], v1 offset:32
    ds_read_b64_tr_b16 a[166:167], v1 offset:2592
    v_mfma_f32_16x16x32_bf16 v[64:67], a[168:171], a[112:115], v[64:67]
    v_mfma_f32_16x16x32_bf16 v[84:87], a[168:171], a[116:119], v[84:87]
    s_waitcnt lgkmcnt(10)
    ds_read_b64_tr_b16 a[168:169], v1 offset:64
    ds_read_b64_tr_b16 a[170:171], v1 offset:2624
    v_mfma_f32_16x16x32_bf16 v[48:51], a[172:175], a[120:123], v[48:51]
    v_mfma_f32_16x16x32_bf16 v[68:71], a[172:175], a[124:127], v[68:71]
    s_add_u32 m0, s42, 41984
    s_add_u32 s7, s38, 2560
    buffer_load_dwordx4 v5, s[12:15], s7 offen lds
    ds_read_b64_tr_b16 a[172:173], v1 offset:96
    ds_read_b64_tr_b16 a[174:175], v1 offset:2656
    v_mfma_f32_16x16x32_bf16 v[52:55], a[176:179], a[120:123], v[52:55]
    v_mfma_f32_16x16x32_bf16 v[72:75], a[176:179], a[124:127], v[72:75]
    s_waitcnt lgkmcnt(10)
    ds_read_b64_tr_b16 a[176:177], v1 offset:128
    ds_read_b64_tr_b16 a[178:179], v1 offset:2688
    v_mfma_f32_16x16x32_bf16 v[56:59], a[180:183], a[120:123], v[56:59]
    v_mfma_f32_16x16x32_bf16 v[76:79], a[180:183], a[124:127], v[76:79]
    s_add_u32 m0, s42, 43008
    s_add_u32 s7, s38, 2560
    buffer_load_dwordx4 v6, s[12:15], s7 offen lds
    ds_read_b64_tr_b16 a[180:181], v1 offset:5120
    ds_read_b64_tr_b16 a[182:183], v1 offset:7680
    v_mfma_f32_16x16x32_bf16 v[60:63], a[184:187], a[120:123], v[60:63]
    v_mfma_f32_16x16x32_bf16 v[80:83], a[184:187], a[124:127], v[80:83]
    s_waitcnt lgkmcnt(10)
    ds_read_b64_tr_b16 a[184:185], v1 offset:5152
    ds_read_b64_tr_b16 a[186:187], v1 offset:7712
    v_mfma_f32_16x16x32_bf16 v[64:67], a[188:191], a[120:123], v[64:67]
    v_mfma_f32_16x16x32_bf16 v[84:87], a[188:191], a[124:127], v[84:87]
    s_add_u32 m0, s42, 44032
    s_add_u32 s7, s38, 2560
    buffer_load_dwordx4 v7, s[12:15], s7 offen lds
    ds_read_b64_tr_b16 a[188:189], v1 offset:5184
    ds_read_b64_tr_b16 a[190:191], v1 offset:7744
    v_mfma_f32_16x16x32_bf16 v[48:51], a[160:163], a[128:131], v[48:51]
    v_mfma_f32_16x16x32_bf16 v[68:71], a[160:163], a[132:135], v[68:71]
    s_waitcnt lgkmcnt(10)
    ds_read_b64_tr_b16 a[160:161], v1 offset:5216
    ds_read_b64_tr_b16 a[162:163], v1 offset:7776
    v_mfma_f32_16x16x32_bf16 v[52:55], a[164:167], a[128:131], v[52:55]
    v_mfma_f32_16x16x32_bf16 v[72:75], a[164:167], a[132:135], v[72:75]
    s_add_u32 m0, s42, 45056
    s_add_u32 s7, s38, 2560
    buffer_load_dwordx4 v8, s[12:15], s7 offen lds
    ds_read_b64_tr_b16 a[164:165], v1 offset:5248
    ds_read_b64_tr_b16 a[166:167], v1 offset:7808
    v_mfma_f32_16x16x32_bf16 v[56:59], a[168:171], a[128:131], v[56:59]
    v_mfma_f32_16x16x32_bf16 v[76:79], a[168:171], a[132:135], v[76:79]
    s_waitcnt lgkmcnt(10)
    ds_read_b64_tr_b16 a[168:169], v1 offset:10240
    ds_read_b64_tr_b16 a[170:171], v1 offset:12800
    v_mfma_f32_16x16x32_bf16 v[60:63], a[172:175], a[128:131], v[60:63]
    v_mfma_f32_16x16x32_bf16 v[80:83], a[172:175], a[132:135], v[80:83]
    s_add_u32 m0, s42, 81920
    s_add_u32 s7, s39, 2560
    buffer_load_dwordx4 v4, s[12:15], s7 offen lds
    ds_read_b64_tr_b16 a[172:173], v1 offset:10272
    ds_read_b64_tr_b16 a[174:175], v1 offset:12832
    v_mfma_f32_16x16x32_bf16 v[64:67], a[176:179], a[128:131], v[64:67]
    v_mfma_f32_16x16x32_bf16 v[84:87], a[176:179], a[132:135], v[84:87]
    s_waitcnt lgkmcnt(10)
    ds_read_b64_tr_b16 a[176:177], v1 offset:10304
    ds_read_b64_tr_b16 a[178:179], v1 offset:12864
    v_mfma_f32_16x16x32_bf16 v[48:51], a[180:183], a[136:139], v[48:51]
    v_mfma_f32_16x16x32_bf16 v[68:71], a[180:183], a[140:143], v[68:71]
    s_add_u32 m0, s42, 82944
    s_add_u32 s7, s39, 2560
    buffer_load_dwordx4 v5, s[12:15], s7 offen lds
    ds_read_b64_tr_b16 a[180:181], v1 offset:10336
    ds_read_b64_tr_b16 a[182:183], v1 offset:12896
    v_mfma_f32_16x16x32_bf16 v[52:55], a[184:187], a[136:139], v[52:55]
    v_mfma_f32_16x16x32_bf16 v[72:75], a[184:187], a[140:143], v[72:75]
    s_waitcnt lgkmcnt(10)
    ds_read_b64_tr_b16 a[184:185], v1 offset:10368
    ds_read_b64_tr_b16 a[186:187], v1 offset:12928
    v_mfma_f32_16x16x32_bf16 v[56:59], a[188:191], a[136:139], v[56:59]
    v_mfma_f32_16x16x32_bf16 v[76:79], a[188:191], a[140:143], v[76:79]
    s_add_u32 m0, s42, 83968
    s_add_u32 s7, s39, 2560
    buffer_load_dwordx4 v6, s[12:15], s7 offen lds
    ds_read_b64_tr_b16 a[188:189], v1 offset:15360
    ds_read_b64_tr_b16 a[190:191], v1 offset:17920
    v_mfma_f32_16x16x32_bf16 v[60:63], a[160:163], a[136:139], v[60:63]
    v_mfma_f32_16x16x32_bf16 v[80:83], a[160:163], a[140:143], v[80:83]
    s_waitcnt lgkmcnt(10)
    ds_read_b64_tr_b16 a[160:161], v1 offset:15392
    ds_read_b64_tr_b16 a[162:163], v1 offset:17952
    v_mfma_f32_16x16x32_bf16 v[64:67], a[164:167], a[136:139], v[64:67]
    v_mfma_f32_16x16x32_bf16 v[84:87], a[164:167], a[140:143], v[84:87]
    s_add_u32 m0, s42, 84992
    s_add_u32 s7, s39, 2560
    buffer_load_dwordx4 v7, s[12:15], s7 offen lds
    ds_read_b64_tr_b16 a[164:165], v1 offset:15424
    ds_read_b64_tr_b16 a[166:167], v1 offset:17984
    v_mfma_f32_16x16x32_bf16 v[48:51], a[168:171], a[144:147], v[48:51]
    v_mfma_f32_16x16x32_bf16 v[68:71], a[168:171], a[148:151], v[68:71]
    s_waitcnt lgkmcnt(10)
    ds_read_b64_tr_b16 a[168:169], v1 offset:15456
    ds_read_b64_tr_b16 a[170:171], v1 offset:18016
    v_mfma_f32_16x16x32_bf16 v[52:55], a[172:175], a[144:147], v[52:55]
    v_mfma_f32_16x16x32_bf16 v[72:75], a[172:175], a[148:151], v[72:75]
    s_add_u32 m0, s42, 86016
    s_add_u32 s7, s39, 2560
    buffer_load_dwordx4 v8, s[12:15], s7 offen lds
    s_waitcnt vmcnt(15)
    s_mov_b32 s66, 0
Lng_1:
    v_readfirstlane_b32 s43, v89
    s_cmp_lg_u32 s43, 0
    s_cbranch_scc1 Lngd_2
    s_mov_b64 exec, 1
    buffer_load_dword v89, v88, s[20:23], 0 offen sc1
    s_mov_b64 exec, -1
    s_waitcnt vmcnt(0)
    s_add_u32 s66, s66, 1
    s_cmp_lt_u32 s66, 0x40000
    s_cbranch_scc1 Lng_1
Lngd_2:
    ds_read_b64_tr_b16 a[172:173], v1 offset:15488
    ds_read_b64_tr_b16 a[174:175], v1 offset:18048
    v_mfma_f32_16x16x32_bf16 v[56:59], a[176:179], a[144:147], v[56:59]
    v_mfma_f32_16x16x32_bf16 v[76:79], a[176:179], a[148:151], v[76:79]
    s_waitcnt lgkmcnt(10)
    s_cmp_lg_u32 s28, 1
    s_cbranch_scc1 Lzs_3
    s_mul_i32 s3, s29, 840
    s_and_b32 s3, s3, -16
    s_mul_i32 s4, s30, 13568
    s_add_u32 s3, s3, s4
    s_add_u32 s3, s3, 7340032
    v_mov_b32 v200, 0
    v_mov_b32 v201, 0
    v_mov_b32 v202, 0
    v_mov_b32 v203, 0
    v_lshlrev_b32 v204, 4, v0
    s_mov_b32 exec_hi, 0x3fffff
    buffer_store_dwordx4 v[200:203], v204, s[16:19], s3 offen sc1
    s_mov_b32 exec_hi, -1
Lzs_3:
    s_waitcnt vmcnt(10)
    s_barrier
    ds_read_b64_tr_b16 a[176:177], v1 offset:20480
    ds_read_b64_tr_b16 a[178:179], v1 offset:23040
    v_mfma_f32_16x16x32_bf16 v[60:63], a[180:183], a[144:147], v[60:63]
    v_mfma_f32_16x16x32_bf16 v[80:83], a[180:183], a[148:151], v[80:83]
    ds_read_b64_tr_b16 a[180:181], v1 offset:20512
    ds_read_b64_tr_b16 a[182:183], v1 offset:23072
    v_mfma_f32_16x16x32_bf16 v[64:67], a[184:187], a[144:147], v[64:67]
    v_mfma_f32_16x16x32_bf16 v[84:87], a[184:187], a[148:151], v[84:87]
    s_waitcnt lgkmcnt(10)
    ds_read_b64_tr_b16 a[184:185], v1 offset:20544
    ds_read_b64_tr_b16 a[186:187], v1 offset:23104
    v_mfma_f32_16x16x32_bf16 v[48:51], a[188:191], a[152:155], v[48:51]
    v_mfma_f32_16x16x32_bf16 v[68:71], a[188:191], a[156:159], v[68:71]
    ds_read_b64_tr_b16 a[188:189], v1 offset:20576
    ds_read_b64_tr_b16 a[190:191], v1 offset:23136
    v_mfma_f32_16x16x32_bf16 v[52:55], a[160:163], a[152:155], v[52:55]
    v_mfma_f32_16x16x32_bf16 v[72:75], a[160:163], a[156:159], v[72:75]
    s_waitcnt lgkmcnt(10)
    ds_read_b64_tr_b16 a[160:161], v1 offset:20608
    ds_read_b64_tr_b16 a[162:163], v1 offset:23168
    v_mfma_f32_16x16x32_bf16 v[56:59], a[164:167], a[152:155], v[56:59]
    v_mfma_f32_16x16x32_bf16 v[76:79], a[164:167], a[156:159], v[76:79]
    ds_read_b64_tr_b16 a[164:165], v1 offset:25600
    ds_read_b64_tr_b16 a[166:167], v1 offset:28160
    v_mfma_f32_16x16x32_bf16 v[60:63], a[168:171], a[152:155], v[60:63]
    v_mfma_f32_16x16x32_bf16 v[80:83], a[168:171], a[156:159], v[80:83]
    s_waitcnt lgkmcnt(10)
    ds_read_b64_tr_b16 a[168:169], v1 offset:25632
    ds_read_b64_tr_b16 a[170:171], v1 offset:28192
    v_mfma_f32_16x16x32_bf16 v[64:67], a[172:175], a[152:155], v[64:67]
    v_mfma_f32_16x16x32_bf16 v[84:87], a[172:175], a[156:159], v[84:87]
    v_cvt_pk_bf16_f32 v88, v48, v49
    v_cvt_pk_bf16_f32 v100, v68, v69
    v_cvt_pk_bf16_f32 v89, v50, v51
    v_cvt_pk_bf16_f32 v101, v70, v71
    v_cvt_pk_bf16_f32 v90, v52, v53
    v_cvt_pk_bf16_f32 v102, v72, v73
    v_cvt_pk_bf16_f32 v91, v54, v55
    v_cvt_pk_bf16_f32 v103, v74, v75
    v_cvt_pk_bf16_f32 v92, v56, v57
    v_cvt_pk_bf16_f32 v104, v76, v77
    v_cvt_pk_bf16_f32 v93, v58, v59
    v_cvt_pk_bf16_f32 v105, v78, v79
    v_cvt_pk_bf16_f32 v94, v60, v61
    v_cvt_pk_bf16_f32 v106, v80, v81
    v_cvt_pk_bf16_f32 v95, v62, v63
    v_cvt_pk_bf16_f32 v107, v82, v83
    v_cvt_pk_bf16_f32 v96, v64, v65
    v_cvt_pk_bf16_f32 v108, v84, v85
    v_cvt_pk_bf16_f32 v97, v66, v67
    v_cvt_pk_bf16_f32 v109, v86, v87
    v_mfma_f32_16x16x32_bf16 v[140:143], v[112:115], v[88:91], 0
    v_mfma_f32_16x16x32_bf16 v[144:147], v[116:119], v[90:93], 0
    v_mfma_f32_16x16x32_bf16 v[148:151], v[120:123], v[92:95], 0
    v_mfma_f32_16x16x32_bf16 v[152:155], v[124:127], v[94:97], 0
    v_mfma_f32_16x16x32_bf16 v[160:163], v[112:115], v[100:103], 0
    v_mfma_f32_16x16x32_bf16 v[164:167], v[116:119], v[102:105], 0
    v_mfma_f32_16x16x32_bf16 v[168:171], v[120:123], v[104:107], 0
    v_mfma_f32_16x16x32_bf16 v[172:175], v[124:127], v[106:109], 0
    v_mfma_f32_16x16x32_bf16 v[156:159], v[128:131], v[88:91], 0
    v_mfma_f32_16x16x32_bf16 v[176:179], v[128:131], v[100:103], 0
    v_mfma_f32_16x16x32_bf16 v[156:159], v[132:135], v[92:95], v[156:159]
    v_mfma_f32_16x16x32_bf16 v[176:179], v[132:135], v[104:107], v[176:179]
    v_mfma_f32_16x16x32_bf16 v[156:159], v[136:139], v[96:99], v[156:159]
    v_mfma_f32_16x16x32_bf16 v[176:179], v[136:139], v[108:111], v[176:179]
    v_max3_f32 v16, v140, v141, v142
    v_max3_f32 v32, v160, v161, v162
    v_min3_f32 v21, v140, v141, v142
    v_min3_f32 v37, v160, v161, v162
    v_max3_f32 v17, v144, v145, v146
    v_max3_f32 v33, v164, v165, v166
    v_min3_f32 v22, v144, v145, v146
    v_min3_f32 v38, v164, v165, v166
    v_max3_f32 v18, v148, v149, v150
    v_max3_f32 v34, v168, v169, v170
    s_add_u32 m0, s42, 102400
    s_add_u32 s7, s40, 2560
    buffer_load_dwordx4 v4, s[12:15], s7 offen lds
    v_min3_f32 v23, v148, v149, v150
    v_min3_f32 v39, v168, v169, v170
    v_max3_f32 v19, v152, v153, v154
    v_max3_f32 v35, v172, v173, v174
    v_min3_f32 v24, v152, v153, v154
    v_min3_f32 v40, v172, v173, v174
    v_max3_f32 v20, v156, v157, v158
    v_max3_f32 v36, v176, v177, v178
    v_min3_f32 v25, v156, v157, v158
    v_min3_f32 v41, v176, v177, v178
    v_max_f32 v16, v16, v143
    v_max_f32 v32, v32, v163
    v_min_f32 v21, v21, v143
    v_min_f32 v37, v37, v163
    v_max_f32 v17, v17, v147
    v_max_f32 v33, v33, v167
    v_min_f32 v22, v22, v147
    v_min_f32 v38, v38, v167
    v_max_f32 v18, v18, v151
    v_max_f32 v34, v34, v171
    v_min_f32 v23, v23, v151
    v_min_f32 v39, v39, v171
    v_max_f32 v19, v19, v155
    v_max_f32 v35, v35, v175
    v_min_f32 v24, v24, v155
    v_min_f32 v40, v40, v175
    v_max_f32 v20, v20, v159
    v_max_f32 v36, v36, v179
    v_min_f32 v25, v25, v159
    v_min_f32 v41, v41, v179
    v_permlane32_swap_b32 v16, v18
    v_permlane32_swap_b32 v32, v34
    v_permlane32_swap_b32 v17, v19
    v_permlane32_swap_b32 v33, v35
    v_permlane32_swap_b32 v21, v23
    s_add_u32 m0, s42, 103424
    s_add_u32 s7, s40, 2560
    buffer_load_dwordx4 v5, s[12:15], s7 offen lds
    v_permlane32_swap_b32 v37, v39
    v_permlane32_swap_b32 v22, v24
    v_permlane32_swap_b32 v38, v40
    v_max_f32 v16, v16, v18
    v_max_f32 v32, v32, v34
    v_max_f32 v17, v17, v19
    v_max_f32 v33, v33, v35
    v_min_f32 v21, v21, v23
    v_min_f32 v37, v37, v39
    v_min_f32 v22, v22, v24
    v_min_f32 v38, v38, v40
    v_permlane16_swap_b32 v16, v17
    v_permlane16_swap_b32 v32, v33
    v_permlane16_swap_b32 v21, v22
    v_permlane16_swap_b32 v37, v38
    v_max_f32 v26, v16, v17
    v_max_f32 v42, v32, v33
    v_min_f32 v27, v21, v22
    v_min_f32 v43, v37, v38
    v_max_f32 v26, v26, v20
    v_max_f32 v42, v42, v36
    v_min_f32 v27, v27, v25
    v_min_f32 v43, v43, v41
    v_mul_f32 v26, s48, v26
    v_mul_f32 v42, s48, v42
    v_mul_f32 v27, s48, v27
    v_mul_f32 v43, s48, v43
    v_mov_b32 v28, v26
    v_mov_b32 v44, v42
    v_mov_b32 v29, v26
    v_mov_b32 v45, v42
    v_mov_b32 v88, v27
    v_mov_b32 v100, v43
    v_mov_b32 v89, v27
    v_mov_b32 v101, v43
    s_add_u32 m0, s42, 104448
    s_add_u32 s7, s40, 2560
    buffer_load_dwordx4 v6, s[12:15], s7 offen lds
    v_permlane16_swap_b32 v28, v29
    v_permlane16_swap_b32 v44, v45
    v_permlane16_swap_b32 v88, v89
    v_permlane16_swap_b32 v100, v101
    v_mov_b32 v30, v28
    v_mov_b32 v46, v44
    v_mov_b32 v31, v29
    v_mov_b32 v47, v45
    v_mov_b32 v90, v88
    v_mov_b32 v102, v100
    v_mov_b32 v91, v89
    v_mov_b32 v103, v101
    v_permlane32_swap_b32 v28, v30
    v_permlane32_swap_b32 v44, v46
    v_permlane32_swap_b32 v29, v31
    v_permlane32_swap_b32 v45, v47
    v_permlane32_swap_b32 v88, v90
    v_permlane32_swap_b32 v100, v102
    v_permlane32_swap_b32 v89, v91
    v_permlane32_swap_b32 v101, v103
    v_pk_fma_f32 v[196:197], v[156:157], s[48:49], v[26:27] op_sel:[0,0,0] op_sel_hi:[1,1,0] neg_lo:[0,0,1] neg_hi:[0,0,1]
    v_pk_fma_f32 v[216:217], v[176:177], s[48:49], v[42:43] op_sel:[0,0,0] op_sel_hi:[1,1,0] neg_lo:[0,0,1] neg_hi:[0,0,1]
    v_pk_fma_f32 v[156:157], v[156:157], s[48:49], v[26:27] op_sel:[0,0,1] op_sel_hi:[1,1,1] neg_lo:[1,0,0] neg_hi:[1,0,0]
    v_pk_fma_f32 v[176:177], v[176:177], s[48:49], v[42:43] op_sel:[0,0,1] op_sel_hi:[1,1,1] neg_lo:[1,0,0] neg_hi:[1,0,0]
    v_pk_fma_f32 v[198:199], v[158:159], s[48:49], v[26:27] op_sel:[0,0,0] op_sel_hi:[1,1,0] neg_lo:[0,0,1] neg_hi:[0,0,1]
    v_pk_fma_f32 v[218:219], v[178:179], s[48:49], v[42:43] op_sel:[0,0,0] op_sel_hi:[1,1,0] neg_lo:[0,0,1] neg_hi:[0,0,1]
    v_pk_fma_f32 v[158:159], v[158:159], s[48:49], v[26:27] op_sel:[0,0,1] op_sel_hi:[1,1,1] neg_lo:[1,0,0] neg_hi:[1,0,0]
    v_pk_fma_f32 v[178:179], v[178:179], s[48:49], v[42:43] op_sel:[0,0,1] op_sel_hi:[1,1,1] neg_lo:[1,0,0] neg_hi:[1,0,0]
    v_pk_fma_f32 v[180:181], v[140:141], s[48:49], v[28:29] op_sel:[0,0,0] op_sel_hi:[1,1,0] neg_lo:[0,0,1] neg_hi:[0,0,1]
    v_pk_fma_f32 v[200:201], v[160:161], s[48:49], v[44:45] op_sel:[0,0,0] op_sel_hi:[1,1,0] neg_lo:[0,0,1] neg_hi:[0,0,1]
    v_pk_fma_f32 v[140:141], v[140:141], s[48:49], v[88:89] op_sel:[0,0,0] op_sel_hi:[1,1,0] neg_lo:[1,0,0] neg_hi:[1,0,0]
    v_pk_fma_f32 v[160:161], v[160:161], s[48:49], v[100:101] op_sel:[0,0,0] op_sel_hi:[1,1,0] neg_lo:[1,0,0] neg_hi:[1,0,0]
    v_pk_fma_f32 v[182:183], v[142:143], s[48:49], v[28:29] op_sel:[0,0,0] op_sel_hi:[1,1,0] neg_lo:[0,0,1] neg_hi:[0,0,1]
    v_pk_fma_f32 v[202:203], v[162:163], s[48:49], v[44:45] op_sel:[0,0,0] op_sel_hi:[1,1,0] neg_lo:[0,0,1] neg_hi:[0,0,1]
    v_pk_fma_f32 v[142:143], v[142:143], s[48:49], v[88:89] op_sel:[0,0,0] op_sel_hi:[1,1,0] neg_lo:[1,0,0] neg_hi:[1,0,0]
    s_add_u32 m0, s42, 105472
    s_add_u32 s7, s40, 2560
    buffer_load_dwordx4 v7, s[12:15], s7 offen lds
    v_pk_fma_f32 v[162:163], v[162:163], s[48:49], v[100:101] op_sel:[0,0,0] op_sel_hi:[1,1,0] neg_lo:[1,0,0] neg_hi:[1,0,0]
    v_pk_fma_f32 v[184:185], v[144:145], s[48:49], v[28:29] op_sel:[0,0,1] op_sel_hi:[1,1,1] neg_lo:[0,0,1] neg_hi:[0,0,1]
    v_pk_fma_f32 v[204:205], v[164:165], s[48:49], v[44:45] op_sel:[0,0,1] op_sel_hi:[1,1,1] neg_lo:[0,0,1] neg_hi:[0,0,1]
    v_pk_fma_f32 v[144:145], v[144:145], s[48:49], v[88:89] op_sel:[0,0,1] op_sel_hi:[1,1,1] neg_lo:[1,0,0] neg_hi:[1,0,0]
    v_pk_fma_f32 v[164:165], v[164:165], s[48:49], v[100:101] op_sel:[0,0,1] op_sel_hi:[1,1,1] neg_lo:[1,0,0] neg_hi:[1,0,0]
    v_pk_fma_f32 v[186:187], v[146:147], s[48:49], v[28:29] op_sel:[0,0,1] op_sel_hi:[1,1,1] neg_lo:[0,0,1] neg_hi:[0,0,1]
    v_pk_fma_f32 v[206:207], v[166:167], s[48:49], v[44:45] op_sel:[0,0,1] op_sel_hi:[1,1,1] neg_lo:[0,0,1] neg_hi:[0,0,1]
    v_pk_fma_f32 v[146:147], v[146:147], s[48:49], v[88:89] op_sel:[0,0,1] op_sel_hi:[1,1,1] neg_lo:[1,0,0] neg_hi:[1,0,0]
    v_pk_fma_f32 v[166:167], v[166:167], s[48:49], v[100:101] op_sel:[0,0,1] op_sel_hi:[1,1,1] neg_lo:[1,0,0] neg_hi:[1,0,0]
    v_pk_fma_f32 v[188:189], v[148:149], s[48:49], v[30:31] op_sel:[0,0,0] op_sel_hi:[1,1,0] neg_lo:[0,0,1] neg_hi:[0,0,1]
    v_pk_fma_f32 v[208:209], v[168:169], s[48:49], v[46:47] op_sel:[0,0,0] op_sel_hi:[1,1,0] neg_lo:[0,0,1] neg_hi:[0,0,1]
    v_pk_fma_f32 v[148:149], v[148:149], s[48:49], v[90:91] op_sel:[0,0,0] op_sel_hi:[1,1,0] neg_lo:[1,0,0] neg_hi:[1,0,0]
    v_pk_fma_f32 v[168:169], v[168:169], s[48:49], v[102:103] op_sel:[0,0,0] op_sel_hi:[1,1,0] neg_lo:[1,0,0] neg_hi:[1,0,0]
    v_pk_fma_f32 v[190:191], v[150:151], s[48:49], v[30:31] op_sel:[0,0,0] op_sel_hi:[1,1,0] neg_lo:[0,0,1] neg_hi:[0,0,1]
    v_pk_fma_f32 v[210:211], v[170:171], s[48:49], v[46:47] op_sel:[0,0,0] op_sel_hi:[1,1,0] neg_lo:[0,0,1] neg_hi:[0,0,1]
    v_pk_fma_f32 v[150:151], v[150:151], s[48:49], v[90:91] op_sel:[0,0,0] op_sel_hi:[1,1,0] neg_lo:[1,0,0] neg_hi:[1,0,0]
    v_pk_fma_f32 v[170:171], v[170:171], s[48:49], v[102:103] op_sel:[0,0,0] op_sel_hi:[1,1,0] neg_lo:[1,0,0] neg_hi:[1,0,0]
    v_pk_fma_f32 v[192:193], v[152:153], s[48:49], v[30:31] op_sel:[0,0,1] op_sel_hi:[1,1,1] neg_lo:[0,0,1] neg_hi:[0,0,1]
    v_pk_fma_f32 v[212:213], v[172:173], s[48:49], v[46:47] op_sel:[0,0,1] op_sel_hi:[1,1,1] neg_lo:[0,0,1] neg_hi:[0,0,1]
    v_pk_fma_f32 v[152:153], v[152:153], s[48:49], v[90:91] op_sel:[0,0,1] op_sel_hi:[1,1,1] neg_lo:[1,0,0] neg_hi:[1,0,0]
    v_pk_fma_f32 v[172:173], v[172:173], s[48:49], v[102:103] op_sel:[0,0,1] op_sel_hi:[1,1,1] neg_lo:[1,0,0] neg_hi:[1,0,0]
    v_pk_fma_f32 v[194:195], v[154:155], s[48:49], v[30:31] op_sel:[0,0,1] op_sel_hi:[1,1,1] neg_lo:[0,0,1] neg_hi:[0,0,1]
    v_pk_fma_f32 v[214:215], v[174:175], s[48:49], v[46:47] op_sel:[0,0,1] op_sel_hi:[1,1,1] neg_lo:[0,0,1] neg_hi:[0,0,1]
    v_pk_fma_f32 v[154:155], v[154:155], s[48:49], v[90:91] op_sel:[0,0,1] op_sel_hi:[1,1,1] neg_lo:[1,0,0] neg_hi:[1,0,0]
    v_pk_fma_f32 v[174:175], v[174:175], s[48:49], v[102:103] op_sel:[0,0,1] op_sel_hi:[1,1,1] neg_lo:[1,0,0] neg_hi:[1,0,0]
    v_exp_f32 v180, v180
    v_exp_f32 v200, v200
    v_exp_f32 v140, v140
    v_exp_f32 v160, v160
    v_exp_f32 v181, v181
    v_exp_f32 v201, v201
    v_exp_f32 v141, v141
    v_exp_f32 v161, v161
    v_exp_f32 v182, v182
    v_exp_f32 v202, v202
    s_add_u32 m0, s42, 106496
    s_add_u32 s7, s40, 2560
    buffer_load_dwordx4 v8, s[12:15], s7 offen lds
    v_exp_f32 v142, v142
    v_exp_f32 v162, v162
    v_exp_f32 v183, v183
    v_exp_f32 v203, v203
    v_exp_f32 v143, v143
    v_exp_f32 v163, v163
    v_exp_f32 v184, v184
    v_exp_f32 v204, v204
    v_exp_f32 v144, v144
    v_exp_f32 v164, v164
    v_exp_f32 v185, v185
    v_exp_f32 v205, v205
    v_exp_f32 v145, v145
    v_exp_f32 v165, v165
    v_exp_f32 v186, v186
    v_exp_f32 v206, v206
    v_exp_f32 v146, v146
    v_exp_f32 v166, v166
    v_exp_f32 v187, v187
    v_exp_f32 v207, v207
    v_exp_f32 v147, v147
    v_exp_f32 v167, v167
    v_exp_f32 v188, v188
    v_exp_f32 v208, v208
    v_exp_f32 v148, v148
    v_exp_f32 v168, v168
    v_exp_f32 v189, v189
    v_exp_f32 v209, v209
    v_exp_f32 v149, v149
    v_exp_f32 v169, v169
    v_exp_f32 v190, v190
    v_exp_f32 v210, v210
    v_exp_f32 v150, v150
    v_exp_f32 v170, v170
    v_exp_f32 v191, v191
    s_add_u32 m0, s42, 122880
    s_add_u32 s7, s41, 2560
    buffer_load_dwordx4 v4, s[12:15], s7 offen lds
    v_exp_f32 v211, v211
    v_exp_f32 v151, v151
    v_exp_f32 v171, v171
    v_exp_f32 v192, v192
    v_exp_f32 v212, v212
    v_exp_f32 v152, v152
    v_exp_f32 v172, v172
    v_exp_f32 v193, v193
    v_exp_f32 v213, v213
    v_exp_f32 v153, v153
    v_exp_f32 v173, v173
    v_exp_f32 v194, v194
    v_exp_f32 v214, v214
    v_exp_f32 v154, v154
    v_exp_f32 v174, v174
    v_exp_f32 v195, v195
    v_exp_f32 v215, v215
    v_exp_f32 v155, v155
    v_exp_f32 v175, v175
    v_exp_f32 v196, v196
    v_exp_f32 v216, v216
    v_exp_f32 v156, v156
    v_exp_f32 v176, v176
    v_exp_f32 v197, v197
    v_exp_f32 v217, v217
    v_exp_f32 v157, v157
    v_exp_f32 v177, v177
    v_exp_f32 v198, v198
    v_exp_f32 v218, v218
    v_exp_f32 v158, v158
    v_exp_f32 v178, v178
    v_exp_f32 v199, v199
    v_exp_f32 v219, v219
    v_exp_f32 v159, v159
    v_exp_f32 v179, v179
    s_add_u32 m0, s42, 123904
    s_add_u32 s7, s41, 2560
    buffer_load_dwordx4 v5, s[12:15], s7 offen lds
    v_pk_add_f32 v[92:93], v[180:181], v[182:183]
    v_pk_add_f32 v[104:105], v[200:201], v[202:203]
    v_pk_add_f32 v[94:95], v[184:185], v[186:187]
    v_pk_add_f32 v[106:107], v[204:205], v[206:207]
    v_pk_add_f32 v[96:97], v[188:189], v[190:191]
    v_pk_add_f32 v[108:109], v[208:209], v[210:211]
    v_pk_add_f32 v[28:29], v[192:193], v[194:195]
    v_pk_add_f32 v[44:45], v[212:213], v[214:215]
    v_pk_add_f32 v[30:31], v[196:197], v[198:199]
    v_pk_add_f32 v[46:47], v[216:217], v[218:219]
    v_add_f32 v16, v92, v93
    v_add_f32 v32, v104, v105
    v_add_f32 v17, v94, v95
    v_add_f32 v33, v106, v107
    v_add_f32 v18, v96, v97
    v_add_f32 v34, v108, v109
    v_add_f32 v19, v28, v29
    v_add_f32 v35, v44, v45
    v_add_f32 v20, v30, v31
    v_add_f32 v36, v46, v47
    v_pk_add_f32 v[92:93], v[140:141], v[142:143]
    v_pk_add_f32 v[104:105], v[160:161], v[162:163]
    v_pk_add_f32 v[94:95], v[144:145], v[146:147]
    v_pk_add_f32 v[106:107], v[164:165], v[166:167]
    v_pk_add_f32 v[96:97], v[148:149], v[150:151]
    v_pk_add_f32 v[108:109], v[168:169], v[170:171]
    v_pk_add_f32 v[28:29], v[152:153], v[154:155]
    v_pk_add_f32 v[44:45], v[172:173], v[174:175]
    v_pk_add_f32 v[30:31], v[156:157], v[158:159]
    v_pk_add_f32 v[46:47], v[176:177], v[178:179]
    v_add_f32 v21, v92, v93
    v_add_f32 v37, v104, v105
    v_add_f32 v22, v94, v95
    v_add_f32 v38, v106, v107
    v_add_f32 v23, v96, v97
    s_add_u32 m0, s42, 124928
    s_add_u32 s7, s41, 2560
    buffer_load_dwordx4 v6, s[12:15], s7 offen lds
    v_add_f32 v39, v108, v109
    v_add_f32 v24, v28, v29
    v_add_f32 v40, v44, v45
    v_add_f32 v25, v30, v31
    v_add_f32 v41, v46, v47
    v_permlane32_swap_b32 v16, v18
    v_permlane32_swap_b32 v32, v34
    v_permlane32_swap_b32 v17, v19
    v_permlane32_swap_b32 v33, v35
    v_permlane32_swap_b32 v21, v23
    v_permlane32_swap_b32 v37, v39
    v_permlane32_swap_b32 v22, v24
    v_permlane32_swap_b32 v38, v40
    v_add_f32 v16, v16, v18
    v_add_f32 v32, v32, v34
    v_add_f32 v17, v17, v19
    v_add_f32 v33, v33, v35
    v_add_f32 v21, v21, v23
    v_add_f32 v37, v37, v39
    v_add_f32 v22, v22, v24
    v_add_f32 v38, v38, v40
    v_permlane16_swap_b32 v16, v17
    v_permlane16_swap_b32 v32, v33
    v_permlane16_swap_b32 v21, v22
    v_permlane16_swap_b32 v37, v38
    v_add_f32 v26, v16, v17
    v_add_f32 v42, v32, v33
    v_add_f32 v27, v21, v22
    v_add_f32 v43, v37, v38
    v_add_f32 v26, v26, v20
    v_add_f32 v42, v42, v36
    v_add_f32 v27, v27, v25
    v_add_f32 v43, v43, v41
    v_rcp_f32 v26, v26
    v_rcp_f32 v42, v42
    s_add_u32 m0, s42, 125952
    s_add_u32 s7, s41, 2560
    buffer_load_dwordx4 v7, s[12:15], s7 offen lds
    v_rcp_f32 v27, v27
    v_rcp_f32 v43, v43
    v_mov_b32 v28, v26
    v_mov_b32 v44, v42
    v_mov_b32 v29, v26
    v_mov_b32 v45, v42
    v_mov_b32 v88, v27
    v_mov_b32 v100, v43
    v_mov_b32 v89, v27
    v_mov_b32 v101, v43
    v_permlane16_swap_b32 v28, v29
    v_permlane16_swap_b32 v44, v45
    v_permlane16_swap_b32 v88, v89
    v_permlane16_swap_b32 v100, v101
    v_mov_b32 v30, v28
    v_mov_b32 v46, v44
    v_mov_b32 v31, v29
    v_mov_b32 v47, v45
    v_mov_b32 v90, v88
    v_mov_b32 v102, v100
    v_mov_b32 v91, v89
    v_mov_b32 v103, v101
    v_permlane32_swap_b32 v28, v30
    v_permlane32_swap_b32 v44, v46
    v_permlane32_swap_b32 v29, v31
    v_permlane32_swap_b32 v45, v47
    v_permlane32_swap_b32 v88, v90
    v_permlane32_swap_b32 v100, v102
    v_permlane32_swap_b32 v89, v91
    v_permlane32_swap_b32 v101, v103
    v_pk_mul_f32 v[196:197], v[196:197], v[26:27] op_sel:[0,0] op_sel_hi:[1,0]
    v_pk_mul_f32 v[216:217], v[216:217], v[42:43] op_sel:[0,0] op_sel_hi:[1,0]
    v_pk_mul_f32 v[156:157], v[156:157], v[26:27] op_sel:[0,1] op_sel_hi:[1,1]
    v_pk_mul_f32 v[176:177], v[176:177], v[42:43] op_sel:[0,1] op_sel_hi:[1,1]
    v_pk_mul_f32 v[198:199], v[198:199], v[26:27] op_sel:[0,0] op_sel_hi:[1,0]
    s_add_u32 m0, s42, 126976
    s_add_u32 s7, s41, 2560
    buffer_load_dwordx4 v8, s[12:15], s7 offen lds
    v_pk_mul_f32 v[218:219], v[218:219], v[42:43] op_sel:[0,0] op_sel_hi:[1,0]
    v_pk_mul_f32 v[158:159], v[158:159], v[26:27] op_sel:[0,1] op_sel_hi:[1,1]
    v_pk_mul_f32 v[178:179], v[178:179], v[42:43] op_sel:[0,1] op_sel_hi:[1,1]
    v_pk_mul_f32 v[180:181], v[180:181], v[28:29] op_sel:[0,0] op_sel_hi:[1,0]
    v_pk_mul_f32 v[200:201], v[200:201], v[44:45] op_sel:[0,0] op_sel_hi:[1,0]
    v_pk_mul_f32 v[140:141], v[140:141], v[88:89] op_sel:[0,0] op_sel_hi:[1,0]
    v_pk_mul_f32 v[160:161], v[160:161], v[100:101] op_sel:[0,0] op_sel_hi:[1,0]
    v_pk_mul_f32 v[182:183], v[182:183], v[28:29] op_sel:[0,0] op_sel_hi:[1,0]
    v_pk_mul_f32 v[202:203], v[202:203], v[44:45] op_sel:[0,0] op_sel_hi:[1,0]
    v_pk_mul_f32 v[142:143], v[142:143], v[88:89] op_sel:[0,0] op_sel_hi:[1,0]
    v_pk_mul_f32 v[162:163], v[162:163], v[100:101] op_sel:[0,0] op_sel_hi:[1,0]
    v_pk_mul_f32 v[184:185], v[184:185], v[28:29] op_sel:[0,1] op_sel_hi:[1,1]
    v_pk_mul_f32 v[204:205], v[204:205], v[44:45] op_sel:[0,1] op_sel_hi:[1,1]
    v_pk_mul_f32 v[144:145], v[144:145], v[88:89] op_sel:[0,1] op_sel_hi:[1,1]
    v_pk_mul_f32 v[164:165], v[164:165], v[100:101] op_sel:[0,1] op_sel_hi:[1,1]
    v_pk_mul_f32 v[186:187], v[186:187], v[28:29] op_sel:[0,1] op_sel_hi:[1,1]
    v_pk_mul_f32 v[206:207], v[206:207], v[44:45] op_sel:[0,1] op_sel_hi:[1,1]
    v_pk_mul_f32 v[146:147], v[146:147], v[88:89] op_sel:[0,1] op_sel_hi:[1,1]
    v_pk_mul_f32 v[166:167], v[166:167], v[100:101] op_sel:[0,1] op_sel_hi:[1,1]
    v_pk_mul_f32 v[188:189], v[188:189], v[30:31] op_sel:[0,0] op_sel_hi:[1,0]
    v_pk_mul_f32 v[208:209], v[208:209], v[46:47] op_sel:[0,0] op_sel_hi:[1,0]
    v_pk_mul_f32 v[148:149], v[148:149], v[90:91] op_sel:[0,0] op_sel_hi:[1,0]
    v_pk_mul_f32 v[168:169], v[168:169], v[102:103] op_sel:[0,0] op_sel_hi:[1,0]
    v_pk_mul_f32 v[190:191], v[190:191], v[30:31] op_sel:[0,0] op_sel_hi:[1,0]
    v_pk_mul_f32 v[210:211], v[210:211], v[46:47] op_sel:[0,0] op_sel_hi:[1,0]
    v_pk_mul_f32 v[150:151], v[150:151], v[90:91] op_sel:[0,0] op_sel_hi:[1,0]
    v_pk_mul_f32 v[170:171], v[170:171], v[102:103] op_sel:[0,0] op_sel_hi:[1,0]
    v_pk_mul_f32 v[192:193], v[192:193], v[30:31] op_sel:[0,1] op_sel_hi:[1,1]
    v_pk_mul_f32 v[212:213], v[212:213], v[46:47] op_sel:[0,1] op_sel_hi:[1,1]
    v_pk_mul_f32 v[152:153], v[152:153], v[90:91] op_sel:[0,1] op_sel_hi:[1,1]
    v_pk_mul_f32 v[172:173], v[172:173], v[102:103] op_sel:[0,1] op_sel_hi:[1,1]
    v_pk_mul_f32 v[194:195], v[194:195], v[30:31] op_sel:[0,1] op_sel_hi:[1,1]
    v_pk_mul_f32 v[214:215], v[214:215], v[46:47] op_sel:[0,1] op_sel_hi:[1,1]
    v_pk_mul_f32 v[154:155], v[154:155], v[90:91] op_sel:[0,1] op_sel_hi:[1,1]
    v_pk_mul_f32 v[174:175], v[174:175], v[102:103] op_sel:[0,1] op_sel_hi:[1,1]
    v_add_u32 v13, 143360, v220
    v_add_u32 v14, 61440, v220
    v_add_u32 v15, 2560, v13
    v_add_u32 v16, 2560, v14
    v_cvt_pk_bf16_f32 v143, v142, v143
    v_cvt_pk_bf16_f32 v163, v162, v163
    v_cvt_pk_bf16_f32 v142, v140, v141
    v_cvt_pk_bf16_f32 v162, v160, v161
    v_cvt_pk_bf16_f32 v140, v180, v181
    v_cvt_pk_bf16_f32 v160, v200, v201
    v_cvt_pk_bf16_f32 v141, v182, v183
    v_cvt_pk_bf16_f32 v161, v202, v203
    ds_write2_b64 v13, v[140:141], v[142:143] offset0:0 offset1:4
    ds_write2_b64 v15, v[160:161], v[162:163] offset0:0 offset1:4
    v_cvt_pk_bf16_f32 v147, v146, v147
    v_cvt_pk_bf16_f32 v167, v166, v167
    v_cvt_pk_bf16_f32 v146, v144, v145
    v_cvt_pk_bf16_f32 v166, v164, v165
    v_cvt_pk_bf16_f32 v144, v184, v185
    v_cvt_pk_bf16_f32 v164, v204, v205
    v_cvt_pk_bf16_f32 v145, v186, v187
    v_cvt_pk_bf16_f32 v165, v206, v207
    ds_write2_b64 v13, v[144:145], v[146:147] offset0:10 offset1:14
    ds_write2_b64 v15, v[164:165], v[166:167] offset0:10 offset1:14
    v_cvt_pk_bf16_f32 v151, v150, v151
    v_cvt_pk_bf16_f32 v171, v170, v171
    v_cvt_pk_bf16_f32 v150, v148, v149
    v_cvt_pk_bf16_f32 v170, v168, v169
    v_cvt_pk_bf16_f32 v148, v188, v189
    v_cvt_pk_bf16_f32 v168, v208, v209
    v_cvt_pk_bf16_f32 v149, v190, v191
    v_cvt_pk_bf16_f32 v169, v210, v211
    ds_write2_b64 v14, v[148:149], v[150:151] offset0:0 offset1:4
    ds_write2_b64 v16, v[168:169], v[170:171] offset0:0 offset1:4
    v_cvt_pk_bf16_f32 v155, v154, v155
    v_cvt_pk_bf16_f32 v175, v174, v175
    v_cvt_pk_bf16_f32 v154, v152, v153
    v_cvt_pk_bf16_f32 v174, v172, v173
    v_cvt_pk_bf16_f32 v152, v192, v193
    v_cvt_pk_bf16_f32 v172, v212, v213
    v_cvt_pk_bf16_f32 v153, v194, v195
    v_cvt_pk_bf16_f32 v173, v214, v215
    ds_write2_b64 v14, v[152:153], v[154:155] offset0:10 offset1:14
    ds_write2_b64 v16, v[172:173], v[174:175] offset0:10 offset1:14
    v_cvt_pk_bf16_f32 v159, v158, v159
    v_cvt_pk_bf16_f32 v179, v178, v179
    v_cvt_pk_bf16_f32 v158, v156, v157
    v_cvt_pk_bf16_f32 v178, v176, v177
    v_cvt_pk_bf16_f32 v156, v196, v197
    v_cvt_pk_bf16_f32 v176, v216, v217
    v_cvt_pk_bf16_f32 v157, v198, v199
    v_cvt_pk_bf16_f32 v177, v218, v219
    ds_write_b128 v221, v[156:159] offset:0
    ds_write_b128 v221, v[176:179] offset:2560
    ds_read_b64_tr_b16 a[172:173], v1 offset:25664
    ds_read_b64_tr_b16 a[174:175], v1 offset:28224
    v_mfma_f32_16x16x32_bf16 v[48:51], a[176:179], a[0:3], 0
    v_mfma_f32_16x16x32_bf16 v[68:71], a[176:179], a[4:7], 0
    s_waitcnt lgkmcnt(15)
    ds_read_b64_tr_b16 a[176:177], v1 offset:25696
    ds_read_b64_tr_b16 a[178:179], v1 offset:28256
    v_mfma_f32_16x16x32_bf16 v[52:55], a[180:183], a[0:3], 0
    v_mfma_f32_16x16x32_bf16 v[72:75], a[180:183], a[4:7], 0
    ds_read_b64_tr_b16 a[180:181], v1 offset:25728
    ds_read_b64_tr_b16 a[182:183], v1 offset:28288
    v_mfma_f32_16x16x32_bf16 v[56:59], a[184:187], a[0:3], 0
    v_mfma_f32_16x16x32_bf16 v[76:79], a[184:187], a[4:7], 0
    ds_read_b64_tr_b16 a[184:185], v1 offset:30720
    ds_read_b64_tr_b16 a[186:187], v1 offset:33280
    v_mfma_f32_16x16x32_bf16 v[60:63], a[188:191], a[0:3], 0
    v_mfma_f32_16x16x32_bf16 v[80:83], a[188:191], a[4:7], 0
    ds_read_b64_tr_b16 a[188:189], v1 offset:30752
    ds_read_b64_tr_b16 a[190:191], v1 offset:33312
    v_mfma_f32_16x16x32_bf16 v[64:67], a[160:163], a[0:3], 0
    v_mfma_f32_16x16x32_bf16 v[84:87], a[160:163], a[4:7], 0
    s_waitcnt lgkmcnt(15)
    ds_read_b64_tr_b16 a[160:161], v1 offset:30784
    ds_read_b64_tr_b16 a[162:163], v1 offset:33344
    v_mfma_f32_16x16x32_bf16 v[48:51], a[164:167], a[8:11], v[48:51]
    v_mfma_f32_16x16x32_bf16 v[68:71], a[164:167], a[12:15], v[68:71]
    ds_read_b64_tr_b16 a[164:165], v1 offset:30816
    ds_read_b64_tr_b16 a[166:167], v1 offset:33376
    v_mfma_f32_16x16x32_bf16 v[52:55], a[168:171], a[8:11], v[52:55]
    v_mfma_f32_16x16x32_bf16 v[72:75], a[168:171], a[12:15], v[72:75]
    s_waitcnt lgkmcnt(10)
    ds_read_b64_tr_b16 a[168:169], v1 offset:30848
    ds_read_b64_tr_b16 a[170:171], v1 offset:33408
    v_mfma_f32_16x16x32_bf16 v[56:59], a[172:175], a[8:11], v[56:59]
    v_mfma_f32_16x16x32_bf16 v[76:79], a[172:175], a[12:15], v[76:79]
    ds_read_b64_tr_b16 a[172:173], v1 offset:35840
    ds_read_b64_tr_b16 a[174:175], v1 offset:38400
    v_mfma_f32_16x16x32_bf16 v[60:63], a[176:179], a[8:11], v[60:63]
    v_mfma_f32_16x16x32_bf16 v[80:83], a[176:179], a[12:15], v[80:83]
    s_waitcnt lgkmcnt(10)
    ds_read_b64_tr_b16 a[176:177], v1 offset:35872
    ds_read_b64_tr_b16 a[178:179], v1 offset:38432
    v_mfma_f32_16x16x32_bf16 v[64:67], a[180:183], a[8:11], v[64:67]
    v_mfma_f32_16x16x32_bf16 v[84:87], a[180:183], a[12:15], v[84:87]
    ds_read_b64_tr_b16 a[180:181], v1 offset:35904
    ds_read_b64_tr_b16 a[182:183], v1 offset:38464
    v_mfma_f32_16x16x32_bf16 v[48:51], a[184:187], a[16:19], v[48:51]
    v_mfma_f32_16x16x32_bf16 v[68:71], a[184:187], a[20:23], v[68:71]
    s_waitcnt lgkmcnt(10)
    ds_read_b64_tr_b16 a[184:185], v1 offset:35936
    ds_read_b64_tr_b16 a[186:187], v1 offset:38496
    v_mfma_f32_16x16x32_bf16 v[52:55], a[188:191], a[16:19], v[52:55]
    v_mfma_f32_16x16x32_bf16 v[72:75], a[188:191], a[20:23], v[72:75]
    ds_read_b64_tr_b16 a[188:189], v1 offset:35968
    ds_read_b64_tr_b16 a[190:191], v1 offset:38528
    v_mfma_f32_16x16x32_bf16 v[56:59], a[160:163], a[16:19], v[56:59]
    v_mfma_f32_16x16x32_bf16 v[76:79], a[160:163], a[20:23], v[76:79]
    s_waitcnt lgkmcnt(10)
    s_waitcnt vmcnt(10)
    s_barrier
    s_lshl_b32 s4, s30, 4
    s_add_u32 s4, s4, s29
    s_lshl_b32 s4, s4, 7
    s_add_u32 s4, s4, 9502720
    s_cmp_lg_u32 s28, 0
    s_cbranch_scc1 Lfl_4
    v_mov_b32 v13, 0
    v_mov_b32 v14, s43
    s_mov_b64 exec, 1
    buffer_store_dword v14, v13, s[16:19], s4 offen sc1
    s_mov_b64 exec, -1
Lfl_4:
    ds_read_b64_tr_b16 a[160:161], v1 offset:40960
    ds_read_b64_tr_b16 a[162:163], v1 offset:43520
    v_mfma_f32_16x16x32_bf16 v[60:63], a[164:167], a[16:19], v[60:63]
    v_mfma_f32_16x16x32_bf16 v[80:83], a[164:167], a[20:23], v[80:83]
    ds_read_b64_tr_b16 a[164:165], v1 offset:40992
    ds_read_b64_tr_b16 a[166:167], v1 offset:43552
    v_mfma_f32_16x16x32_bf16 v[64:67], a[168:171], a[16:19], v[64:67]
    v_mfma_f32_16x16x32_bf16 v[84:87], a[168:171], a[20:23], v[84:87]
    s_waitcnt lgkmcnt(10)
    s_add_u32 m0, s42, 0
    s_nop 0
    buffer_load_dwordx4 v4, s[12:15], s37 offen lds
    ds_read_b64_tr_b16 a[168:169], v1 offset:41024
    ds_read_b64_tr_b16 a[170:171], v1 offset:43584
    v_mfma_f32_16x16x32_bf16 v[48:51], a[172:175], a[24:27], v[48:51]
    v_mfma_f32_16x16x32_bf16 v[68:71], a[172:175], a[28:31], v[68:71]
    ds_read_b64_tr_b16 a[172:173], v1 offset:41056
    ds_read_b64_tr_b16 a[174:175], v1 offset:43616
    v_mfma_f32_16x16x32_bf16 v[52:55], a[176:179], a[24:27], v[52:55]
    v_mfma_f32_16x16x32_bf16 v[72:75], a[176:179], a[28:31], v[72:75]
    s_waitcnt lgkmcnt(10)
    ds_read_b64_tr_b16 a[176:177], v1 offset:41088
    ds_read_b64_tr_b16 a[178:179], v1 offset:43648
    v_mfma_f32_16x16x32_bf16 v[56:59], a[180:183], a[24:27], v[56:59]
    v_mfma_f32_16x16x32_bf16 v[76:79], a[180:183], a[28:31], v[76:79]
    s_add_u32 m0, s42, 1024
    s_nop 0
    buffer_load_dwordx4 v5, s[12:15], s37 offen lds
    ds_read_b64_tr_b16 a[180:181], v1 offset:46080
    ds_read_b64_tr_b16 a[182:183], v1 offset:48640
    v_mfma_f32_16x16x32_bf16 v[60:63], a[184:187], a[24:27], v[60:63]
    v_mfma_f32_16x16x32_bf16 v[80:83], a[184:187], a[28:31], v[80:83]
    s_waitcnt lgkmcnt(10)
    ds_read_b64_tr_b16 a[184:185], v1 offset:46112
    ds_read_b64_tr_b16 a[186:187], v1 offset:48672
    v_mfma_f32_16x16x32_bf16 v[64:67], a[188:191], a[24:27], v[64:67]
    v_mfma_f32_16x16x32_bf16 v[84:87], a[188:191], a[28:31], v[84:87]
    ds_read_b64_tr_b16 a[188:189], v1 offset:46144
    ds_read_b64_tr_b16 a[190:191], v1 offset:48704
    v_mfma_f32_16x16x32_bf16 v[48:51], a[160:163], a[32:35], v[48:51]
    v_mfma_f32_16x16x32_bf16 v[68:71], a[160:163], a[36:39], v[68:71]
    s_waitcnt lgkmcnt(10)
    ds_read_b64_tr_b16 a[160:161], v1 offset:46176
    ds_read_b64_tr_b16 a[162:163], v1 offset:48736
    v_mfma_f32_16x16x32_bf16 v[52:55], a[164:167], a[32:35], v[52:55]
    v_mfma_f32_16x16x32_bf16 v[72:75], a[164:167], a[36:39], v[72:75]
    s_add_u32 m0, s42, 2048
    s_nop 0
    buffer_load_dwordx4 v6, s[12:15], s37 offen lds
    ds_read_b64_tr_b16 a[164:165], v1 offset:46208
    ds_read_b64_tr_b16 a[166:167], v1 offset:48768
    v_mfma_f32_16x16x32_bf16 v[56:59], a[168:171], a[32:35], v[56:59]
    v_mfma_f32_16x16x32_bf16 v[76:79], a[168:171], a[36:39], v[76:79]
    s_waitcnt lgkmcnt(10)
    ds_read_b64_tr_b16 a[168:169], v1 offset:51200
    ds_read_b64_tr_b16 a[170:171], v1 offset:53760
    v_mfma_f32_16x16x32_bf16 v[60:63], a[172:175], a[32:35], v[60:63]
    v_mfma_f32_16x16x32_bf16 v[80:83], a[172:175], a[36:39], v[80:83]
    ds_read_b64_tr_b16 a[172:173], v1 offset:51232
    ds_read_b64_tr_b16 a[174:175], v1 offset:53792
    v_mfma_f32_16x16x32_bf16 v[64:67], a[176:179], a[32:35], v[64:67]
    v_mfma_f32_16x16x32_bf16 v[84:87], a[176:179], a[36:39], v[84:87]
    s_waitcnt lgkmcnt(10)
    s_add_u32 m0, s42, 3072
    s_nop 0
    buffer_load_dwordx4 v7, s[12:15], s37 offen lds
    ds_read_b64_tr_b16 a[176:177], v1 offset:51264
    ds_read_b64_tr_b16 a[178:179], v1 offset:53824
    v_mfma_f32_16x16x32_bf16 v[48:51], a[180:183], a[40:43], v[48:51]
    v_mfma_f32_16x16x32_bf16 v[68:71], a[180:183], a[44:47], v[68:71]
    ds_read_b64_tr_b16 a[180:181], v1 offset:51296
    ds_read_b64_tr_b16 a[182:183], v1 offset:53856
    v_mfma_f32_16x16x32_bf16 v[52:55], a[184:187], a[40:43], v[52:55]
    v_mfma_f32_16x16x32_bf16 v[72:75], a[184:187], a[44:47], v[72:75]
    s_waitcnt lgkmcnt(10)
    ds_read_b64_tr_b16 a[184:185], v1 offset:51328
    ds_read_b64_tr_b16 a[186:187], v1 offset:53888
    v_mfma_f32_16x16x32_bf16 v[56:59], a[188:191], a[40:43], v[56:59]
    v_mfma_f32_16x16x32_bf16 v[76:79], a[188:191], a[44:47], v[76:79]
    ds_read_b64_tr_b16 a[188:189], v1 offset:56320
    ds_read_b64_tr_b16 a[190:191], v1 offset:58880
    v_mfma_f32_16x16x32_bf16 v[60:63], a[160:163], a[40:43], v[60:63]
    v_mfma_f32_16x16x32_bf16 v[80:83], a[160:163], a[44:47], v[80:83]
    s_waitcnt lgkmcnt(10)
    s_add_u32 m0, s42, 4096
    s_nop 0
    buffer_load_dwordx4 v8, s[12:15], s37 offen lds
    ds_read_b64_tr_b16 a[160:161], v1 offset:56352
    ds_read_b64_tr_b16 a[162:163], v1 offset:58912
    v_mfma_f32_16x16x32_bf16 v[64:67], a[164:167], a[40:43], v[64:67]
    v_mfma_f32_16x16x32_bf16 v[84:87], a[164:167], a[44:47], v[84:87]
    ds_read_b64_tr_b16 a[164:165], v1 offset:56384
    ds_read_b64_tr_b16 a[166:167], v1 offset:58944
    v_mfma_f32_16x16x32_bf16 v[48:51], a[168:171], a[48:51], v[48:51]
    v_mfma_f32_16x16x32_bf16 v[68:71], a[168:171], a[52:55], v[68:71]
    s_waitcnt lgkmcnt(10)
    ds_read_b64_tr_b16 a[168:169], v1 offset:56416
    ds_read_b64_tr_b16 a[170:171], v1 offset:58976
    v_mfma_f32_16x16x32_bf16 v[52:55], a[172:175], a[48:51], v[52:55]
    v_mfma_f32_16x16x32_bf16 v[72:75], a[172:175], a[52:55], v[72:75]
    ds_read_b64_tr_b16 a[172:173], v1 offset:56448
    ds_read_b64_tr_b16 a[174:175], v1 offset:59008
    v_mfma_f32_16x16x32_bf16 v[56:59], a[176:179], a[48:51], v[56:59]
    v_mfma_f32_16x16x32_bf16 v[76:79], a[176:179], a[52:55], v[76:79]
    s_waitcnt lgkmcnt(10)
    s_waitcnt vmcnt(15)
    s_barrier
    ds_read_b64_tr_b16 a[176:177], v2 offset:20480
    ds_read_b64_tr_b16 a[178:179], v2 offset:23040
    v_mfma_f32_16x16x32_bf16 v[60:63], a[180:183], a[48:51], v[60:63]
    v_mfma_f32_16x16x32_bf16 v[80:83], a[180:183], a[52:55], v[80:83]
    ds_read_b64_tr_b16 a[180:181], v2 offset:20512
    ds_read_b64_tr_b16 a[182:183], v2 offset:23072
    v_mfma_f32_16x16x32_bf16 v[64:67], a[184:187], a[48:51], v[64:67]
    v_mfma_f32_16x16x32_bf16 v[84:87], a[184:187], a[52:55], v[84:87]
    s_waitcnt lgkmcnt(10)
    s_add_u32 m0, s42, 20480
    s_nop 0
    buffer_load_dwordx4 v4, s[12:15], s38 offen lds
    ds_read_b64_tr_b16 a[184:185], v2 offset:20544
    ds_read_b64_tr_b16 a[186:187], v2 offset:23104
    v_mfma_f32_16x16x32_bf16 v[48:51], a[188:191], a[56:59], v[48:51]
    v_mfma_f32_16x16x32_bf16 v[68:71], a[188:191], a[60:63], v[68:71]
    ds_read_b64_tr_b16 a[188:189], v2 offset:20576
    ds_read_b64_tr_b16 a[190:191], v2 offset:23136
    v_mfma_f32_16x16x32_bf16 v[52:55], a[160:163], a[56:59], v[52:55]
    v_mfma_f32_16x16x32_bf16 v[72:75], a[160:163], a[60:63], v[72:75]
    s_waitcnt lgkmcnt(10)
    ds_read_b64_tr_b16 a[160:161], v2 offset:20608
    ds_read_b64_tr_b16 a[162:163], v2 offset:23168
    v_mfma_f32_16x16x32_bf16 v[56:59], a[164:167], a[56:59], v[56:59]
    v_mfma_f32_16x16x32_bf16 v[76:79], a[164:167], a[60:63], v[76:79]
    s_add_u32 m0, s42, 21504
    s_nop 0
    buffer_load_dwordx4 v5, s[12:15], s38 offen lds
    ds_read_b64_tr_b16 a[164:165], v2 offset:25600
    ds_read_b64_tr_b16 a[166:167], v2 offset:28160
    v_mfma_f32_16x16x32_bf16 v[60:63], a[168:171], a[56:59], v[60:63]
    v_mfma_f32_16x16x32_bf16 v[80:83], a[168:171], a[60:63], v[80:83]
    s_waitcnt lgkmcnt(10)
    ds_read_b64_tr_b16 a[168:169], v2 offset:25632
    ds_read_b64_tr_b16 a[170:171], v2 offset:28192
    v_mfma_f32_16x16x32_bf16 v[64:67], a[172:175], a[56:59], v[64:67]
    v_mfma_f32_16x16x32_bf16 v[84:87], a[172:175], a[60:63], v[84:87]
    ds_read_b64_tr_b16 a[172:173], v2 offset:25664
    ds_read_b64_tr_b16 a[174:175], v2 offset:28224
    v_mfma_f32_16x16x32_bf16 v[48:51], a[176:179], a[64:67], v[48:51]
    v_mfma_f32_16x16x32_bf16 v[68:71], a[176:179], a[68:71], v[68:71]
    s_waitcnt lgkmcnt(10)
    ds_read_b64_tr_b16 a[176:177], v2 offset:25696
    ds_read_b64_tr_b16 a[178:179], v2 offset:28256
    v_mfma_f32_16x16x32_bf16 v[52:55], a[180:183], a[64:67], v[52:55]
    v_mfma_f32_16x16x32_bf16 v[72:75], a[180:183], a[68:71], v[72:75]
    s_add_u32 m0, s42, 22528
    s_nop 0
    buffer_load_dwordx4 v6, s[12:15], s38 offen lds
    ds_read_b64_tr_b16 a[180:181], v2 offset:25728
    ds_read_b64_tr_b16 a[182:183], v2 offset:28288
    v_mfma_f32_16x16x32_bf16 v[56:59], a[184:187], a[64:67], v[56:59]
    v_mfma_f32_16x16x32_bf16 v[76:79], a[184:187], a[68:71], v[76:79]
    s_waitcnt lgkmcnt(10)
    ds_read_b64_tr_b16 a[184:185], v2 offset:30720
    ds_read_b64_tr_b16 a[186:187], v2 offset:33280
    v_mfma_f32_16x16x32_bf16 v[60:63], a[188:191], a[64:67], v[60:63]
    v_mfma_f32_16x16x32_bf16 v[80:83], a[188:191], a[68:71], v[80:83]
    ds_read_b64_tr_b16 a[188:189], v2 offset:30752
    ds_read_b64_tr_b16 a[190:191], v2 offset:33312
    v_mfma_f32_16x16x32_bf16 v[64:67], a[160:163], a[64:67], v[64:67]
    v_mfma_f32_16x16x32_bf16 v[84:87], a[160:163], a[68:71], v[84:87]
    s_waitcnt lgkmcnt(10)
    s_add_u32 m0, s42, 23552
    s_nop 0
    buffer_load_dwordx4 v7, s[12:15], s38 offen lds
    ds_read_b64_tr_b16 a[160:161], v2 offset:30784
    ds_read_b64_tr_b16 a[162:163], v2 offset:33344
    v_mfma_f32_16x16x32_bf16 v[48:51], a[164:167], a[72:75], v[48:51]
    v_mfma_f32_16x16x32_bf16 v[68:71], a[164:167], a[76:79], v[68:71]
    ds_read_b64_tr_b16 a[164:165], v2 offset:30816
    ds_read_b64_tr_b16 a[166:167], v2 offset:33376
    v_mfma_f32_16x16x32_bf16 v[52:55], a[168:171], a[72:75], v[52:55]
    v_mfma_f32_16x16x32_bf16 v[72:75], a[168:171], a[76:79], v[72:75]
    s_waitcnt lgkmcnt(10)
    ds_read_b64_tr_b16 a[168:169], v2 offset:30848
    ds_read_b64_tr_b16 a[170:171], v2 offset:33408
    v_mfma_f32_16x16x32_bf16 v[56:59], a[172:175], a[72:75], v[56:59]
    v_mfma_f32_16x16x32_bf16 v[76:79], a[172:175], a[76:79], v[76:79]
    ds_read_b64_tr_b16 a[172:173], v2 offset:35840
    ds_read_b64_tr_b16 a[174:175], v2 offset:38400
    v_mfma_f32_16x16x32_bf16 v[60:63], a[176:179], a[72:75], v[60:63]
    v_mfma_f32_16x16x32_bf16 v[80:83], a[176:179], a[76:79], v[80:83]
    s_waitcnt lgkmcnt(10)
    s_add_u32 m0, s42, 24576
    s_nop 0
    buffer_load_dwordx4 v8, s[12:15], s38 offen lds
    ds_read_b64_tr_b16 a[176:177], v2 offset:35872
    ds_read_b64_tr_b16 a[178:179], v2 offset:38432
    v_mfma_f32_16x16x32_bf16 v[64:67], a[180:183], a[72:75], v[64:67]
    v_mfma_f32_16x16x32_bf16 v[84:87], a[180:183], a[76:79], v[84:87]
    ds_read_b64_tr_b16 a[180:181], v2 offset:35904
    ds_read_b64_tr_b16 a[182:183], v2 offset:38464
    v_mfma_f32_16x16x32_bf16 v[48:51], a[184:187], a[80:83], v[48:51]
    v_mfma_f32_16x16x32_bf16 v[68:71], a[184:187], a[84:87], v[68:71]
    s_waitcnt lgkmcnt(10)
    ds_read_b64_tr_b16 a[184:185], v2 offset:35936
    ds_read_b64_tr_b16 a[186:187], v2 offset:38496
    v_mfma_f32_16x16x32_bf16 v[52:55], a[188:191], a[80:83], v[52:55]
    v_mfma_f32_16x16x32_bf16 v[72:75], a[188:191], a[84:87], v[72:75]
    ds_read_b64_tr_b16 a[188:189], v2 offset:35968
    ds_read_b64_tr_b16 a[190:191], v2 offset:38528
    v_mfma_f32_16x16x32_bf16 v[56:59], a[160:163], a[80:83], v[56:59]
    v_mfma_f32_16x16x32_bf16 v[76:79], a[160:163], a[84:87], v[76:79]
    s_waitcnt lgkmcnt(10)
    s_waitcnt vmcnt(15)
    s_barrier
    ds_read_b64_tr_b16 a[160:161], v2 offset:40960
    ds_read_b64_tr_b16 a[162:163], v2 offset:43520
    v_mfma_f32_16x16x32_bf16 v[60:63], a[164:167], a[80:83], v[60:63]
    v_mfma_f32_16x16x32_bf16 v[80:83], a[164:167], a[84:87], v[80:83]
    ds_read_b64_tr_b16 a[164:165], v2 offset:40992
    ds_read_b64_tr_b16 a[166:167], v2 offset:43552
    v_mfma_f32_16x16x32_bf16 v[64:67], a[168:171], a[80:83], v[64:67]
    v_mfma_f32_16x16x32_bf16 v[84:87], a[168:171], a[84:87], v[84:87]
    s_waitcnt lgkmcnt(10)
    s_add_u32 m0, s42, 40960
    s_nop 0
    buffer_load_dwordx4 v4, s[12:15], s39 offen lds
    ds_read_b64_tr_b16 a[168:169], v2 offset:41024
    ds_read_b64_tr_b16 a[170:171], v2 offset:43584
    v_mfma_f32_16x16x32_bf16 v[48:51], a[172:175], a[88:91], v[48:51]
    v_mfma_f32_16x16x32_bf16 v[68:71], a[172:175], a[92:95], v[68:71]
    ds_read_b64_tr_b16 a[172:173], v2 offset:41056
    ds_read_b64_tr_b16 a[174:175], v2 offset:43616
    v_mfma_f32_16x16x32_bf16 v[52:55], a[176:179], a[88:91], v[52:55]
    v_mfma_f32_16x16x32_bf16 v[72:75], a[176:179], a[92:95], v[72:75]
    s_waitcnt lgkmcnt(10)
    ds_read_b64_tr_b16 a[176:177], v2 offset:41088
    ds_read_b64_tr_b16 a[178:179], v2 offset:43648
    v_mfma_f32_16x16x32_bf16 v[56:59], a[180:183], a[88:91], v[56:59]
    v_mfma_f32_16x16x32_bf16 v[76:79], a[180:183], a[92:95], v[76:79]
    s_add_u32 m0, s42, 41984
    s_nop 0
    buffer_load_dwordx4 v5, s[12:15], s39 offen lds
    ds_read_b64_tr_b16 a[180:181], v2 offset:46080
    ds_read_b64_tr_b16 a[182:183], v2 offset:48640
    v_mfma_f32_16x16x32_bf16 v[60:63], a[184:187], a[88:91], v[60:63]
    v_mfma_f32_16x16x32_bf16 v[80:83], a[184:187], a[92:95], v[80:83]
    s_waitcnt lgkmcnt(10)
    ds_read_b64_tr_b16 a[184:185], v2 offset:46112
    ds_read_b64_tr_b16 a[186:187], v2 offset:48672
    v_mfma_f32_16x16x32_bf16 v[64:67], a[188:191], a[88:91], v[64:67]
    v_mfma_f32_16x16x32_bf16 v[84:87], a[188:191], a[92:95], v[84:87]
    ds_read_b64_tr_b16 a[188:189], v2 offset:46144
    ds_read_b64_tr_b16 a[190:191], v2 offset:48704
    v_mfma_f32_16x16x32_bf16 v[48:51], a[160:163], a[96:99], v[48:51]
    v_mfma_f32_16x16x32_bf16 v[68:71], a[160:163], a[100:103], v[68:71]
    s_waitcnt lgkmcnt(10)
    ds_read_b64_tr_b16 a[160:161], v2 offset:46176
    ds_read_b64_tr_b16 a[162:163], v2 offset:48736
    v_mfma_f32_16x16x32_bf16 v[52:55], a[164:167], a[96:99], v[52:55]
    v_mfma_f32_16x16x32_bf16 v[72:75], a[164:167], a[100:103], v[72:75]
    s_add_u32 m0, s42, 43008
    s_nop 0
    buffer_load_dwordx4 v6, s[12:15], s39 offen lds
    ds_read_b64_tr_b16 a[164:165], v2 offset:46208
    ds_read_b64_tr_b16 a[166:167], v2 offset:48768
    v_mfma_f32_16x16x32_bf16 v[56:59], a[168:171], a[96:99], v[56:59]
    v_mfma_f32_16x16x32_bf16 v[76:79], a[168:171], a[100:103], v[76:79]
    s_waitcnt lgkmcnt(10)
    ds_read_b64_tr_b16 a[168:169], v2 offset:51200
    ds_read_b64_tr_b16 a[170:171], v2 offset:53760
    v_mfma_f32_16x16x32_bf16 v[60:63], a[172:175], a[96:99], v[60:63]
    v_mfma_f32_16x16x32_bf16 v[80:83], a[172:175], a[100:103], v[80:83]
    ds_read_b64_tr_b16 a[172:173], v2 offset:51232
    ds_read_b64_tr_b16 a[174:175], v2 offset:53792
    v_mfma_f32_16x16x32_bf16 v[64:67], a[176:179], a[96:99], v[64:67]
    v_mfma_f32_16x16x32_bf16 v[84:87], a[176:179], a[100:103], v[84:87]
    s_waitcnt lgkmcnt(10)
    s_add_u32 m0, s42, 44032
    s_nop 0
    buffer_load_dwordx4 v7, s[12:15], s39 offen lds
    ds_read_b64_tr_b16 a[176:177], v2 offset:51264
    ds_read_b64_tr_b16 a[178:179], v2 offset:53824
    v_mfma_f32_16x16x32_bf16 v[48:51], a[180:183], a[104:107], v[48:51]
    v_mfma_f32_16x16x32_bf16 v[68:71], a[180:183], a[108:111], v[68:71]
    ds_read_b64_tr_b16 a[180:181], v2 offset:51296
    ds_read_b64_tr_b16 a[182:183], v2 offset:53856
    v_mfma_f32_16x16x32_bf16 v[52:55], a[184:187], a[104:107], v[52:55]
    v_mfma_f32_16x16x32_bf16 v[72:75], a[184:187], a[108:111], v[72:75]
    s_waitcnt lgkmcnt(10)
    ds_read_b64_tr_b16 a[184:185], v2 offset:51328
    ds_read_b64_tr_b16 a[186:187], v2 offset:53888
    v_mfma_f32_16x16x32_bf16 v[56:59], a[188:191], a[104:107], v[56:59]
    v_mfma_f32_16x16x32_bf16 v[76:79], a[188:191], a[108:111], v[76:79]
    ds_read_b64_tr_b16 a[188:189], v2 offset:56320
    ds_read_b64_tr_b16 a[190:191], v2 offset:58880
    v_mfma_f32_16x16x32_bf16 v[60:63], a[160:163], a[104:107], v[60:63]
    v_mfma_f32_16x16x32_bf16 v[80:83], a[160:163], a[108:111], v[80:83]
    s_waitcnt lgkmcnt(10)
    s_add_u32 m0, s42, 45056
    s_nop 0
    buffer_load_dwordx4 v8, s[12:15], s39 offen lds
    ds_read_b64_tr_b16 a[160:161], v2 offset:56352
    ds_read_b64_tr_b16 a[162:163], v2 offset:58912
    v_mfma_f32_16x16x32_bf16 v[64:67], a[164:167], a[104:107], v[64:67]
    v_mfma_f32_16x16x32_bf16 v[84:87], a[164:167], a[108:111], v[84:87]
    ds_read_b64_tr_b16 a[164:165], v2 offset:56384
    ds_read_b64_tr_b16 a[166:167], v2 offset:58944
    v_mfma_f32_16x16x32_bf16 v[48:51], a[168:171], a[112:115], v[48:51]
    v_mfma_f32_16x16x32_bf16 v[68:71], a[168:171], a[116:119], v[68:71]
    s_waitcnt lgkmcnt(10)
    ds_read_b64_tr_b16 a[168:169], v2 offset:56416
    ds_read_b64_tr_b16 a[170:171], v2 offset:58976
    v_mfma_f32_16x16x32_bf16 v[52:55], a[172:175], a[112:115], v[52:55]
    v_mfma_f32_16x16x32_bf16 v[72:75], a[172:175], a[116:119], v[72:75]
    ds_read_b64_tr_b16 a[172:173], v2 offset:56448
    ds_read_b64_tr_b16 a[174:175], v2 offset:59008
    v_mfma_f32_16x16x32_bf16 v[56:59], a[176:179], a[112:115], v[56:59]
    v_mfma_f32_16x16x32_bf16 v[76:79], a[176:179], a[116:119], v[76:79]
    s_waitcnt lgkmcnt(10)
    s_waitcnt vmcnt(15)
    s_barrier
    ds_read_b64_tr_b16 a[176:177], v3 offset:0
    ds_read_b64_tr_b16 a[178:179], v3 offset:2560
    v_mfma_f32_16x16x32_bf16 v[60:63], a[180:183], a[112:115], v[60:63]
    v_mfma_f32_16x16x32_bf16 v[80:83], a[180:183], a[116:119], v[80:83]
    s_lshl_b32 s7, s30, 11
    s_add_u32 s7, s7, 9502720
    v_and_b32 v13, 15, v0
    v_lshlrev_b32 v13, 7, v13
    buffer_load_dword v9, v13, s[16:19], s7 offen sc1
    ds_read_b64_tr_b16 a[180:181], v3 offset:32
    ds_read_b64_tr_b16 a[182:183], v3 offset:2592
    v_mfma_f32_16x16x32_bf16 v[64:67], a[184:187], a[112:115], v[64:67]
    v_mfma_f32_16x16x32_bf16 v[84:87], a[184:187], a[116:119], v[84:87]
    s_waitcnt lgkmcnt(10)
    s_add_u32 m0, s42, 81920
    s_nop 0
    buffer_load_dwordx4 v4, s[12:15], s40 offen lds
    ds_read_b64_tr_b16 a[184:185], v3 offset:64
    ds_read_b64_tr_b16 a[186:187], v3 offset:2624
    v_mfma_f32_16x16x32_bf16 v[48:51], a[188:191], a[120:123], v[48:51]
    v_mfma_f32_16x16x32_bf16 v[68:71], a[188:191], a[124:127], v[68:71]
    ds_read_b64_tr_b16 a[188:189], v3 offset:96
    ds_read_b64_tr_b16 a[190:191], v3 offset:2656
    v_mfma_f32_16x16x32_bf16 v[52:55], a[160:163], a[120:123], v[52:55]
    v_mfma_f32_16x16x32_bf16 v[72:75], a[160:163], a[124:127], v[72:75]
    s_waitcnt lgkmcnt(10)
    ds_read_b64_tr_b16 a[160:161], v3 offset:128
    ds_read_b64_tr_b16 a[162:163], v3 offset:2688
    v_mfma_f32_16x16x32_bf16 v[56:59], a[164:167], a[120:123], v[56:59]
    v_mfma_f32_16x16x32_bf16 v[76:79], a[164:167], a[124:127], v[76:79]
    s_add_u32 m0, s42, 82944
    s_nop 0
    buffer_load_dwordx4 v5, s[12:15], s40 offen lds
    ds_read_b64_tr_b16 a[164:165], v3 offset:5120
    ds_read_b64_tr_b16 a[166:167], v3 offset:7680
    v_mfma_f32_16x16x32_bf16 v[60:63], a[168:171], a[120:123], v[60:63]
    v_mfma_f32_16x16x32_bf16 v[80:83], a[168:171], a[124:127], v[80:83]
    s_waitcnt lgkmcnt(10)
    ds_read_b64_tr_b16 a[168:169], v3 offset:5152
    ds_read_b64_tr_b16 a[170:171], v3 offset:7712
    v_mfma_f32_16x16x32_bf16 v[64:67], a[172:175], a[120:123], v[64:67]
    v_mfma_f32_16x16x32_bf16 v[84:87], a[172:175], a[124:127], v[84:87]
    ds_read_b64_tr_b16 a[172:173], v3 offset:5184
    ds_read_b64_tr_b16 a[174:175], v3 offset:7744
    v_mfma_f32_16x16x32_bf16 v[48:51], a[176:179], a[128:131], v[48:51]
    v_mfma_f32_16x16x32_bf16 v[68:71], a[176:179], a[132:135], v[68:71]
    s_waitcnt lgkmcnt(10)
    ds_read_b64_tr_b16 a[176:177], v3 offset:5216
    ds_read_b64_tr_b16 a[178:179], v3 offset:7776
    v_mfma_f32_16x16x32_bf16 v[52:55], a[180:183], a[128:131], v[52:55]
    v_mfma_f32_16x16x32_bf16 v[72:75], a[180:183], a[132:135], v[72:75]
    s_add_u32 m0, s42, 83968
    s_nop 0
    buffer_load_dwordx4 v6, s[12:15], s40 offen lds
    ds_read_b64_tr_b16 a[180:181], v3 offset:5248
    ds_read_b64_tr_b16 a[182:183], v3 offset:7808
    v_mfma_f32_16x16x32_bf16 v[56:59], a[184:187], a[128:131], v[56:59]
    v_mfma_f32_16x16x32_bf16 v[76:79], a[184:187], a[132:135], v[76:79]
    s_waitcnt lgkmcnt(10)
    ds_read_b64_tr_b16 a[184:185], v3 offset:10240
    ds_read_b64_tr_b16 a[186:187], v3 offset:12800
    v_mfma_f32_16x16x32_bf16 v[60:63], a[188:191], a[128:131], v[60:63]
    v_mfma_f32_16x16x32_bf16 v[80:83], a[188:191], a[132:135], v[80:83]
    ds_read_b64_tr_b16 a[188:189], v3 offset:10272
    ds_read_b64_tr_b16 a[190:191], v3 offset:12832
    v_mfma_f32_16x16x32_bf16 v[64:67], a[160:163], a[128:131], v[64:67]
    v_mfma_f32_16x16x32_bf16 v[84:87], a[160:163], a[132:135], v[84:87]
    s_waitcnt lgkmcnt(10)
    s_add_u32 m0, s42, 84992
    s_nop 0
    buffer_load_dwordx4 v7, s[12:15], s40 offen lds
    ds_read_b64_tr_b16 a[160:161], v3 offset:10304
    ds_read_b64_tr_b16 a[162:163], v3 offset:12864
    v_mfma_f32_16x16x32_bf16 v[48:51], a[164:167], a[136:139], v[48:51]
    v_mfma_f32_16x16x32_bf16 v[68:71], a[164:167], a[140:143], v[68:71]
    ds_read_b64_tr_b16 a[164:165], v3 offset:10336
    ds_read_b64_tr_b16 a[166:167], v3 offset:12896
    v_mfma_f32_16x16x32_bf16 v[52:55], a[168:171], a[136:139], v[52:55]
    v_mfma_f32_16x16x32_bf16 v[72:75], a[168:171], a[140:143], v[72:75]
    s_waitcnt lgkmcnt(10)
    ds_read_b64_tr_b16 a[168:169], v3 offset:10368
    ds_read_b64_tr_b16 a[170:171], v3 offset:12928
    v_mfma_f32_16x16x32_bf16 v[56:59], a[172:175], a[136:139], v[56:59]
    v_mfma_f32_16x16x32_bf16 v[76:79], a[172:175], a[140:143], v[76:79]
    ds_read_b64_tr_b16 a[172:173], v3 offset:15360
    ds_read_b64_tr_b16 a[174:175], v3 offset:17920
    v_mfma_f32_16x16x32_bf16 v[60:63], a[176:179], a[136:139], v[60:63]
    v_mfma_f32_16x16x32_bf16 v[80:83], a[176:179], a[140:143], v[80:83]
    s_waitcnt lgkmcnt(10)
    s_add_u32 m0, s42, 86016
    s_nop 0
    buffer_load_dwordx4 v8, s[12:15], s40 offen lds
    ds_read_b64_tr_b16 a[176:177], v3 offset:15392
    ds_read_b64_tr_b16 a[178:179], v3 offset:17952
    v_mfma_f32_16x16x32_bf16 v[64:67], a[180:183], a[136:139], v[64:67]
    v_mfma_f32_16x16x32_bf16 v[84:87], a[180:183], a[140:143], v[84:87]
    ds_read_b64_tr_b16 a[180:181], v3 offset:15424
    ds_read_b64_tr_b16 a[182:183], v3 offset:17984
    v_mfma_f32_16x16x32_bf16 v[48:51], a[184:187], a[144:147], v[48:51]
    v_mfma_f32_16x16x32_bf16 v[68:71], a[184:187], a[148:151], v[68:71]
    s_waitcnt lgkmcnt(10)
    ds_read_b64_tr_b16 a[184:185], v3 offset:15456
    ds_read_b64_tr_b16 a[186:187], v3 offset:18016
    v_mfma_f32_16x16x32_bf16 v[52:55], a[188:191], a[144:147], v[52:55]
    v_mfma_f32_16x16x32_bf16 v[72:75], a[188:191], a[148:151], v[72:75]
    ds_read_b64_tr_b16 a[188:189], v3 offset:15488
    ds_read_b64_tr_b16 a[190:191], v3 offset:18048
    v_mfma_f32_16x16x32_bf16 v[56:59], a[160:163], a[144:147], v[56:59]
    v_mfma_f32_16x16x32_bf16 v[76:79], a[160:163], a[148:151], v[76:79]
    s_waitcnt lgkmcnt(10)
    s_waitcnt vmcnt(16)
    s_barrier
    ds_read_b64_tr_b16 a[160:161], v1 offset:0
    ds_read_b64_tr_b16 a[162:163], v1 offset:2560
    v_mfma_f32_16x16x32_bf16 v[60:63], a[164:167], a[144:147], v[60:63]
    v_mfma_f32_16x16x32_bf16 v[80:83], a[164:167], a[148:151], v[80:83]
    ds_read_b64_tr_b16 a[164:165], v1 offset:32
    ds_read_b64_tr_b16 a[166:167], v1 offset:2592
    v_mfma_f32_16x16x32_bf16 v[64:67], a[168:171], a[144:147], v[64:67]
    v_mfma_f32_16x16x32_bf16 v[84:87], a[168:171], a[148:151], v[84:87]
    s_waitcnt lgkmcnt(10)
    ds_read_b64_tr_b16 a[168:169], v1 offset:64
    ds_read_b64_tr_b16 a[170:171], v1 offset:2624
    v_mfma_f32_16x16x32_bf16 v[48:51], a[172:175], a[152:155], v[48:51]
    v_mfma_f32_16x16x32_bf16 v[68:71], a[172:175], a[156:159], v[68:71]
    ds_read_b64_tr_b16 a[172:173], v1 offset:96
    ds_read_b64_tr_b16 a[174:175], v1 offset:2656
    v_mfma_f32_16x16x32_bf16 v[52:55], a[176:179], a[152:155], v[52:55]
    v_mfma_f32_16x16x32_bf16 v[72:75], a[176:179], a[156:159], v[72:75]
    s_waitcnt lgkmcnt(10)
    ds_read_b64_tr_b16 a[176:177], v1 offset:128
    ds_read_b64_tr_b16 a[178:179], v1 offset:2688
    v_mfma_f32_16x16x32_bf16 v[56:59], a[180:183], a[152:155], v[56:59]
    v_mfma_f32_16x16x32_bf16 v[76:79], a[180:183], a[156:159], v[76:79]
    ds_read_b64_tr_b16 a[180:181], v1 offset:5120
    ds_read_b64_tr_b16 a[182:183], v1 offset:7680
    v_mfma_f32_16x16x32_bf16 v[60:63], a[184:187], a[152:155], v[60:63]
    v_mfma_f32_16x16x32_bf16 v[80:83], a[184:187], a[156:159], v[80:83]
    s_waitcnt lgkmcnt(10)
    ds_read_b64_tr_b16 a[184:185], v1 offset:5152
    ds_read_b64_tr_b16 a[186:187], v1 offset:7712
    v_mfma_f32_16x16x32_bf16 v[64:67], a[188:191], a[152:155], v[64:67]
    v_mfma_f32_16x16x32_bf16 v[84:87], a[188:191], a[156:159], v[84:87]
    v_cvt_pk_bf16_f32 v88, v48, v49
    v_cvt_pk_bf16_f32 v100, v68, v69
    v_cvt_pk_bf16_f32 v89, v50, v51
    v_cvt_pk_bf16_f32 v101, v70, v71
    v_cvt_pk_bf16_f32 v90, v52, v53
    v_cvt_pk_bf16_f32 v102, v72, v73
    v_cvt_pk_bf16_f32 v91, v54, v55
    v_cvt_pk_bf16_f32 v103, v74, v75
    v_cvt_pk_bf16_f32 v92, v56, v57
    v_cvt_pk_bf16_f32 v104, v76, v77
    v_cvt_pk_bf16_f32 v93, v58, v59
    v_cvt_pk_bf16_f32 v105, v78, v79
    v_cvt_pk_bf16_f32 v94, v60, v61
    v_cvt_pk_bf16_f32 v106, v80, v81
    v_cvt_pk_bf16_f32 v95, v62, v63
    v_cvt_pk_bf16_f32 v107, v82, v83
    v_cvt_pk_bf16_f32 v96, v64, v65
    v_cvt_pk_bf16_f32 v108, v84, v85
    v_cvt_pk_bf16_f32 v97, v66, v67
    v_cvt_pk_bf16_f32 v109, v86, v87
    v_add_u32 v16, 102400, v220
    ds_write_b64 v16, v[88:89] offset:0
    ds_write_b64 v16, v[90:91] offset:32
    ds_write_b64 v16, v[92:93] offset:64
    ds_write_b64 v16, v[94:95] offset:96
    ds_write_b64 v16, v[96:97] offset:128
    ds_write_b64 v16, v[100:101] offset:2560
    ds_write_b64 v16, v[102:103] offset:2592
    ds_write_b64 v16, v[104:105] offset:2624
    ds_write_b64 v16, v[106:107] offset:2656
    ds_write_b64 v16, v[108:109] offset:2688
    v_mov_b32 v216, 0x3f803f80
    v_mov_b32 v217, 0x3f803f80
    v_mov_b32 v218, 0x3f803f80
    v_mov_b32 v219, 0x3f803f80
    s_waitcnt lgkmcnt(0)
    s_barrier
    ds_read_b64_tr_b16 v[140:141], v222 offset:0
    ds_read_b64_tr_b16 v[142:143], v222 offset:2560
    ds_read_b64_tr_b16 v[156:157], v224 offset:0
    ds_read_b64_tr_b16 v[158:159], v224 offset:2560
    ds_read_b64_tr_b16 v[160:161], v224 offset:32
    ds_read_b64_tr_b16 v[162:163], v224 offset:2592
    ds_read_b64_tr_b16 v[144:145], v222 offset:32
    ds_read_b64_tr_b16 v[146:147], v222 offset:2592
    ds_read_b64_tr_b16 v[148:149], v223 offset:0
    ds_read_b64_tr_b16 v[150:151], v223 offset:2560
    ds_read_b64_tr_b16 v[152:153], v223 offset:8
    ds_read_b64_tr_b16 v[154:155], v223 offset:2568
    s_add_u32 m0, s42, 122880
    s_nop 0
    buffer_load_dwordx4 v4, s[12:15], s41 offen lds
    ds_read_b64_tr_b16 v[164:165], v222 offset:5120
    ds_read_b64_tr_b16 v[166:167], v222 offset:7680
    ds_read_b64_tr_b16 v[180:181], v224 offset:5120
    ds_read_b64_tr_b16 v[182:183], v224 offset:7680
    ds_read_b64_tr_b16 v[184:185], v224 offset:5152
    ds_read_b64_tr_b16 v[186:187], v224 offset:7712
    ds_read_b64_tr_b16 v[168:169], v222 offset:5152
    ds_read_b64_tr_b16 v[170:171], v222 offset:7712
    ds_read_b64_tr_b16 v[172:173], v223 offset:5120
    ds_read_b64_tr_b16 v[174:175], v223 offset:7680
    ds_read_b64_tr_b16 v[176:177], v223 offset:5128
    ds_read_b64_tr_b16 v[178:179], v223 offset:7688
    s_waitcnt lgkmcnt(12)
    ds_read_b64_tr_b16 v[48:49], v222 offset:10240
    ds_read_b64_tr_b16 v[50:51], v222 offset:12800
    ds_read_b64_tr_b16 v[64:65], v224 offset:10240
    ds_read_b64_tr_b16 v[66:67], v224 offset:12800
    ds_read_b64_tr_b16 v[68:69], v224 offset:10272
    ds_read_b64_tr_b16 v[70:71], v224 offset:12832
    ds_read_b64_tr_b16 v[52:53], v222 offset:10272
    ds_read_b64_tr_b16 v[54:55], v222 offset:12832
    ds_read_b64_tr_b16 v[56:57], v223 offset:10240
    ds_read_b64_tr_b16 v[58:59], v223 offset:12800
    ds_read_b64_tr_b16 v[60:61], v223 offset:10248
    ds_read_b64_tr_b16 v[62:63], v223 offset:12808
    v_cndmask_b32_e64 v188, v216, v160, s[100:101]
    v_cndmask_b32_e64 v189, v217, v161, s[100:101]
    v_cndmask_b32_e64 v190, v218, v162, s[100:101]
    v_cndmask_b32_e64 v191, v219, v163, s[100:101]
    v_mfma_f32_16x16x32_bf16 v[16:19], v[140:143], v[156:159], 0
    v_mfma_f32_16x16x32_bf16 v[20:23], v[140:143], v[160:163], 0
    v_mfma_f32_16x16x32_bf16 v[24:27], v[140:143], v[216:219], 0
    v_mfma_f32_16x16x32_bf16 v[28:31], v[148:151], v[156:159], 0
    v_mfma_f32_16x16x32_bf16 v[32:35], v[148:151], v[188:191], 0
    s_add_u32 m0, s42, 123904
    s_nop 0
    buffer_load_dwordx4 v5, s[12:15], s41 offen lds
    v_mfma_f32_16x16x32_bf16 v[36:39], v[144:147], v[156:159], 0
    v_mfma_f32_16x16x32_bf16 v[40:43], v[144:147], v[160:163], 0
    v_mfma_f32_16x16x32_bf16 v[44:47], v[144:147], v[216:219], 0
    v_mfma_f32_16x16x32_bf16 v[196:199], v[152:155], v[156:159], 0
    v_mfma_f32_16x16x32_bf16 v[200:203], v[152:155], v[188:191], 0
    s_waitcnt lgkmcnt(12)
    ds_read_b64_tr_b16 v[72:73], v222 offset:15360
    ds_read_b64_tr_b16 v[74:75], v222 offset:17920
    ds_read_b64_tr_b16 v[88:89], v224 offset:15360
    ds_read_b64_tr_b16 v[90:91], v224 offset:17920
    ds_read_b64_tr_b16 v[92:93], v224 offset:15392
    ds_read_b64_tr_b16 v[94:95], v224 offset:17952
    ds_read_b64_tr_b16 v[76:77], v222 offset:15392
    ds_read_b64_tr_b16 v[78:79], v222 offset:17952
    ds_read_b64_tr_b16 v[80:81], v223 offset:15360
    ds_read_b64_tr_b16 v[82:83], v223 offset:17920
    ds_read_b64_tr_b16 v[84:85], v223 offset:15368
    ds_read_b64_tr_b16 v[86:87], v223 offset:17928
    v_cndmask_b32_e64 v192, v216, v184, s[100:101]
    v_cndmask_b32_e64 v193, v217, v185, s[100:101]
    v_cndmask_b32_e64 v194, v218, v186, s[100:101]
    v_cndmask_b32_e64 v195, v219, v187, s[100:101]
    v_mfma_f32_16x16x32_bf16 v[16:19], v[164:167], v[180:183], v[16:19]
    v_mfma_f32_16x16x32_bf16 v[20:23], v[164:167], v[184:187], v[20:23]
    v_mfma_f32_16x16x32_bf16 v[24:27], v[164:167], v[216:219], v[24:27]
    v_mfma_f32_16x16x32_bf16 v[28:31], v[172:175], v[180:183], v[28:31]
    v_mfma_f32_16x16x32_bf16 v[32:35], v[172:175], v[192:195], v[32:35]
    s_add_u32 m0, s42, 124928
    s_nop 0
    buffer_load_dwordx4 v6, s[12:15], s41 offen lds
    v_mfma_f32_16x16x32_bf16 v[36:39], v[168:171], v[180:183], v[36:39]
    v_mfma_f32_16x16x32_bf16 v[40:43], v[168:171], v[184:187], v[40:43]
    v_mfma_f32_16x16x32_bf16 v[44:47], v[168:171], v[216:219], v[44:47]
    v_mfma_f32_16x16x32_bf16 v[196:199], v[176:179], v[180:183], v[196:199]
    v_mfma_f32_16x16x32_bf16 v[200:203], v[176:179], v[192:195], v[200:203]
    s_waitcnt lgkmcnt(12)
    v_cndmask_b32_e64 v188, v216, v68, s[100:101]
    v_cndmask_b32_e64 v189, v217, v69, s[100:101]
    v_cndmask_b32_e64 v190, v218, v70, s[100:101]
    v_cndmask_b32_e64 v191, v219, v71, s[100:101]
    v_mfma_f32_16x16x32_bf16 v[16:19], v[48:51], v[64:67], v[16:19]
    v_mfma_f32_16x16x32_bf16 v[20:23], v[48:51], v[68:71], v[20:23]
    v_mfma_f32_16x16x32_bf16 v[24:27], v[48:51], v[216:219], v[24:27]
    v_mfma_f32_16x16x32_bf16 v[28:31], v[56:59], v[64:67], v[28:31]
    v_mfma_f32_16x16x32_bf16 v[32:35], v[56:59], v[188:191], v[32:35]
    s_add_u32 m0, s42, 125952
    s_nop 0
    buffer_load_dwordx4 v7, s[12:15], s41 offen lds
    v_mfma_f32_16x16x32_bf16 v[36:39], v[52:55], v[64:67], v[36:39]
    v_mfma_f32_16x16x32_bf16 v[40:43], v[52:55], v[68:71], v[40:43]
    v_mfma_f32_16x16x32_bf16 v[44:47], v[52:55], v[216:219], v[44:47]
    v_mfma_f32_16x16x32_bf16 v[196:199], v[60:63], v[64:67], v[196:199]
    v_mfma_f32_16x16x32_bf16 v[200:203], v[60:63], v[188:191], v[200:203]
    s_waitcnt lgkmcnt(0)
    v_cndmask_b32_e64 v192, v216, v92, s[100:101]
    v_cndmask_b32_e64 v193, v217, v93, s[100:101]
    v_cndmask_b32_e64 v194, v218, v94, s[100:101]
    v_cndmask_b32_e64 v195, v219, v95, s[100:101]
    v_mfma_f32_16x16x32_bf16 v[16:19], v[72:75], v[88:91], v[16:19]
    v_mfma_f32_16x16x32_bf16 v[20:23], v[72:75], v[92:95], v[20:23]
    v_mfma_f32_16x16x32_bf16 v[24:27], v[72:75], v[216:219], v[24:27]
    v_mfma_f32_16x16x32_bf16 v[28:31], v[80:83], v[88:91], v[28:31]
    v_mfma_f32_16x16x32_bf16 v[32:35], v[80:83], v[192:195], v[32:35]
    s_add_u32 m0, s42, 126976
    s_nop 0
    buffer_load_dwordx4 v8, s[12:15], s41 offen lds
    v_mfma_f32_16x16x32_bf16 v[36:39], v[76:79], v[88:91], v[36:39]
    v_mfma_f32_16x16x32_bf16 v[40:43], v[76:79], v[92:95], v[40:43]
    v_mfma_f32_16x16x32_bf16 v[44:47], v[76:79], v[216:219], v[44:47]
    v_mfma_f32_16x16x32_bf16 v[196:199], v[84:87], v[88:91], v[196:199]
    v_mfma_f32_16x16x32_bf16 v[200:203], v[84:87], v[192:195], v[200:203]
    s_waitcnt vmcnt(10)
    v_cmp_ne_u32 vcc, s43, v9
    s_cbranch_vccz Lzok_5
    s_lshl_b32 s6, s30, 11
    s_add_u32 s6, s6, 9502720
    v_lshlrev_b32 v13, 7, v0
    s_mov_b32 s68, 0xffff
    s_mov_b32 s69, 0x0
    s_mov_b64 exec, s[68:69]
    s_mov_b32 s66, 0
Lpoll_6:
    buffer_load_dword v14, v13, s[16:19], s6 offen sc1
    s_waitcnt vmcnt(0)
    v_cmp_ne_u32 vcc, s43, v14
    s_cbranch_vccz Lpd_7
    s_add_u32 s66, s66, 1
    s_cmp_lt_u32 s66, 0x40000
    s_cbranch_scc1 Lpoll_6
Lpd_7:
    s_mov_b64 exec, -1
Lzok_5:
    s_mul_i32 s3, s30, 13568
    s_add_u32 s3, s3, 7340032
    s_add_u32 s4, s3, 5120
    v_cmp_ne_u32 s[50:51], 0, v230
    v_cmp_ne_u32 s[52:53], 0, v231
    v_permlane32_swap_b32 v16, v18
    v_permlane32_swap_b32 v17, v19
    v_permlane32_swap_b32 v20, v22
    v_permlane32_swap_b32 v21, v23
    v_permlane32_swap_b32 v36, v38
    v_permlane32_swap_b32 v37, v39
    v_permlane32_swap_b32 v40, v42
    v_permlane32_swap_b32 v41, v43
    v_permlane16_swap_b32 v16, v17
    v_permlane16_swap_b32 v18, v19
    v_permlane16_swap_b32 v20, v21
    v_permlane16_swap_b32 v22, v23
    v_permlane16_swap_b32 v36, v37
    v_permlane16_swap_b32 v38, v39
    v_permlane16_swap_b32 v40, v41
    v_permlane16_swap_b32 v42, v43
    buffer_atomic_add_f32 v16, v225, s[16:19], s3 offen offset:0
    buffer_atomic_add_f32 v17, v225, s[16:19], s3 offen offset:256
    buffer_atomic_add_f32 v18, v225, s[16:19], s3 offen offset:512
    buffer_atomic_add_f32 v19, v225, s[16:19], s3 offen offset:768
    v_cndmask_b32_e64 v28, 0, v28, s[50:51]
    v_cndmask_b32_e64 v29, 0, v29, s[50:51]
    v_cndmask_b32_e64 v30, 0, v30, s[50:51]
    v_cndmask_b32_e64 v31, 0, v31, s[50:51]
    buffer_atomic_add_f32 v20, v226, s[16:19], s3 offen offset:0
    buffer_atomic_add_f32 v21, v226, s[16:19], s3 offen offset:256
    buffer_atomic_add_f32 v22, v226, s[16:19], s3 offen offset:512
    buffer_atomic_add_f32 v23, v226, s[16:19], s3 offen offset:768
    v_cndmask_b32_e64 v32, 0, v32, s[52:53]
    v_cndmask_b32_e64 v33, 0, v33, s[52:53]
    v_cndmask_b32_e64 v34, 0, v34, s[52:53]
    v_cndmask_b32_e64 v35, 0, v35, s[52:53]
    buffer_atomic_add_f32 v36, v225, s[16:19], s4 offen offset:0
    buffer_atomic_add_f32 v37, v225, s[16:19], s4 offen offset:256
    buffer_atomic_add_f32 v38, v225, s[16:19], s4 offen offset:512
    buffer_atomic_add_f32 v39, v225, s[16:19], s4 offen offset:768
    v_cndmask_b32_e64 v196, 0, v196, s[50:51]
    v_cndmask_b32_e64 v197, 0, v197, s[50:51]
    v_cndmask_b32_e64 v198, 0, v198, s[50:51]
    v_cndmask_b32_e64 v199, 0, v199, s[50:51]
    buffer_atomic_add_f32 v40, v226, s[16:19], s4 offen offset:0
    buffer_atomic_add_f32 v41, v226, s[16:19], s4 offen offset:256
    buffer_atomic_add_f32 v42, v226, s[16:19], s4 offen offset:512
    buffer_atomic_add_f32 v43, v226, s[16:19], s4 offen offset:768
    v_cndmask_b32_e64 v200, 0, v200, s[52:53]
    v_cndmask_b32_e64 v201, 0, v201, s[52:53]
    v_cndmask_b32_e64 v202, 0, v202, s[52:53]
    v_cndmask_b32_e64 v203, 0, v203, s[52:53]
    v_permlane32_swap_b32 v28, v30
    v_permlane32_swap_b32 v29, v31
    v_permlane32_swap_b32 v32, v34
    v_permlane32_swap_b32 v33, v35
    v_permlane32_swap_b32 v196, v198
    v_permlane32_swap_b32 v197, v199
    v_permlane32_swap_b32 v200, v202
    v_permlane32_swap_b32 v201, v203
    v_add_f32 v28, v28, v30
    v_add_f32 v29, v29, v31
    v_add_f32 v32, v32, v34
    v_add_f32 v33, v33, v35
    v_add_f32 v196, v196, v198
    v_add_f32 v197, v197, v199
    v_add_f32 v200, v200, v202
    v_add_f32 v201, v201, v203
    v_permlane16_swap_b32 v28, v29
    v_permlane16_swap_b32 v32, v33
    v_permlane16_swap_b32 v196, v197
    v_permlane16_swap_b32 v200, v201
    v_add_f32 v28, v28, v29
    v_add_f32 v32, v32, v33
    v_add_f32 v196, v196, v197
    v_add_f32 v200, v200, v201
    s_mov_b32 s50, 0x22222222
    s_mov_b32 s51, 0x22222222
    v_cndmask_b32_e64 v24, v24, v25, s[50:51]
    v_cndmask_b32_e64 v44, v44, v45, s[50:51]
    s_mov_b32 s50, 0x44444444
    s_mov_b32 s51, 0x44444444
    v_cndmask_b32_e64 v24, v24, v26, s[50:51]
    v_cndmask_b32_e64 v44, v44, v46, s[50:51]
    s_mov_b32 s50, 0x88888888
    s_mov_b32 s51, 0x88888888
    v_cndmask_b32_e64 v24, v24, v27, s[50:51]
    v_cndmask_b32_e64 v44, v44, v47, s[50:51]
    s_cmp_eq_u32 s28, 3
    s_cselect_b32 s4, 1280, 64
    s_add_u32 s4, s4, s3
    buffer_atomic_add_f32 v24, v227, s[16:19], s3 offen offset:0
    buffer_atomic_add_f32 v28, v228, s[16:19], s3 offen offset:0
    buffer_atomic_add_f32 v32, v229, s[16:19], s3 offen
    buffer_atomic_add_f32 v44, v227, s[16:19], s3 offen offset:256
    buffer_atomic_add_f32 v196, v228, s[16:19], s3 offen offset:1280
    buffer_atomic_add_f32 v200, v229, s[16:19], s4 offen
    ds_read_b64_tr_b16 a[188:189], v1 offset:5184
    ds_read_b64_tr_b16 a[190:191], v1 offset:7744
    v_mfma_f32_16x16x32_bf16 v[48:51], a[160:163], a[0:3], 0
    v_mfma_f32_16x16x32_bf16 v[68:71], a[160:163], a[4:7], 0
    ds_read_b64_tr_b16 a[160:161], v1 offset:5216
    ds_read_b64_tr_b16 a[162:163], v1 offset:7776
    v_mfma_f32_16x16x32_bf16 v[52:55], a[164:167], a[0:3], 0
    v_mfma_f32_16x16x32_bf16 v[72:75], a[164:167], a[4:7], 0
    ds_read_b64_tr_b16 a[164:165], v1 offset:5248
    ds_read_b64_tr_b16 a[166:167], v1 offset:7808
    v_mfma_f32_16x16x32_bf16 v[56:59], a[168:171], a[0:3], 0
    v_mfma_f32_16x16x32_bf16 v[76:79], a[168:171], a[4:7], 0
    ds_read_b64_tr_b16 a[168:169], v1 offset:10240
    ds_read_b64_tr_b16 a[170:171], v1 offset:12800
    v_mfma_f32_16x16x32_bf16 v[60:63], a[172:175], a[0:3], 0
    v_mfma_f32_16x16x32_bf16 v[80:83], a[172:175], a[4:7], 0
    ds_read_b64_tr_b16 a[172:173], v1 offset:10272
    ds_read_b64_tr_b16 a[174:175], v1 offset:12832
    v_mfma_f32_16x16x32_bf16 v[64:67], a[176:179], a[0:3], 0
    v_mfma_f32_16x16x32_bf16 v[84:87], a[176:179], a[4:7], 0
    ds_read_b64_tr_b16 a[176:177], v1 offset:10304
    ds_read_b64_tr_b16 a[178:179], v1 offset:12864
    v_mfma_f32_16x16x32_bf16 v[48:51], a[180:183], a[8:11], v[48:51]
    v_mfma_f32_16x16x32_bf16 v[68:71], a[180:183], a[12:15], v[68:71]
    ds_read_b64_tr_b16 a[180:181], v1 offset:10336
    ds_read_b64_tr_b16 a[182:183], v1 offset:12896
    v_mfma_f32_16x16x32_bf16 v[52:55], a[184:187], a[8:11], v[52:55]
    v_mfma_f32_16x16x32_bf16 v[72:75], a[184:187], a[12:15], v[72:75]
    s_waitcnt lgkmcnt(10)
    ds_read_b64_tr_b16 a[184:185], v1 offset:10368
    ds_read_b64_tr_b16 a[186:187], v1 offset:12928
    v_mfma_f32_16x16x32_bf16 v[56:59], a[188:191], a[8:11], v[56:59]
    v_mfma_f32_16x16x32_bf16 v[76:79], a[188:191], a[12:15], v[76:79]
    ds_read_b64_tr_b16 a[188:189], v1 offset:15360
    ds_read_b64_tr_b16 a[190:191], v1 offset:17920
    v_mfma_f32_16x16x32_bf16 v[60:63], a[160:163], a[8:11], v[60:63]
    v_mfma_f32_16x16x32_bf16 v[80:83], a[160:163], a[12:15], v[80:83]
    s_waitcnt lgkmcnt(10)
    ds_read_b64_tr_b16 a[160:161], v1 offset:15392
    ds_read_b64_tr_b16 a[162:163], v1 offset:17952
    v_mfma_f32_16x16x32_bf16 v[64:67], a[164:167], a[8:11], v[64:67]
    v_mfma_f32_16x16x32_bf16 v[84:87], a[164:167], a[12:15], v[84:87]
    ds_read_b64_tr_b16 a[164:165], v1 offset:15424
    ds_read_b64_tr_b16 a[166:167], v1 offset:17984
    v_mfma_f32_16x16x32_bf16 v[48:51], a[168:171], a[16:19], v[48:51]
    v_mfma_f32_16x16x32_bf16 v[68:71], a[168:171], a[20:23], v[68:71]
    s_waitcnt lgkmcnt(10)
    ds_read_b64_tr_b16 a[168:169], v1 offset:15456
    ds_read_b64_tr_b16 a[170:171], v1 offset:18016
    v_mfma_f32_16x16x32_bf16 v[52:55], a[172:175], a[16:19], v[52:55]
    v_mfma_f32_16x16x32_bf16 v[72:75], a[172:175], a[20:23], v[72:75]
    ds_read_b64_tr_b16 a[172:173], v1 offset:15488
    ds_read_b64_tr_b16 a[174:175], v1 offset:18048
    v_mfma_f32_16x16x32_bf16 v[56:59], a[176:179], a[16:19], v[56:59]
    v_mfma_f32_16x16x32_bf16 v[76:79], a[176:179], a[20:23], v[76:79]
    s_waitcnt lgkmcnt(10)
    s_waitcnt vmcnt(38)
    s_barrier
    ds_read_b64_tr_b16 a[176:177], v1 offset:20480
    ds_read_b64_tr_b16 a[178:179], v1 offset:23040
    v_mfma_f32_16x16x32_bf16 v[60:63], a[180:183], a[16:19], v[60:63]
    v_mfma_f32_16x16x32_bf16 v[80:83], a[180:183], a[20:23], v[80:83]
    ds_read_b64_tr_b16 a[180:181], v1 offset:20512
    ds_read_b64_tr_b16 a[182:183], v1 offset:23072
    v_mfma_f32_16x16x32_bf16 v[64:67], a[184:187], a[16:19], v[64:67]
    v_mfma_f32_16x16x32_bf16 v[84:87], a[184:187], a[20:23], v[84:87]
    s_waitcnt lgkmcnt(10)
    ds_read_b64_tr_b16 a[184:185], v1 offset:20544
    ds_read_b64_tr_b16 a[186:187], v1 offset:23104
    v_mfma_f32_16x16x32_bf16 v[48:51], a[188:191], a[24:27], v[48:51]
    v_mfma_f32_16x16x32_bf16 v[68:71], a[188:191], a[28:31], v[68:71]
    ds_read_b64_tr_b16 a[188:189], v1 offset:20576
    ds_read_b64_tr_b16 a[190:191], v1 offset:23136
    v_mfma_f32_16x16x32_bf16 v[52:55], a[160:163], a[24:27], v[52:55]
    v_mfma_f32_16x16x32_bf16 v[72:75], a[160:163], a[28:31], v[72:75]
    s_waitcnt lgkmcnt(10)
    ds_read_b64_tr_b16 a[160:161], v1 offset:20608
    ds_read_b64_tr_b16 a[162:163], v1 offset:23168
    v_mfma_f32_16x16x32_bf16 v[56:59], a[164:167], a[24:27], v[56:59]
    v_mfma_f32_16x16x32_bf16 v[76:79], a[164:167], a[28:31], v[76:79]
    ds_read_b64_tr_b16 a[164:165], v1 offset:25600
    ds_read_b64_tr_b16 a[166:167], v1 offset:28160
    v_mfma_f32_16x16x32_bf16 v[60:63], a[168:171], a[24:27], v[60:63]
    v_mfma_f32_16x16x32_bf16 v[80:83], a[168:171], a[28:31], v[80:83]
    s_waitcnt lgkmcnt(10)
    ds_read_b64_tr_b16 a[168:169], v1 offset:25632
    ds_read_b64_tr_b16 a[170:171], v1 offset:28192
    v_mfma_f32_16x16x32_bf16 v[64:67], a[172:175], a[24:27], v[64:67]
    v_mfma_f32_16x16x32_bf16 v[84:87], a[172:175], a[28:31], v[84:87]
    ds_read_b64_tr_b16 a[172:173], v1 offset:25664
    ds_read_b64_tr_b16 a[174:175], v1 offset:28224
    v_mfma_f32_16x16x32_bf16 v[48:51], a[176:179], a[32:35], v[48:51]
    v_mfma_f32_16x16x32_bf16 v[68:71], a[176:179], a[36:39], v[68:71]
    s_waitcnt lgkmcnt(10)
    ds_read_b64_tr_b16 a[176:177], v1 offset:25696
    ds_read_b64_tr_b16 a[178:179], v1 offset:28256
    v_mfma_f32_16x16x32_bf16 v[52:55], a[180:183], a[32:35], v[52:55]
    v_mfma_f32_16x16x32_bf16 v[72:75], a[180:183], a[36:39], v[72:75]
    ds_read_b64_tr_b16 a[180:181], v1 offset:25728
    ds_read_b64_tr_b16 a[182:183], v1 offset:28288
    v_mfma_f32_16x16x32_bf16 v[56:59], a[184:187], a[32:35], v[56:59]
    v_mfma_f32_16x16x32_bf16 v[76:79], a[184:187], a[36:39], v[76:79]
    s_waitcnt lgkmcnt(10)
    ds_read_b64_tr_b16 a[184:185], v1 offset:30720
    ds_read_b64_tr_b16 a[186:187], v1 offset:33280
    v_mfma_f32_16x16x32_bf16 v[60:63], a[188:191], a[32:35], v[60:63]
    v_mfma_f32_16x16x32_bf16 v[80:83], a[188:191], a[36:39], v[80:83]
    ds_read_b64_tr_b16 a[188:189], v1 offset:30752
    ds_read_b64_tr_b16 a[190:191], v1 offset:33312
    v_mfma_f32_16x16x32_bf16 v[64:67], a[160:163], a[32:35], v[64:67]
    v_mfma_f32_16x16x32_bf16 v[84:87], a[160:163], a[36:39], v[84:87]
    s_waitcnt lgkmcnt(10)
    ds_read_b64_tr_b16 a[160:161], v1 offset:30784
    ds_read_b64_tr_b16 a[162:163], v1 offset:33344
    v_mfma_f32_16x16x32_bf16 v[48:51], a[164:167], a[40:43], v[48:51]
    v_mfma_f32_16x16x32_bf16 v[68:71], a[164:167], a[44:47], v[68:71]
    v_add_u32 v13, 0, v0
    v_mul_u32_u24 v14, 6554, v13
    v_lshrrev_b32 v14, 16, v14
    v_mul_u32_u24 v15, 10, v14
    v_sub_u32 v15, v13, v15
    v_mul_u32_u24 v14, 1280, v14
    v_lshl_add_u32 v4, v15, 4, v14
    v_add_u32 v13, 64, v0
    v_mul_u32_u24 v14, 6554, v13
    v_lshrrev_b32 v14, 16, v14
    v_mul_u32_u24 v15, 10, v14
    v_sub_u32 v15, v13, v15
    v_mul_u32_u24 v14, 1280, v14
    v_lshl_add_u32 v5, v15, 4, v14
    v_add_u32 v13, 128, v0
    v_mul_u32_u24 v14, 6554, v13
    v_lshrrev_b32 v14, 16, v14
    v_mul_u32_u24 v15, 10, v14
    v_sub_u32 v15, v13, v15
    v_mul_u32_u24 v14, 1280, v14
    v_lshl_add_u32 v6, v15, 4, v14
    v_add_u32 v13, 192, v0
    v_mul_u32_u24 v14, 6554, v13
    v_lshrrev_b32 v14, 16, v14
    v_mul_u32_u24 v15, 10, v14
    v_sub_u32 v15, v13, v15
    v_mul_u32_u24 v14, 1280, v14
    v_lshl_add_u32 v7, v15, 4, v14
    v_add_u32 v13, 256, v0
    v_mul_u32_u24 v14, 6554, v13
    v_lshrrev_b32 v14, 16, v14
    v_mul_u32_u24 v15, 10, v14
    v_sub_u32 v15, v13, v15
    v_mul_u32_u24 v14, 1280, v14
    v_lshl_add_u32 v8, v15, 4, v14
    s_mul_i32 s37, s28, 40960
    s_mul_i32 s7, s30, 160
    s_add_u32 s37, s37, s7
    ds_read_b64_tr_b16 a[164:165], v1 offset:30816
    ds_read_b64_tr_b16 a[166:167], v1 offset:33376
    v_mfma_f32_16x16x32_bf16 v[52:55], a[168:171], a[40:43], v[52:55]
    v_mfma_f32_16x16x32_bf16 v[72:75], a[168:171], a[44:47], v[72:75]
    s_waitcnt lgkmcnt(10)
    ds_read_b64_tr_b16 a[168:169], v1 offset:30848
    ds_read_b64_tr_b16 a[170:171], v1 offset:33408
    v_mfma_f32_16x16x32_bf16 v[56:59], a[172:175], a[40:43], v[56:59]
    v_mfma_f32_16x16x32_bf16 v[76:79], a[172:175], a[44:47], v[76:79]
    ds_read_b64_tr_b16 a[172:173], v1 offset:35840
    ds_read_b64_tr_b16 a[174:175], v1 offset:38400
    v_mfma_f32_16x16x32_bf16 v[60:63], a[176:179], a[40:43], v[60:63]
    v_mfma_f32_16x16x32_bf16 v[80:83], a[176:179], a[44:47], v[80:83]
    s_waitcnt lgkmcnt(10)
    ds_read_b64_tr_b16 a[176:177], v1 offset:35872
    ds_read_b64_tr_b16 a[178:179], v1 offset:38432
    v_mfma_f32_16x16x32_bf16 v[64:67], a[180:183], a[40:43], v[64:67]
    v_mfma_f32_16x16x32_bf16 v[84:87], a[180:183], a[44:47], v[84:87]
    ds_read_b64_tr_b16 a[180:181], v1 offset:35904
    ds_read_b64_tr_b16 a[182:183], v1 offset:38464
    v_mfma_f32_16x16x32_bf16 v[48:51], a[184:187], a[48:51], v[48:51]
    v_mfma_f32_16x16x32_bf16 v[68:71], a[184:187], a[52:55], v[68:71]
    s_waitcnt lgkmcnt(10)
    ds_read_b64_tr_b16 a[184:185], v1 offset:35936
    ds_read_b64_tr_b16 a[186:187], v1 offset:38496
    v_mfma_f32_16x16x32_bf16 v[52:55], a[188:191], a[48:51], v[52:55]
    v_mfma_f32_16x16x32_bf16 v[72:75], a[188:191], a[52:55], v[72:75]
    ds_read_b64_tr_b16 a[188:189], v1 offset:35968
    ds_read_b64_tr_b16 a[190:191], v1 offset:38528
    v_mfma_f32_16x16x32_bf16 v[56:59], a[160:163], a[48:51], v[56:59]
    v_mfma_f32_16x16x32_bf16 v[76:79], a[160:163], a[52:55], v[76:79]
    s_waitcnt lgkmcnt(10)
    s_waitcnt vmcnt(33)
    s_barrier
    ds_read_b64_tr_b16 a[160:161], v1 offset:40960
    ds_read_b64_tr_b16 a[162:163], v1 offset:43520
    v_mfma_f32_16x16x32_bf16 v[60:63], a[164:167], a[48:51], v[60:63]
    v_mfma_f32_16x16x32_bf16 v[80:83], a[164:167], a[52:55], v[80:83]
    s_add_u32 m0, s42, 61440
    s_nop 0
    buffer_load_dwordx4 v4, s[44:47], s37 offen lds
    ds_read_b64_tr_b16 a[164:165], v1 offset:40992
    ds_read_b64_tr_b16 a[166:167], v1 offset:43552
    v_mfma_f32_16x16x32_bf16 v[64:67], a[168:171], a[48:51], v[64:67]
    v_mfma_f32_16x16x32_bf16 v[84:87], a[168:171], a[52:55], v[84:87]
    s_waitcnt lgkmcnt(10)
    ds_read_b64_tr_b16 a[168:169], v1 offset:41024
    ds_read_b64_tr_b16 a[170:171], v1 offset:43584
    v_mfma_f32_16x16x32_bf16 v[48:51], a[172:175], a[56:59], v[48:51]
    v_mfma_f32_16x16x32_bf16 v[68:71], a[172:175], a[60:63], v[68:71]
    s_add_u32 m0, s42, 62464
    s_nop 0
    buffer_load_dwordx4 v5, s[44:47], s37 offen lds
    ds_read_b64_tr_b16 a[172:173], v1 offset:41056
    ds_read_b64_tr_b16 a[174:175], v1 offset:43616
    v_mfma_f32_16x16x32_bf16 v[52:55], a[176:179], a[56:59], v[52:55]
    v_mfma_f32_16x16x32_bf16 v[72:75], a[176:179], a[60:63], v[72:75]
    s_waitcnt lgkmcnt(10)
    ds_read_b64_tr_b16 a[176:177], v1 offset:41088
    ds_read_b64_tr_b16 a[178:179], v1 offset:43648
    v_mfma_f32_16x16x32_bf16 v[56:59], a[180:183], a[56:59], v[56:59]
    v_mfma_f32_16x16x32_bf16 v[76:79], a[180:183], a[60:63], v[76:79]
    s_add_u32 m0, s42, 63488
    s_nop 0
    buffer_load_dwordx4 v6, s[44:47], s37 offen lds
    ds_read_b64_tr_b16 a[180:181], v1 offset:46080
    ds_read_b64_tr_b16 a[182:183], v1 offset:48640
    v_mfma_f32_16x16x32_bf16 v[60:63], a[184:187], a[56:59], v[60:63]
    v_mfma_f32_16x16x32_bf16 v[80:83], a[184:187], a[60:63], v[80:83]
    s_waitcnt lgkmcnt(10)
    ds_read_b64_tr_b16 a[184:185], v1 offset:46112
    ds_read_b64_tr_b16 a[186:187], v1 offset:48672
    v_mfma_f32_16x16x32_bf16 v[64:67], a[188:191], a[56:59], v[64:67]
    v_mfma_f32_16x16x32_bf16 v[84:87], a[188:191], a[60:63], v[84:87]
    s_add_u32 m0, s42, 64512
    s_nop 0
    buffer_load_dwordx4 v7, s[44:47], s37 offen lds
    ds_read_b64_tr_b16 a[188:189], v1 offset:46144
    ds_read_b64_tr_b16 a[190:191], v1 offset:48704
    v_mfma_f32_16x16x32_bf16 v[48:51], a[160:163], a[64:67], v[48:51]
    v_mfma_f32_16x16x32_bf16 v[68:71], a[160:163], a[68:71], v[68:71]
    s_waitcnt lgkmcnt(10)
    ds_read_b64_tr_b16 a[160:161], v1 offset:46176
    ds_read_b64_tr_b16 a[162:163], v1 offset:48736
    v_mfma_f32_16x16x32_bf16 v[52:55], a[164:167], a[64:67], v[52:55]
    v_mfma_f32_16x16x32_bf16 v[72:75], a[164:167], a[68:71], v[72:75]
    s_add_u32 m0, s42, 65536
    s_nop 0
    buffer_load_dwordx4 v8, s[44:47], s37 offen lds
    ds_read_b64_tr_b16 a[164:165], v1 offset:46208
    ds_read_b64_tr_b16 a[166:167], v1 offset:48768
    v_mfma_f32_16x16x32_bf16 v[56:59], a[168:171], a[64:67], v[56:59]
    v_mfma_f32_16x16x32_bf16 v[76:79], a[168:171], a[68:71], v[76:79]
    s_waitcnt lgkmcnt(10)
    ds_read_b64_tr_b16 a[168:169], v1 offset:51200
    ds_read_b64_tr_b16 a[170:171], v1 offset:53760
    v_mfma_f32_16x16x32_bf16 v[60:63], a[172:175], a[64:67], v[60:63]
    v_mfma_f32_16x16x32_bf16 v[80:83], a[172:175], a[68:71], v[80:83]
    s_add_u32 m0, s42, 143360
    s_add_u32 s7, s37, 163840
    buffer_load_dwordx4 v4, s[44:47], s7 offen lds
    ds_read_b64_tr_b16 a[172:173], v1 offset:51232
    ds_read_b64_tr_b16 a[174:175], v1 offset:53792
    v_mfma_f32_16x16x32_bf16 v[64:67], a[176:179], a[64:67], v[64:67]
    v_mfma_f32_16x16x32_bf16 v[84:87], a[176:179], a[68:71], v[84:87]
    s_waitcnt lgkmcnt(10)
    ds_read_b64_tr_b16 a[176:177], v1 offset:51264
    ds_read_b64_tr_b16 a[178:179], v1 offset:53824
    v_mfma_f32_16x16x32_bf16 v[48:51], a[180:183], a[72:75], v[48:51]
    v_mfma_f32_16x16x32_bf16 v[68:71], a[180:183], a[76:79], v[68:71]
    s_add_u32 m0, s42, 144384
    s_add_u32 s7, s37, 163840
    buffer_load_dwordx4 v5, s[44:47], s7 offen lds
    ds_read_b64_tr_b16 a[180:181], v1 offset:51296
    ds_read_b64_tr_b16 a[182:183], v1 offset:53856
    v_mfma_f32_16x16x32_bf16 v[52:55], a[184:187], a[72:75], v[52:55]
    v_mfma_f32_16x16x32_bf16 v[72:75], a[184:187], a[76:79], v[72:75]
    s_waitcnt lgkmcnt(10)
    ds_read_b64_tr_b16 a[184:185], v1 offset:51328
    ds_read_b64_tr_b16 a[186:187], v1 offset:53888
    v_mfma_f32_16x16x32_bf16 v[56:59], a[188:191], a[72:75], v[56:59]
    v_mfma_f32_16x16x32_bf16 v[76:79], a[188:191], a[76:79], v[76:79]
    s_add_u32 m0, s42, 145408
    s_add_u32 s7, s37, 163840
    buffer_load_dwordx4 v6, s[44:47], s7 offen lds
    ds_read_b64_tr_b16 a[188:189], v1 offset:56320
    ds_read_b64_tr_b16 a[190:191], v1 offset:58880
    v_mfma_f32_16x16x32_bf16 v[60:63], a[160:163], a[72:75], v[60:63]
    v_mfma_f32_16x16x32_bf16 v[80:83], a[160:163], a[76:79], v[80:83]
    s_waitcnt lgkmcnt(10)
    ds_read_b64_tr_b16 a[160:161], v1 offset:56352
    ds_read_b64_tr_b16 a[162:163], v1 offset:58912
    v_mfma_f32_16x16x32_bf16 v[64:67], a[164:167], a[72:75], v[64:67]
    v_mfma_f32_16x16x32_bf16 v[84:87], a[164:167], a[76:79], v[84:87]
    s_add_u32 m0, s42, 146432
    s_add_u32 s7, s37, 163840
    buffer_load_dwordx4 v7, s[44:47], s7 offen lds
    ds_read_b64_tr_b16 a[164:165], v1 offset:56384
    ds_read_b64_tr_b16 a[166:167], v1 offset:58944
    v_mfma_f32_16x16x32_bf16 v[48:51], a[168:171], a[80:83], v[48:51]
    v_mfma_f32_16x16x32_bf16 v[68:71], a[168:171], a[84:87], v[68:71]
    s_waitcnt lgkmcnt(10)
    ds_read_b64_tr_b16 a[168:169], v1 offset:56416
    ds_read_b64_tr_b16 a[170:171], v1 offset:58976
    v_mfma_f32_16x16x32_bf16 v[52:55], a[172:175], a[80:83], v[52:55]
    v_mfma_f32_16x16x32_bf16 v[72:75], a[172:175], a[84:87], v[72:75]
    s_add_u32 m0, s42, 147456
    s_add_u32 s7, s37, 163840
    buffer_load_dwordx4 v8, s[44:47], s7 offen lds
    ds_read_b64_tr_b16 a[172:173], v1 offset:56448
    ds_read_b64_tr_b16 a[174:175], v1 offset:59008
    v_mfma_f32_16x16x32_bf16 v[56:59], a[176:179], a[80:83], v[56:59]
    v_mfma_f32_16x16x32_bf16 v[76:79], a[176:179], a[84:87], v[76:79]
    s_waitcnt lgkmcnt(10)
    s_waitcnt vmcnt(10)
    s_barrier
    s_lshl_b32 s4, s30, 4
    s_add_u32 s4, s4, s29
    s_lshl_b32 s4, s4, 7
    s_add_u32 s4, s4, 9453568
    s_cmp_lg_u32 s28, 0
    s_cbranch_scc1 Lfl_8
    v_mov_b32 v13, 0
    v_mov_b32 v14, s43
    s_mov_b64 exec, 1
    buffer_store_dword v14, v13, s[16:19], s4 offen sc1
    s_mov_b64 exec, -1
Lfl_8:
    ds_read_b64_tr_b16 a[176:177], v2 offset:20480
    ds_read_b64_tr_b16 a[178:179], v2 offset:23040
    v_mfma_f32_16x16x32_bf16 v[60:63], a[180:183], a[80:83], v[60:63]
    v_mfma_f32_16x16x32_bf16 v[80:83], a[180:183], a[84:87], v[80:83]
    s_add_u32 m0, s42, 0
    s_add_u32 s7, s37, 327680
    buffer_load_dwordx4 v4, s[44:47], s7 offen lds
    ds_read_b64_tr_b16 a[180:181], v2 offset:20512
    ds_read_b64_tr_b16 a[182:183], v2 offset:23072
    v_mfma_f32_16x16x32_bf16 v[64:67], a[184:187], a[80:83], v[64:67]
    v_mfma_f32_16x16x32_bf16 v[84:87], a[184:187], a[84:87], v[84:87]
    s_waitcnt lgkmcnt(10)
    ds_read_b64_tr_b16 a[184:185], v2 offset:20544
    ds_read_b64_tr_b16 a[186:187], v2 offset:23104
    v_mfma_f32_16x16x32_bf16 v[48:51], a[188:191], a[88:91], v[48:51]
    v_mfma_f32_16x16x32_bf16 v[68:71], a[188:191], a[92:95], v[68:71]
    s_add_u32 m0, s42, 1024
    s_add_u32 s7, s37, 327680
    buffer_load_dwordx4 v5, s[44:47], s7 offen lds
    ds_read_b64_tr_b16 a[188:189], v2 offset:20576
    ds_read_b64_tr_b16 a[190:191], v2 offset:23136
    v_mfma_f32_16x16x32_bf16 v[52:55], a[160:163], a[88:91], v[52:55]
    v_mfma_f32_16x16x32_bf16 v[72:75], a[160:163], a[92:95], v[72:75]
    s_waitcnt lgkmcnt(10)
    ds_read_b64_tr_b16 a[160:161], v2 offset:20608
    ds_read_b64_tr_b16 a[162:163], v2 offset:23168
    v_mfma_f32_16x16x32_bf16 v[56:59], a[164:167], a[88:91], v[56:59]
    v_mfma_f32_16x16x32_bf16 v[76:79], a[164:167], a[92:95], v[76:79]
    s_add_u32 m0, s42, 2048
    s_add_u32 s7, s37, 327680
    buffer_load_dwordx4 v6, s[44:47], s7 offen lds
    ds_read_b64_tr_b16 a[164:165], v2 offset:25600
    ds_read_b64_tr_b16 a[166:167], v2 offset:28160
    v_mfma_f32_16x16x32_bf16 v[60:63], a[168:171], a[88:91], v[60:63]
    v_mfma_f32_16x16x32_bf16 v[80:83], a[168:171], a[92:95], v[80:83]
    s_waitcnt lgkmcnt(10)
    ds_read_b64_tr_b16 a[168:169], v2 offset:25632
    ds_read_b64_tr_b16 a[170:171], v2 offset:28192
    v_mfma_f32_16x16x32_bf16 v[64:67], a[172:175], a[88:91], v[64:67]
    v_mfma_f32_16x16x32_bf16 v[84:87], a[172:175], a[92:95], v[84:87]
    s_add_u32 m0, s42, 3072
    s_add_u32 s7, s37, 327680
    buffer_load_dwordx4 v7, s[44:47], s7 offen lds
    ds_read_b64_tr_b16 a[172:173], v2 offset:25664
    ds_read_b64_tr_b16 a[174:175], v2 offset:28224
    v_mfma_f32_16x16x32_bf16 v[48:51], a[176:179], a[96:99], v[48:51]
    v_mfma_f32_16x16x32_bf16 v[68:71], a[176:179], a[100:103], v[68:71]
    s_waitcnt lgkmcnt(10)
    ds_read_b64_tr_b16 a[176:177], v2 offset:25696
    ds_read_b64_tr_b16 a[178:179], v2 offset:28256
    v_mfma_f32_16x16x32_bf16 v[52:55], a[180:183], a[96:99], v[52:55]
    v_mfma_f32_16x16x32_bf16 v[72:75], a[180:183], a[100:103], v[72:75]
    s_add_u32 m0, s42, 4096
    s_add_u32 s7, s37, 327680
    buffer_load_dwordx4 v8, s[44:47], s7 offen lds
    ds_read_b64_tr_b16 a[180:181], v2 offset:25728
    ds_read_b64_tr_b16 a[182:183], v2 offset:28288
    v_mfma_f32_16x16x32_bf16 v[56:59], a[184:187], a[96:99], v[56:59]
    v_mfma_f32_16x16x32_bf16 v[76:79], a[184:187], a[100:103], v[76:79]
    s_waitcnt lgkmcnt(10)
    ds_read_b64_tr_b16 a[184:185], v2 offset:30720
    ds_read_b64_tr_b16 a[186:187], v2 offset:33280
    v_mfma_f32_16x16x32_bf16 v[60:63], a[188:191], a[96:99], v[60:63]
    v_mfma_f32_16x16x32_bf16 v[80:83], a[188:191], a[100:103], v[80:83]
    s_add_u32 m0, s42, 20480
    s_add_u32 s7, s37, 491520
    buffer_load_dwordx4 v4, s[44:47], s7 offen lds
    ds_read_b64_tr_b16 a[188:189], v2 offset:30752
    ds_read_b64_tr_b16 a[190:191], v2 offset:33312
    v_mfma_f32_16x16x32_bf16 v[64:67], a[160:163], a[96:99], v[64:67]
    v_mfma_f32_16x16x32_bf16 v[84:87], a[160:163], a[100:103], v[84:87]
    s_waitcnt lgkmcnt(10)
    ds_read_b64_tr_b16 a[160:161], v2 offset:30784
    ds_read_b64_tr_b16 a[162:163], v2 offset:33344
    v_mfma_f32_16x16x32_bf16 v[48:51], a[164:167], a[104:107], v[48:51]
    v_mfma_f32_16x16x32_bf16 v[68:71], a[164:167], a[108:111], v[68:71]
    s_add_u32 m0, s42, 21504
    s_add_u32 s7, s37, 491520
    buffer_load_dwordx4 v5, s[44:47], s7 offen lds
    ds_read_b64_tr_b16 a[164:165], v2 offset:30816
    ds_read_b64_tr_b16 a[166:167], v2 offset:33376
    v_mfma_f32_16x16x32_bf16 v[52:55], a[168:171], a[104:107], v[52:55]
    v_mfma_f32_16x16x32_bf16 v[72:75], a[168:171], a[108:111], v[72:75]
    s_waitcnt lgkmcnt(10)
    ds_read_b64_tr_b16 a[168:169], v2 offset:30848
    ds_read_b64_tr_b16 a[170:171], v2 offset:33408
    v_mfma_f32_16x16x32_bf16 v[56:59], a[172:175], a[104:107], v[56:59]
    v_mfma_f32_16x16x32_bf16 v[76:79], a[172:175], a[108:111], v[76:79]
    s_add_u32 m0, s42, 22528
    s_add_u32 s7, s37, 491520
    buffer_load_dwordx4 v6, s[44:47], s7 offen lds
    ds_read_b64_tr_b16 a[172:173], v2 offset:35840
    ds_read_b64_tr_b16 a[174:175], v2 offset:38400
    v_mfma_f32_16x16x32_bf16 v[60:63], a[176:179], a[104:107], v[60:63]
    v_mfma_f32_16x16x32_bf16 v[80:83], a[176:179], a[108:111], v[80:83]
    s_waitcnt lgkmcnt(10)
    ds_read_b64_tr_b16 a[176:177], v2 offset:35872
    ds_read_b64_tr_b16 a[178:179], v2 offset:38432
    v_mfma_f32_16x16x32_bf16 v[64:67], a[180:183], a[104:107], v[64:67]
    v_mfma_f32_16x16x32_bf16 v[84:87], a[180:183], a[108:111], v[84:87]
    s_add_u32 m0, s42, 23552
    s_add_u32 s7, s37, 491520
    buffer_load_dwordx4 v7, s[44:47], s7 offen lds
    ds_read_b64_tr_b16 a[180:181], v2 offset:35904
    ds_read_b64_tr_b16 a[182:183], v2 offset:38464
    v_mfma_f32_16x16x32_bf16 v[48:51], a[184:187], a[112:115], v[48:51]
    v_mfma_f32_16x16x32_bf16 v[68:71], a[184:187], a[116:119], v[68:71]
    s_waitcnt lgkmcnt(10)
    ds_read_b64_tr_b16 a[184:185], v2 offset:35936
    ds_read_b64_tr_b16 a[186:187], v2 offset:38496
    v_mfma_f32_16x16x32_bf16 v[52:55], a[188:191], a[112:115], v[52:55]
    v_mfma_f32_16x16x32_bf16 v[72:75], a[188:191], a[116:119], v[72:75]
    s_add_u32 m0, s42, 24576
    s_add_u32 s7, s37, 491520
    buffer_load_dwordx4 v8, s[44:47], s7 offen lds
    ds_read_b64_tr_b16 a[188:189], v2 offset:35968
    ds_read_b64_tr_b16 a[190:191], v2 offset:38528
    v_mfma_f32_16x16x32_bf16 v[56:59], a[160:163], a[112:115], v[56:59]
    v_mfma_f32_16x16x32_bf16 v[76:79], a[160:163], a[116:119], v[76:79]
    s_waitcnt lgkmcnt(10)
    s_waitcnt vmcnt(42)
    s_barrier
    ds_read_b64_tr_b16 a[160:161], v3 offset:0
    ds_read_b64_tr_b16 a[162:163], v3 offset:2560
    v_mfma_f32_16x16x32_bf16 v[60:63], a[164:167], a[112:115], v[60:63]
    v_mfma_f32_16x16x32_bf16 v[80:83], a[164:167], a[116:119], v[80:83]
    ds_read_b64_tr_b16 a[164:165], v3 offset:32
    ds_read_b64_tr_b16 a[166:167], v3 offset:2592
    v_mfma_f32_16x16x32_bf16 v[64:67], a[168:171], a[112:115], v[64:67]
    v_mfma_f32_16x16x32_bf16 v[84:87], a[168:171], a[116:119], v[84:87]
    s_waitcnt lgkmcnt(10)
    s_add_u32 m0, s42, 40960
    s_add_u32 s7, s37, 655360
    buffer_load_dwordx4 v4, s[44:47], s7 offen lds
    ds_read_b64_tr_b16 a[168:169], v3 offset:64
    ds_read_b64_tr_b16 a[170:171], v3 offset:2624
    v_mfma_f32_16x16x32_bf16 v[48:51], a[172:175], a[120:123], v[48:51]
    v_mfma_f32_16x16x32_bf16 v[68:71], a[172:175], a[124:127], v[68:71]
    ds_read_b64_tr_b16 a[172:173], v3 offset:96
    ds_read_b64_tr_b16 a[174:175], v3 offset:2656
    v_mfma_f32_16x16x32_bf16 v[52:55], a[176:179], a[120:123], v[52:55]
    v_mfma_f32_16x16x32_bf16 v[72:75], a[176:179], a[124:127], v[72:75]
    s_waitcnt lgkmcnt(10)
    s_add_u32 m0, s42, 41984
    s_add_u32 s7, s37, 655360
    buffer_load_dwordx4 v5, s[44:47], s7 offen lds
    ds_read_b64_tr_b16 a[176:177], v3 offset:128
    ds_read_b64_tr_b16 a[178:179], v3 offset:2688
    v_mfma_f32_16x16x32_bf16 v[56:59], a[180:183], a[120:123], v[56:59]
    v_mfma_f32_16x16x32_bf16 v[76:79], a[180:183], a[124:127], v[76:79]
    ds_read_b64_tr_b16 a[180:181], v3 offset:5120
    ds_read_b64_tr_b16 a[182:183], v3 offset:7680
    v_mfma_f32_16x16x32_bf16 v[60:63], a[184:187], a[120:123], v[60:63]
    v_mfma_f32_16x16x32_bf16 v[80:83], a[184:187], a[124:127], v[80:83]
    s_waitcnt lgkmcnt(10)
    s_add_u32 m0, s42, 43008
    s_add_u32 s7, s37, 655360
    buffer_load_dwordx4 v6, s[44:47], s7 offen lds
    ds_read_b64_tr_b16 a[184:185], v3 offset:5152
    ds_read_b64_tr_b16 a[186:187], v3 offset:7712
    v_mfma_f32_16x16x32_bf16 v[64:67], a[188:191], a[120:123], v[64:67]
    v_mfma_f32_16x16x32_bf16 v[84:87], a[188:191], a[124:127], v[84:87]
    ds_read_b64_tr_b16 a[188:189], v3 offset:5184
    ds_read_b64_tr_b16 a[190:191], v3 offset:7744
    v_mfma_f32_16x16x32_bf16 v[48:51], a[160:163], a[128:131], v[48:51]
    v_mfma_f32_16x16x32_bf16 v[68:71], a[160:163], a[132:135], v[68:71]
    s_waitcnt lgkmcnt(10)
    s_add_u32 m0, s42, 44032
    s_add_u32 s7, s37, 655360
    buffer_load_dwordx4 v7, s[44:47], s7 offen lds
    ds_read_b64_tr_b16 a[160:161], v3 offset:5216
    ds_read_b64_tr_b16 a[162:163], v3 offset:7776
    v_mfma_f32_16x16x32_bf16 v[52:55], a[164:167], a[128:131], v[52:55]
    v_mfma_f32_16x16x32_bf16 v[72:75], a[164:167], a[132:135], v[72:75]
    ds_read_b64_tr_b16 a[164:165], v3 offset:5248
    ds_read_b64_tr_b16 a[166:167], v3 offset:7808
    v_mfma_f32_16x16x32_bf16 v[56:59], a[168:171], a[128:131], v[56:59]
    v_mfma_f32_16x16x32_bf16 v[76:79], a[168:171], a[132:135], v[76:79]
    s_waitcnt lgkmcnt(10)
    s_add_u32 m0, s42, 45056
    s_add_u32 s7, s37, 655360
    buffer_load_dwordx4 v8, s[44:47], s7 offen lds
    ds_read_b64_tr_b16 a[168:169], v3 offset:10240
    ds_read_b64_tr_b16 a[170:171], v3 offset:12800
    v_mfma_f32_16x16x32_bf16 v[60:63], a[172:175], a[128:131], v[60:63]
    v_mfma_f32_16x16x32_bf16 v[80:83], a[172:175], a[132:135], v[80:83]
    ds_read_b64_tr_b16 a[172:173], v3 offset:10272
    ds_read_b64_tr_b16 a[174:175], v3 offset:12832
    v_mfma_f32_16x16x32_bf16 v[64:67], a[176:179], a[128:131], v[64:67]
    v_mfma_f32_16x16x32_bf16 v[84:87], a[176:179], a[132:135], v[84:87]
    s_waitcnt lgkmcnt(10)
    ds_read_b64_tr_b16 a[176:177], v3 offset:10304
    ds_read_b64_tr_b16 a[178:179], v3 offset:12864
    v_mfma_f32_16x16x32_bf16 v[48:51], a[180:183], a[136:139], v[48:51]
    v_mfma_f32_16x16x32_bf16 v[68:71], a[180:183], a[140:143], v[68:71]
    ds_read_b64_tr_b16 a[180:181], v3 offset:10336
    ds_read_b64_tr_b16 a[182:183], v3 offset:12896
    v_mfma_f32_16x16x32_bf16 v[52:55], a[184:187], a[136:139], v[52:55]
    v_mfma_f32_16x16x32_bf16 v[72:75], a[184:187], a[140:143], v[72:75]
    s_waitcnt lgkmcnt(10)
    s_lshl_b32 s7, s30, 11
    s_add_u32 s7, s7, 9453568
    v_and_b32 v13, 15, v0
    v_lshlrev_b32 v13, 7, v13
    buffer_load_dword v9, v13, s[16:19], s7 offen sc1
    ds_read_b64_tr_b16 a[184:185], v3 offset:10368
    ds_read_b64_tr_b16 a[186:187], v3 offset:12928
    v_mfma_f32_16x16x32_bf16 v[56:59], a[188:191], a[136:139], v[56:59]
    v_mfma_f32_16x16x32_bf16 v[76:79], a[188:191], a[140:143], v[76:79]
    ds_read_b64_tr_b16 a[188:189], v3 offset:15360
    ds_read_b64_tr_b16 a[190:191], v3 offset:17920
    v_mfma_f32_16x16x32_bf16 v[60:63], a[160:163], a[136:139], v[60:63]
    v_mfma_f32_16x16x32_bf16 v[80:83], a[160:163], a[140:143], v[80:83]
    s_waitcnt lgkmcnt(10)
    ds_read_b64_tr_b16 a[160:161], v3 offset:15392
    ds_read_b64_tr_b16 a[162:163], v3 offset:17952
    v_mfma_f32_16x16x32_bf16 v[64:67], a[164:167], a[136:139], v[64:67]
    v_mfma_f32_16x16x32_bf16 v[84:87], a[164:167], a[140:143], v[84:87]
    ds_read_b64_tr_b16 a[164:165], v3 offset:15424
    ds_read_b64_tr_b16 a[166:167], v3 offset:17984
    v_mfma_f32_16x16x32_bf16 v[48:51], a[168:171], a[144:147], v[48:51]
    v_mfma_f32_16x16x32_bf16 v[68:71], a[168:171], a[148:151], v[68:71]
    s_waitcnt lgkmcnt(10)
    ds_read_b64_tr_b16 a[168:169], v3 offset:15456
    ds_read_b64_tr_b16 a[170:171], v3 offset:18016
    v_mfma_f32_16x16x32_bf16 v[52:55], a[172:175], a[144:147], v[52:55]
    v_mfma_f32_16x16x32_bf16 v[72:75], a[172:175], a[148:151], v[72:75]
    ds_read_b64_tr_b16 a[172:173], v3 offset:15488
    ds_read_b64_tr_b16 a[174:175], v3 offset:18048
    v_mfma_f32_16x16x32_bf16 v[56:59], a[176:179], a[144:147], v[56:59]
    v_mfma_f32_16x16x32_bf16 v[76:79], a[176:179], a[148:151], v[76:79]
    s_waitcnt lgkmcnt(10)
    v_mfma_f32_16x16x32_bf16 v[60:63], a[180:183], a[144:147], v[60:63]
    v_mfma_f32_16x16x32_bf16 v[80:83], a[180:183], a[148:151], v[80:83]
    v_mfma_f32_16x16x32_bf16 v[64:67], a[184:187], a[144:147], v[64:67]
    v_mfma_f32_16x16x32_bf16 v[84:87], a[184:187], a[148:151], v[84:87]
    s_waitcnt lgkmcnt(6)
    v_mfma_f32_16x16x32_bf16 v[48:51], a[188:191], a[152:155], v[48:51]
    v_mfma_f32_16x16x32_bf16 v[68:71], a[188:191], a[156:159], v[68:71]
    v_mfma_f32_16x16x32_bf16 v[52:55], a[160:163], a[152:155], v[52:55]
    v_mfma_f32_16x16x32_bf16 v[72:75], a[160:163], a[156:159], v[72:75]
    s_waitcnt lgkmcnt(2)
    v_mfma_f32_16x16x32_bf16 v[56:59], a[164:167], a[152:155], v[56:59]
    v_mfma_f32_16x16x32_bf16 v[76:79], a[164:167], a[156:159], v[76:79]
    v_mfma_f32_16x16x32_bf16 v[60:63], a[168:171], a[152:155], v[60:63]
    v_mfma_f32_16x16x32_bf16 v[80:83], a[168:171], a[156:159], v[80:83]
    s_waitcnt lgkmcnt(0)
    v_mfma_f32_16x16x32_bf16 v[64:67], a[172:175], a[152:155], v[64:67]
    v_mfma_f32_16x16x32_bf16 v[84:87], a[172:175], a[156:159], v[84:87]
    v_cvt_pk_bf16_f32 v88, v48, v49
    v_cvt_pk_bf16_f32 v100, v68, v69
    v_cvt_pk_bf16_f32 v89, v50, v51
    v_cvt_pk_bf16_f32 v101, v70, v71
    v_cvt_pk_bf16_f32 v90, v52, v53
    v_cvt_pk_bf16_f32 v102, v72, v73
    v_cvt_pk_bf16_f32 v91, v54, v55
    v_cvt_pk_bf16_f32 v103, v74, v75
    v_cvt_pk_bf16_f32 v92, v56, v57
    v_cvt_pk_bf16_f32 v104, v76, v77
    v_cvt_pk_bf16_f32 v93, v58, v59
    v_cvt_pk_bf16_f32 v105, v78, v79
    v_cvt_pk_bf16_f32 v94, v60, v61
    v_cvt_pk_bf16_f32 v106, v80, v81
    v_cvt_pk_bf16_f32 v95, v62, v63
    v_cvt_pk_bf16_f32 v107, v82, v83
    v_cvt_pk_bf16_f32 v96, v64, v65
    v_cvt_pk_bf16_f32 v108, v84, v85
    v_cvt_pk_bf16_f32 v97, v66, v67
    v_cvt_pk_bf16_f32 v109, v86, v87
    v_mfma_f32_16x16x32_bf16 v[140:143], v[112:115], v[88:91], 0
    v_mfma_f32_16x16x32_bf16 v[144:147], v[116:119], v[90:93], 0
    v_mfma_f32_16x16x32_bf16 v[148:151], v[120:123], v[92:95], 0
    v_mfma_f32_16x16x32_bf16 v[152:155], v[124:127], v[94:97], 0
    v_mfma_f32_16x16x32_bf16 v[160:163], v[112:115], v[100:103], 0
    v_mfma_f32_16x16x32_bf16 v[164:167], v[116:119], v[102:105], 0
    v_mfma_f32_16x16x32_bf16 v[168:171], v[120:123], v[104:107], 0
    v_mfma_f32_16x16x32_bf16 v[172:175], v[124:127], v[106:109], 0
    v_mfma_f32_16x16x32_bf16 v[156:159], v[128:131], v[88:91], 0
    v_mfma_f32_16x16x32_bf16 v[176:179], v[128:131], v[100:103], 0
    v_mfma_f32_16x16x32_bf16 v[156:159], v[132:135], v[92:95], v[156:159]
    v_mfma_f32_16x16x32_bf16 v[176:179], v[132:135], v[104:107], v[176:179]
    v_mfma_f32_16x16x32_bf16 v[156:159], v[136:139], v[96:99], v[156:159]
    v_mfma_f32_16x16x32_bf16 v[176:179], v[136:139], v[108:111], v[176:179]
    s_mov_b32 s52, 0
    s_waitcnt vmcnt(0)
    v_cmp_ne_u32 vcc, s43, v9
    s_cbranch_vccnz Lno_9
    s_mul_i32 s3, s30, 13568
    s_add_u32 s3, s3, 7340032
    buffer_load_dwordx4 v[48:51], v232, s[16:19], s3 offen sc1
    buffer_load_dwordx4 v[52:55], v233, s[16:19], s3 offen sc1
    buffer_load_dwordx4 v[56:59], v234, s[16:19], s3 offen sc1
    buffer_load_dwordx4 v[60:63], v235, s[16:19], s3 offen sc1
    s_mov_b32 s52, 1
Lno_9:
    v_max3_f32 v16, v140, v141, v142
    v_max3_f32 v32, v160, v161, v162
    v_min3_f32 v21, v140, v141, v142
    v_min3_f32 v37, v160, v161, v162
    v_max3_f32 v17, v144, v145, v146
    v_max3_f32 v33, v164, v165, v166
    v_min3_f32 v22, v144, v145, v146
    v_min3_f32 v38, v164, v165, v166
    v_max3_f32 v18, v148, v149, v150
    v_max3_f32 v34, v168, v169, v170
    v_min3_f32 v23, v148, v149, v150
    v_min3_f32 v39, v168, v169, v170
    v_max3_f32 v19, v152, v153, v154
    v_max3_f32 v35, v172, v173, v174
    v_min3_f32 v24, v152, v153, v154
    v_min3_f32 v40, v172, v173, v174
    v_max3_f32 v20, v156, v157, v158
    v_max3_f32 v36, v176, v177, v178
    v_min3_f32 v25, v156, v157, v158
    v_min3_f32 v41, v176, v177, v178
    v_max_f32 v16, v16, v143
    v_max_f32 v32, v32, v163
    v_min_f32 v21, v21, v143
    v_min_f32 v37, v37, v163
    v_max_f32 v17, v17, v147
    v_max_f32 v33, v33, v167
    v_min_f32 v22, v22, v147
    v_min_f32 v38, v38, v167
    v_max_f32 v18, v18, v151
    v_max_f32 v34, v34, v171
    v_min_f32 v23, v23, v151
    v_min_f32 v39, v39, v171
    v_max_f32 v19, v19, v155
    v_max_f32 v35, v35, v175
    v_min_f32 v24, v24, v155
    v_min_f32 v40, v40, v175
    v_max_f32 v20, v20, v159
    v_max_f32 v36, v36, v179
    v_min_f32 v25, v25, v159
    v_min_f32 v41, v41, v179
    v_permlane32_swap_b32 v16, v18
    v_permlane32_swap_b32 v32, v34
    v_permlane32_swap_b32 v17, v19
    v_permlane32_swap_b32 v33, v35
    v_permlane32_swap_b32 v21, v23
    v_permlane32_swap_b32 v37, v39
    v_permlane32_swap_b32 v22, v24
    v_permlane32_swap_b32 v38, v40
    v_max_f32 v16, v16, v18
    v_max_f32 v32, v32, v34
    v_max_f32 v17, v17, v19
    v_max_f32 v33, v33, v35
    v_min_f32 v21, v21, v23
    v_min_f32 v37, v37, v39
    v_min_f32 v22, v22, v24
    v_min_f32 v38, v38, v40
    v_permlane16_swap_b32 v16, v17
    v_permlane16_swap_b32 v32, v33
    v_permlane16_swap_b32 v21, v22
    v_permlane16_swap_b32 v37, v38
    v_max_f32 v26, v16, v17
    v_max_f32 v42, v32, v33
    v_min_f32 v27, v21, v22
    v_min_f32 v43, v37, v38
    v_max_f32 v26, v26, v20
    v_max_f32 v42, v42, v36
    v_min_f32 v27, v27, v25
    v_min_f32 v43, v43, v41
    v_mul_f32 v26, s48, v26
    v_mul_f32 v42, s48, v42
    v_mul_f32 v27, s48, v27
    v_mul_f32 v43, s48, v43
    v_mov_b32 v28, v26
    v_mov_b32 v44, v42
    v_mov_b32 v29, v26
    v_mov_b32 v45, v42
    v_mov_b32 v88, v27
    v_mov_b32 v100, v43
    v_mov_b32 v89, v27
    v_mov_b32 v101, v43
    v_permlane16_swap_b32 v28, v29
    v_permlane16_swap_b32 v44, v45
    v_permlane16_swap_b32 v88, v89
    v_permlane16_swap_b32 v100, v101
    v_mov_b32 v30, v28
    v_mov_b32 v46, v44
    v_mov_b32 v31, v29
    v_mov_b32 v47, v45
    v_mov_b32 v90, v88
    v_mov_b32 v102, v100
    v_mov_b32 v91, v89
    v_mov_b32 v103, v101
    v_permlane32_swap_b32 v28, v30
    v_permlane32_swap_b32 v44, v46
    v_permlane32_swap_b32 v29, v31
    v_permlane32_swap_b32 v45, v47
    v_permlane32_swap_b32 v88, v90
    v_permlane32_swap_b32 v100, v102
    v_permlane32_swap_b32 v89, v91
    v_permlane32_swap_b32 v101, v103
    v_pk_fma_f32 v[196:197], v[156:157], s[48:49], v[26:27] op_sel:[0,0,0] op_sel_hi:[1,1,0] neg_lo:[0,0,1] neg_hi:[0,0,1]
    v_pk_fma_f32 v[216:217], v[176:177], s[48:49], v[42:43] op_sel:[0,0,0] op_sel_hi:[1,1,0] neg_lo:[0,0,1] neg_hi:[0,0,1]
    v_pk_fma_f32 v[156:157], v[156:157], s[48:49], v[26:27] op_sel:[0,0,1] op_sel_hi:[1,1,1] neg_lo:[1,0,0] neg_hi:[1,0,0]
    v_pk_fma_f32 v[176:177], v[176:177], s[48:49], v[42:43] op_sel:[0,0,1] op_sel_hi:[1,1,1] neg_lo:[1,0,0] neg_hi:[1,0,0]
    v_pk_fma_f32 v[198:199], v[158:159], s[48:49], v[26:27] op_sel:[0,0,0] op_sel_hi:[1,1,0] neg_lo:[0,0,1] neg_hi:[0,0,1]
    v_pk_fma_f32 v[218:219], v[178:179], s[48:49], v[42:43] op_sel:[0,0,0] op_sel_hi:[1,1,0] neg_lo:[0,0,1] neg_hi:[0,0,1]
    v_pk_fma_f32 v[158:159], v[158:159], s[48:49], v[26:27] op_sel:[0,0,1] op_sel_hi:[1,1,1] neg_lo:[1,0,0] neg_hi:[1,0,0]
    v_pk_fma_f32 v[178:179], v[178:179], s[48:49], v[42:43] op_sel:[0,0,1] op_sel_hi:[1,1,1] neg_lo:[1,0,0] neg_hi:[1,0,0]
    v_pk_fma_f32 v[180:181], v[140:141], s[48:49], v[28:29] op_sel:[0,0,0] op_sel_hi:[1,1,0] neg_lo:[0,0,1] neg_hi:[0,0,1]
    v_pk_fma_f32 v[200:201], v[160:161], s[48:49], v[44:45] op_sel:[0,0,0] op_sel_hi:[1,1,0] neg_lo:[0,0,1] neg_hi:[0,0,1]
    v_pk_fma_f32 v[140:141], v[140:141], s[48:49], v[88:89] op_sel:[0,0,0] op_sel_hi:[1,1,0] neg_lo:[1,0,0] neg_hi:[1,0,0]
    v_pk_fma_f32 v[160:161], v[160:161], s[48:49], v[100:101] op_sel:[0,0,0] op_sel_hi:[1,1,0] neg_lo:[1,0,0] neg_hi:[1,0,0]
    v_pk_fma_f32 v[182:183], v[142:143], s[48:49], v[28:29] op_sel:[0,0,0] op_sel_hi:[1,1,0] neg_lo:[0,0,1] neg_hi:[0,0,1]
    v_pk_fma_f32 v[202:203], v[162:163], s[48:49], v[44:45] op_sel:[0,0,0] op_sel_hi:[1,1,0] neg_lo:[0,0,1] neg_hi:[0,0,1]
    v_pk_fma_f32 v[142:143], v[142:143], s[48:49], v[88:89] op_sel:[0,0,0] op_sel_hi:[1,1,0] neg_lo:[1,0,0] neg_hi:[1,0,0]
    v_pk_fma_f32 v[162:163], v[162:163], s[48:49], v[100:101] op_sel:[0,0,0] op_sel_hi:[1,1,0] neg_lo:[1,0,0] neg_hi:[1,0,0]
    v_pk_fma_f32 v[184:185], v[144:145], s[48:49], v[28:29] op_sel:[0,0,1] op_sel_hi:[1,1,1] neg_lo:[0,0,1] neg_hi:[0,0,1]
    v_pk_fma_f32 v[204:205], v[164:165], s[48:49], v[44:45] op_sel:[0,0,1] op_sel_hi:[1,1,1] neg_lo:[0,0,1] neg_hi:[0,0,1]
    v_pk_fma_f32 v[144:145], v[144:145], s[48:49], v[88:89] op_sel:[0,0,1] op_sel_hi:[1,1,1] neg_lo:[1,0,0] neg_hi:[1,0,0]
    v_pk_fma_f32 v[164:165], v[164:165], s[48:49], v[100:101] op_sel:[0,0,1] op_sel_hi:[1,1,1] neg_lo:[1,0,0] neg_hi:[1,0,0]
    v_pk_fma_f32 v[186:187], v[146:147], s[48:49], v[28:29] op_sel:[0,0,1] op_sel_hi:[1,1,1] neg_lo:[0,0,1] neg_hi:[0,0,1]
    v_pk_fma_f32 v[206:207], v[166:167], s[48:49], v[44:45] op_sel:[0,0,1] op_sel_hi:[1,1,1] neg_lo:[0,0,1] neg_hi:[0,0,1]
    v_pk_fma_f32 v[146:147], v[146:147], s[48:49], v[88:89] op_sel:[0,0,1] op_sel_hi:[1,1,1] neg_lo:[1,0,0] neg_hi:[1,0,0]
    v_pk_fma_f32 v[166:167], v[166:167], s[48:49], v[100:101] op_sel:[0,0,1] op_sel_hi:[1,1,1] neg_lo:[1,0,0] neg_hi:[1,0,0]
    v_pk_fma_f32 v[188:189], v[148:149], s[48:49], v[30:31] op_sel:[0,0,0] op_sel_hi:[1,1,0] neg_lo:[0,0,1] neg_hi:[0,0,1]
    v_pk_fma_f32 v[208:209], v[168:169], s[48:49], v[46:47] op_sel:[0,0,0] op_sel_hi:[1,1,0] neg_lo:[0,0,1] neg_hi:[0,0,1]
    v_pk_fma_f32 v[148:149], v[148:149], s[48:49], v[90:91] op_sel:[0,0,0] op_sel_hi:[1,1,0] neg_lo:[1,0,0] neg_hi:[1,0,0]
    v_pk_fma_f32 v[168:169], v[168:169], s[48:49], v[102:103] op_sel:[0,0,0] op_sel_hi:[1,1,0] neg_lo:[1,0,0] neg_hi:[1,0,0]
    v_pk_fma_f32 v[190:191], v[150:151], s[48:49], v[30:31] op_sel:[0,0,0] op_sel_hi:[1,1,0] neg_lo:[0,0,1] neg_hi:[0,0,1]
    v_pk_fma_f32 v[210:211], v[170:171], s[48:49], v[46:47] op_sel:[0,0,0] op_sel_hi:[1,1,0] neg_lo:[0,0,1] neg_hi:[0,0,1]
    v_pk_fma_f32 v[150:151], v[150:151], s[48:49], v[90:91] op_sel:[0,0,0] op_sel_hi:[1,1,0] neg_lo:[1,0,0] neg_hi:[1,0,0]
    v_pk_fma_f32 v[170:171], v[170:171], s[48:49], v[102:103] op_sel:[0,0,0] op_sel_hi:[1,1,0] neg_lo:[1,0,0] neg_hi:[1,0,0]
    v_pk_fma_f32 v[192:193], v[152:153], s[48:49], v[30:31] op_sel:[0,0,1] op_sel_hi:[1,1,1] neg_lo:[0,0,1] neg_hi:[0,0,1]
    v_pk_fma_f32 v[212:213], v[172:173], s[48:49], v[46:47] op_sel:[0,0,1] op_sel_hi:[1,1,1] neg_lo:[0,0,1] neg_hi:[0,0,1]
    v_pk_fma_f32 v[152:153], v[152:153], s[48:49], v[90:91] op_sel:[0,0,1] op_sel_hi:[1,1,1] neg_lo:[1,0,0] neg_hi:[1,0,0]
    v_pk_fma_f32 v[172:173], v[172:173], s[48:49], v[102:103] op_sel:[0,0,1] op_sel_hi:[1,1,1] neg_lo:[1,0,0] neg_hi:[1,0,0]
    v_pk_fma_f32 v[194:195], v[154:155], s[48:49], v[30:31] op_sel:[0,0,1] op_sel_hi:[1,1,1] neg_lo:[0,0,1] neg_hi:[0,0,1]
    v_pk_fma_f32 v[214:215], v[174:175], s[48:49], v[46:47] op_sel:[0,0,1] op_sel_hi:[1,1,1] neg_lo:[0,0,1] neg_hi:[0,0,1]
    v_pk_fma_f32 v[154:155], v[154:155], s[48:49], v[90:91] op_sel:[0,0,1] op_sel_hi:[1,1,1] neg_lo:[1,0,0] neg_hi:[1,0,0]
    v_pk_fma_f32 v[174:175], v[174:175], s[48:49], v[102:103] op_sel:[0,0,1] op_sel_hi:[1,1,1] neg_lo:[1,0,0] neg_hi:[1,0,0]
    v_exp_f32 v180, v180
    v_exp_f32 v200, v200
    v_exp_f32 v140, v140
    v_exp_f32 v160, v160
    v_exp_f32 v181, v181
    v_exp_f32 v201, v201
    v_exp_f32 v141, v141
    v_exp_f32 v161, v161
    v_exp_f32 v182, v182
    v_exp_f32 v202, v202
    v_exp_f32 v142, v142
    v_exp_f32 v162, v162
    v_exp_f32 v183, v183
    v_exp_f32 v203, v203
    v_exp_f32 v143, v143
    v_exp_f32 v163, v163
    v_exp_f32 v184, v184
    v_exp_f32 v204, v204
    v_exp_f32 v144, v144
    v_exp_f32 v164, v164
    v_exp_f32 v185, v185
    v_exp_f32 v205, v205
    v_exp_f32 v145, v145
    v_exp_f32 v165, v165
    v_exp_f32 v186, v186
    v_exp_f32 v206, v206
    v_exp_f32 v146, v146
    v_exp_f32 v166, v166
    v_exp_f32 v187, v187
    v_exp_f32 v207, v207
    v_exp_f32 v147, v147
    v_exp_f32 v167, v167
    v_exp_f32 v188, v188
    v_exp_f32 v208, v208
    v_exp_f32 v148, v148
    v_exp_f32 v168, v168
    v_exp_f32 v189, v189
    v_exp_f32 v209, v209
    v_exp_f32 v149, v149
    v_exp_f32 v169, v169
    v_exp_f32 v190, v190
    v_exp_f32 v210, v210
    v_exp_f32 v150, v150
    s_cmp_eq_u32 s52, 1
    s_cbranch_scc1 Lh2_11
    s_lshl_b32 s6, s30, 11
    s_add_u32 s6, s6, 9453568
    v_lshlrev_b32 v13, 7, v0
    s_mov_b32 s68, 0xffff
    s_mov_b32 s69, 0x0
    s_mov_b64 exec, s[68:69]
    s_mov_b32 s66, 0
Lpoll_12:
    buffer_load_dword v14, v13, s[16:19], s6 offen sc1
    s_waitcnt vmcnt(0)
    v_cmp_ne_u32 vcc, s43, v14
    s_cbranch_vccz Lpd_13
    s_add_u32 s66, s66, 1
    s_cmp_lt_u32 s66, 0x40000
    s_cbranch_scc1 Lpoll_12
Lpd_13:
    s_mov_b64 exec, -1
    s_mul_i32 s3, s30, 13568
    s_add_u32 s3, s3, 7340032
    buffer_load_dwordx4 v[48:51], v232, s[16:19], s3 offen sc1
    buffer_load_dwordx4 v[52:55], v233, s[16:19], s3 offen sc1
    buffer_load_dwordx4 v[56:59], v234, s[16:19], s3 offen sc1
    buffer_load_dwordx4 v[60:63], v235, s[16:19], s3 offen sc1
Lh2_11:
    v_exp_f32 v170, v170
    v_exp_f32 v191, v191
    v_exp_f32 v211, v211
    v_exp_f32 v151, v151
    v_exp_f32 v171, v171
    v_exp_f32 v192, v192
    v_exp_f32 v212, v212
    v_exp_f32 v152, v152
    v_exp_f32 v172, v172
    v_exp_f32 v193, v193
    v_exp_f32 v213, v213
    v_exp_f32 v153, v153
    v_exp_f32 v173, v173
    v_exp_f32 v194, v194
    v_exp_f32 v214, v214
    v_exp_f32 v154, v154
    v_exp_f32 v174, v174
    v_exp_f32 v195, v195
    v_exp_f32 v215, v215
    v_exp_f32 v155, v155
    v_exp_f32 v175, v175
    v_exp_f32 v196, v196
    v_exp_f32 v216, v216
    v_exp_f32 v156, v156
    v_exp_f32 v176, v176
    v_exp_f32 v197, v197
    v_exp_f32 v217, v217
    v_exp_f32 v157, v157
    v_exp_f32 v177, v177
    v_exp_f32 v198, v198
    v_exp_f32 v218, v218
    v_exp_f32 v158, v158
    v_exp_f32 v178, v178
    v_exp_f32 v199, v199
    v_exp_f32 v219, v219
    v_exp_f32 v159, v159
    v_exp_f32 v179, v179
    v_pk_add_f32 v[92:93], v[180:181], v[182:183]
    v_pk_add_f32 v[104:105], v[200:201], v[202:203]
    v_pk_add_f32 v[94:95], v[184:185], v[186:187]
    v_pk_add_f32 v[106:107], v[204:205], v[206:207]
    v_pk_add_f32 v[96:97], v[188:189], v[190:191]
    v_pk_add_f32 v[108:109], v[208:209], v[210:211]
    v_pk_add_f32 v[28:29], v[192:193], v[194:195]
    v_pk_add_f32 v[44:45], v[212:213], v[214:215]
    v_pk_add_f32 v[30:31], v[196:197], v[198:199]
    v_pk_add_f32 v[46:47], v[216:217], v[218:219]
    v_add_f32 v16, v92, v93
    v_add_f32 v32, v104, v105
    v_add_f32 v17, v94, v95
    v_add_f32 v33, v106, v107
    v_add_f32 v18, v96, v97
    v_add_f32 v34, v108, v109
    v_add_f32 v19, v28, v29
    v_add_f32 v35, v44, v45
    v_add_f32 v20, v30, v31
    v_add_f32 v36, v46, v47
    v_pk_add_f32 v[92:93], v[140:141], v[142:143]
    v_pk_add_f32 v[104:105], v[160:161], v[162:163]
    v_pk_add_f32 v[94:95], v[144:145], v[146:147]
    v_pk_add_f32 v[106:107], v[164:165], v[166:167]
    v_pk_add_f32 v[96:97], v[148:149], v[150:151]
    v_pk_add_f32 v[108:109], v[168:169], v[170:171]
    v_pk_add_f32 v[28:29], v[152:153], v[154:155]
    v_pk_add_f32 v[44:45], v[172:173], v[174:175]
    v_pk_add_f32 v[30:31], v[156:157], v[158:159]
    v_pk_add_f32 v[46:47], v[176:177], v[178:179]
    v_add_f32 v21, v92, v93
    v_add_f32 v37, v104, v105
    v_add_f32 v22, v94, v95
    v_add_f32 v38, v106, v107
    v_add_f32 v23, v96, v97
    v_add_f32 v39, v108, v109
    v_add_f32 v24, v28, v29
    v_add_f32 v40, v44, v45
    v_add_f32 v25, v30, v31
    v_add_f32 v41, v46, v47
    v_permlane32_swap_b32 v16, v18
    v_permlane32_swap_b32 v32, v34
    v_permlane32_swap_b32 v17, v19
    v_permlane32_swap_b32 v33, v35
    v_permlane32_swap_b32 v21, v23
    v_permlane32_swap_b32 v37, v39
    v_permlane32_swap_b32 v22, v24
    v_permlane32_swap_b32 v38, v40
    v_add_f32 v16, v16, v18
    v_add_f32 v32, v32, v34
    v_add_f32 v17, v17, v19
    v_add_f32 v33, v33, v35
    v_add_f32 v21, v21, v23
    v_add_f32 v37, v37, v39
    v_add_f32 v22, v22, v24
    v_add_f32 v38, v38, v40
    v_permlane16_swap_b32 v16, v17
    v_permlane16_swap_b32 v32, v33
    v_permlane16_swap_b32 v21, v22
    v_permlane16_swap_b32 v37, v38
    v_add_f32 v26, v16, v17
    v_add_f32 v42, v32, v33
    v_add_f32 v27, v21, v22
    v_add_f32 v43, v37, v38
    v_add_f32 v26, v26, v20
    v_add_f32 v42, v42, v36
    v_add_f32 v27, v27, v25
    v_add_f32 v43, v43, v41
    v_rcp_f32 v27, v27
    v_rcp_f32 v43, v43
    v_mul_f32 v27, v27, v26
    v_mul_f32 v43, v43, v42
    v_mov_b32 v88, v27
    v_mov_b32 v100, v43
    v_mov_b32 v89, v27
    v_mov_b32 v101, v43
    s_nop 0
    v_permlane16_swap_b32 v88, v89
    v_permlane16_swap_b32 v100, v101
    v_mov_b32 v90, v88
    v_mov_b32 v102, v100
    v_mov_b32 v91, v89
    v_mov_b32 v103, v101
    v_permlane32_swap_b32 v88, v90
    v_permlane32_swap_b32 v100, v102
    v_permlane32_swap_b32 v89, v91
    v_permlane32_swap_b32 v101, v103
    v_pk_mul_f32 v[156:157], v[156:157], v[26:27] op_sel:[0,1] op_sel_hi:[1,1]
    v_pk_mul_f32 v[176:177], v[176:177], v[42:43] op_sel:[0,1] op_sel_hi:[1,1]
    v_pk_mul_f32 v[158:159], v[158:159], v[26:27] op_sel:[0,1] op_sel_hi:[1,1]
    v_pk_mul_f32 v[178:179], v[178:179], v[42:43] op_sel:[0,1] op_sel_hi:[1,1]
    v_pk_mul_f32 v[140:141], v[140:141], v[88:89] op_sel:[0,0] op_sel_hi:[1,0]
    v_pk_mul_f32 v[160:161], v[160:161], v[100:101] op_sel:[0,0] op_sel_hi:[1,0]
    v_pk_mul_f32 v[142:143], v[142:143], v[88:89] op_sel:[0,0] op_sel_hi:[1,0]
    v_pk_mul_f32 v[162:163], v[162:163], v[100:101] op_sel:[0,0] op_sel_hi:[1,0]
    v_pk_mul_f32 v[144:145], v[144:145], v[88:89] op_sel:[0,1] op_sel_hi:[1,1]
    v_pk_mul_f32 v[164:165], v[164:165], v[100:101] op_sel:[0,1] op_sel_hi:[1,1]
    v_pk_mul_f32 v[146:147], v[146:147], v[88:89] op_sel:[0,1] op_sel_hi:[1,1]
    v_pk_mul_f32 v[166:167], v[166:167], v[100:101] op_sel:[0,1] op_sel_hi:[1,1]
    v_pk_mul_f32 v[148:149], v[148:149], v[90:91] op_sel:[0,0] op_sel_hi:[1,0]
    v_pk_mul_f32 v[168:169], v[168:169], v[102:103] op_sel:[0,0] op_sel_hi:[1,0]
    v_pk_mul_f32 v[150:151], v[150:151], v[90:91] op_sel:[0,0] op_sel_hi:[1,0]
    v_pk_mul_f32 v[170:171], v[170:171], v[102:103] op_sel:[0,0] op_sel_hi:[1,0]
    v_pk_mul_f32 v[152:153], v[152:153], v[90:91] op_sel:[0,1] op_sel_hi:[1,1]
    v_pk_mul_f32 v[172:173], v[172:173], v[102:103] op_sel:[0,1] op_sel_hi:[1,1]
    v_pk_mul_f32 v[154:155], v[154:155], v[90:91] op_sel:[0,1] op_sel_hi:[1,1]
    v_pk_mul_f32 v[174:175], v[174:175], v[102:103] op_sel:[0,1] op_sel_hi:[1,1]
    s_waitcnt vmcnt(0)
    v_add_f32 v60, v251, v60
    v_add_f32 v61, v251, v61
    v_add_f32 v62, v251, v62
    v_add_f32 v63, v251, v63
    v_cvt_pk_bf16_f32 v48, v48, v49
    v_cvt_pk_bf16_f32 v49, v50, v51
    ds_write_b64 v236, v[48:49]
    v_cvt_pk_bf16_f32 v52, v52, v53
    v_cvt_pk_bf16_f32 v53, v54, v55
    ds_write_b64 v237, v[52:53]
    v_cvt_pk_bf16_f32 v56, v56, v57
    v_cvt_pk_bf16_f32 v57, v58, v59
    ds_write_b64 v238, v[56:57]
    v_cvt_pk_bf16_f32 v60, v60, v61
    v_cvt_pk_bf16_f32 v61, v62, v63
    ds_write_b64 v239, v[60:61]
    v_cvt_pk_bf16_f32 v143, v142, v143
    v_cvt_pk_bf16_f32 v163, v162, v163
    v_cvt_pk_bf16_f32 v142, v140, v141
    v_cvt_pk_bf16_f32 v162, v160, v161
    v_cvt_pk_bf16_f32 v140, v180, v181
    v_cvt_pk_bf16_f32 v160, v200, v201
    v_cvt_pk_bf16_f32 v141, v182, v183
    v_cvt_pk_bf16_f32 v161, v202, v203
    v_cvt_pk_bf16_f32 v147, v146, v147
    v_cvt_pk_bf16_f32 v167, v166, v167
    v_cvt_pk_bf16_f32 v146, v144, v145
    v_cvt_pk_bf16_f32 v166, v164, v165
    v_cvt_pk_bf16_f32 v144, v184, v185
    v_cvt_pk_bf16_f32 v164, v204, v205
    v_cvt_pk_bf16_f32 v145, v186, v187
    v_cvt_pk_bf16_f32 v165, v206, v207
    v_cvt_pk_bf16_f32 v151, v150, v151
    v_cvt_pk_bf16_f32 v171, v170, v171
    v_cvt_pk_bf16_f32 v150, v148, v149
    v_cvt_pk_bf16_f32 v170, v168, v169
    s_waitcnt lgkmcnt(0)
    s_barrier
    ds_read_b128 a[20:23], v242
    ds_read_b128 a[24:27], v243
    ds_read_b128 a[28:31], v244
    ds_read_b128 a[32:35], v245
    ds_read_b128 a[36:39], v246
    ds_read_b128 a[40:43], v241 offset:6400
    ds_read_b128 a[44:47], v241 offset:6464
    ds_read_b128 a[48:51], v241 offset:6528
    ds_read_b128 a[52:55], v241 offset:6592
    ds_read_b128 a[56:59], v247
    ds_read_b128 a[60:63], v248
    ds_read_b128 a[64:67], v249
    ds_read_b128 a[68:71], v250
    ds_read_b128 a[0:3], v240 offset:0
    ds_read_b128 a[4:7], v240 offset:1024
    ds_read_b128 a[8:11], v240 offset:2048
    ds_read_b128 a[12:15], v240 offset:3072
    ds_read_b128 a[16:19], v240 offset:4096
    v_cvt_pk_bf16_f32 v148, v188, v189
    v_cvt_pk_bf16_f32 v168, v208, v209
    v_cvt_pk_bf16_f32 v149, v190, v191
    v_cvt_pk_bf16_f32 v169, v210, v211
    v_cvt_pk_bf16_f32 v155, v154, v155
    v_cvt_pk_bf16_f32 v175, v174, v175
    v_cvt_pk_bf16_f32 v154, v152, v153
    v_cvt_pk_bf16_f32 v174, v172, v173
    v_cvt_pk_bf16_f32 v152, v192, v193
    v_cvt_pk_bf16_f32 v172, v212, v213
    v_cvt_pk_bf16_f32 v153, v194, v195
    v_cvt_pk_bf16_f32 v173, v214, v215
    v_cvt_pk_bf16_f32 v159, v158, v159
    v_cvt_pk_bf16_f32 v179, v178, v179
    v_cvt_pk_bf16_f32 v158, v156, v157
    v_cvt_pk_bf16_f32 v178, v176, v177
    v_cvt_pk_bf16_f32 v156, v196, v197
    v_cvt_pk_bf16_f32 v176, v216, v217
    v_cvt_pk_bf16_f32 v157, v198, v199
    v_cvt_pk_bf16_f32 v177, v218, v219
    s_waitcnt lgkmcnt(13)
    v_mfma_f32_16x16x32_bf16 v[180:183], a[20:23], v[156:159], 0
    v_mfma_f32_16x16x32_bf16 v[184:187], a[24:27], v[156:159], 0
    v_mfma_f32_16x16x32_bf16 v[188:191], a[28:31], v[156:159], 0
    v_mfma_f32_16x16x32_bf16 v[192:195], a[32:35], v[156:159], 0
    v_mfma_f32_16x16x32_bf16 v[196:199], a[36:39], v[156:159], 0
    v_mfma_f32_16x16x32_bf16 v[200:203], a[20:23], v[176:179], 0
    v_mfma_f32_16x16x32_bf16 v[204:207], a[24:27], v[176:179], 0
    v_mfma_f32_16x16x32_bf16 v[208:211], a[28:31], v[176:179], 0
    v_mfma_f32_16x16x32_bf16 v[212:215], a[32:35], v[176:179], 0
    v_mfma_f32_16x16x32_bf16 v[216:219], a[36:39], v[176:179], 0
    s_waitcnt lgkmcnt(9)
    v_mfma_f32_16x16x32_bf16 v[16:19], a[40:43], v[140:143], 0
    v_mfma_f32_16x16x32_bf16 v[20:23], a[44:47], v[144:147], 0
    v_mfma_f32_16x16x32_bf16 v[24:27], a[48:51], v[148:151], 0
    v_mfma_f32_16x16x32_bf16 v[28:31], a[52:55], v[152:155], 0
    v_mfma_f32_16x16x32_bf16 v[32:35], a[40:43], v[160:163], 0
    v_mfma_f32_16x16x32_bf16 v[36:39], a[44:47], v[164:167], 0
    v_mfma_f32_16x16x32_bf16 v[40:43], a[48:51], v[168:171], 0
    v_mfma_f32_16x16x32_bf16 v[44:47], a[52:55], v[172:175], 0
    s_waitcnt lgkmcnt(5)
    v_mfma_f32_16x16x32_bf16 v[16:19], a[56:59], v[156:159], v[16:19]
    v_mfma_f32_16x16x32_bf16 v[20:23], a[60:63], v[156:159], v[20:23]
    v_mfma_f32_16x16x32_bf16 v[24:27], a[64:67], v[156:159], v[24:27]
    v_mfma_f32_16x16x32_bf16 v[28:31], a[68:71], v[156:159], v[28:31]
    v_mfma_f32_16x16x32_bf16 v[32:35], a[56:59], v[176:179], v[32:35]
    v_mfma_f32_16x16x32_bf16 v[36:39], a[60:63], v[176:179], v[36:39]
    v_mfma_f32_16x16x32_bf16 v[40:43], a[64:67], v[176:179], v[40:43]
    v_mfma_f32_16x16x32_bf16 v[44:47], a[68:71], v[176:179], v[44:47]
    s_waitcnt lgkmcnt(0)
    v_mfma_f32_16x16x32_bf16 v[48:51], a[0:3], v[140:143], v[180:183]
    v_mfma_f32_16x16x32_bf16 v[112:115], a[4:7], v[140:143], v[184:187]
    v_mfma_f32_16x16x32_bf16 v[52:55], a[4:7], v[144:147], v[184:187]
    v_mfma_f32_16x16x32_bf16 v[116:119], a[8:11], v[144:147], v[188:191]
    v_mfma_f32_16x16x32_bf16 v[56:59], a[8:11], v[148:151], v[188:191]
    v_mfma_f32_16x16x32_bf16 v[120:123], a[12:15], v[148:151], v[192:195]
    v_mfma_f32_16x16x32_bf16 v[60:63], a[12:15], v[152:155], v[192:195]
    v_mfma_f32_16x16x32_bf16 v[124:127], a[16:19], v[152:155], v[196:199]
    v_rcp_f32 v16, v16
    v_rcp_f32 v20, v20
    v_rcp_f32 v24, v24
    v_rcp_f32 v28, v28
    v_rcp_f32 v32, v32
    v_rcp_f32 v36, v36
    v_rcp_f32 v40, v40
    v_rcp_f32 v44, v44
    v_mfma_f32_16x16x32_bf16 v[68:71], a[0:3], v[160:163], v[200:203]
    v_mfma_f32_16x16x32_bf16 v[88:91], a[4:7], v[160:163], v[204:207]
    v_mfma_f32_16x16x32_bf16 v[72:75], a[4:7], v[164:167], v[204:207]
    v_mfma_f32_16x16x32_bf16 v[92:95], a[8:11], v[164:167], v[208:211]
    v_mfma_f32_16x16x32_bf16 v[76:79], a[8:11], v[168:171], v[208:211]
    v_mfma_f32_16x16x32_bf16 v[96:99], a[12:15], v[168:171], v[212:215]
    v_mfma_f32_16x16x32_bf16 v[80:83], a[12:15], v[172:175], v[212:215]
    v_mfma_f32_16x16x32_bf16 v[100:103], a[16:19], v[172:175], v[216:219]
    v_pk_mul_f32 v[48:49], v[48:49], v[16:17] op_sel:[0,0] op_sel_hi:[1,0]
    v_pk_mul_f32 v[50:51], v[50:51], v[16:17] op_sel:[0,0] op_sel_hi:[1,0]
    v_pk_mul_f32 v[112:113], v[112:113], v[16:17] op_sel:[0,0] op_sel_hi:[1,0]
    v_pk_mul_f32 v[114:115], v[114:115], v[16:17] op_sel:[0,0] op_sel_hi:[1,0]
    v_pk_mul_f32 v[52:53], v[52:53], v[20:21] op_sel:[0,0] op_sel_hi:[1,0]
    v_pk_mul_f32 v[54:55], v[54:55], v[20:21] op_sel:[0,0] op_sel_hi:[1,0]
    v_pk_mul_f32 v[116:117], v[116:117], v[20:21] op_sel:[0,0] op_sel_hi:[1,0]
    v_pk_mul_f32 v[118:119], v[118:119], v[20:21] op_sel:[0,0] op_sel_hi:[1,0]
    v_pk_mul_f32 v[56:57], v[56:57], v[24:25] op_sel:[0,0] op_sel_hi:[1,0]
    v_pk_mul_f32 v[58:59], v[58:59], v[24:25] op_sel:[0,0] op_sel_hi:[1,0]
    v_pk_mul_f32 v[120:121], v[120:121], v[24:25] op_sel:[0,0] op_sel_hi:[1,0]
    v_pk_mul_f32 v[122:123], v[122:123], v[24:25] op_sel:[0,0] op_sel_hi:[1,0]
    v_pk_mul_f32 v[60:61], v[60:61], v[28:29] op_sel:[0,0] op_sel_hi:[1,0]
    v_pk_mul_f32 v[62:63], v[62:63], v[28:29] op_sel:[0,0] op_sel_hi:[1,0]
    v_pk_mul_f32 v[124:125], v[124:125], v[28:29] op_sel:[0,0] op_sel_hi:[1,0]
    v_pk_mul_f32 v[126:127], v[126:127], v[28:29] op_sel:[0,0] op_sel_hi:[1,0]
    v_pk_mul_f32 v[68:69], v[68:69], v[32:33] op_sel:[0,0] op_sel_hi:[1,0]
    v_pk_mul_f32 v[70:71], v[70:71], v[32:33] op_sel:[0,0] op_sel_hi:[1,0]
    v_pk_mul_f32 v[88:89], v[88:89], v[32:33] op_sel:[0,0] op_sel_hi:[1,0]
    v_pk_mul_f32 v[90:91], v[90:91], v[32:33] op_sel:[0,0] op_sel_hi:[1,0]
    v_pk_mul_f32 v[72:73], v[72:73], v[36:37] op_sel:[0,0] op_sel_hi:[1,0]
    v_pk_mul_f32 v[74:75], v[74:75], v[36:37] op_sel:[0,0] op_sel_hi:[1,0]
    v_pk_mul_f32 v[92:93], v[92:93], v[36:37] op_sel:[0,0] op_sel_hi:[1,0]
    v_pk_mul_f32 v[94:95], v[94:95], v[36:37] op_sel:[0,0] op_sel_hi:[1,0]
    v_pk_mul_f32 v[76:77], v[76:77], v[40:41] op_sel:[0,0] op_sel_hi:[1,0]
    v_pk_mul_f32 v[78:79], v[78:79], v[40:41] op_sel:[0,0] op_sel_hi:[1,0]
    v_pk_mul_f32 v[96:97], v[96:97], v[40:41] op_sel:[0,0] op_sel_hi:[1,0]
    v_pk_mul_f32 v[98:99], v[98:99], v[40:41] op_sel:[0,0] op_sel_hi:[1,0]
    v_pk_mul_f32 v[80:81], v[80:81], v[44:45] op_sel:[0,0] op_sel_hi:[1,0]
    v_pk_mul_f32 v[82:83], v[82:83], v[44:45] op_sel:[0,0] op_sel_hi:[1,0]
    v_pk_mul_f32 v[100:101], v[100:101], v[44:45] op_sel:[0,0] op_sel_hi:[1,0]
    v_pk_mul_f32 v[102:103], v[102:103], v[44:45] op_sel:[0,0] op_sel_hi:[1,0]
    v_cvt_pk_bf16_f32 v140, v48, v49
    v_cvt_pk_bf16_f32 v160, v68, v69
    v_cvt_pk_bf16_f32 v141, v50, v51
    v_cvt_pk_bf16_f32 v161, v70, v71
    s_mov_b64 exec, s[54:55]
    v_cvt_pk_bf16_f32 v142, v52, v53
    v_cvt_pk_bf16_f32 v162, v72, v73
    v_cvt_pk_bf16_f32 v143, v54, v55
    v_cvt_pk_bf16_f32 v163, v74, v75
    s_mov_b64 exec, s[60:61]
    v_cvt_pk_bf16_f32 v142, v112, v113
    v_cvt_pk_bf16_f32 v162, v88, v89
    v_cvt_pk_bf16_f32 v143, v114, v115
    v_cvt_pk_bf16_f32 v163, v90, v91
    s_mov_b64 exec, s[56:57]
    v_cvt_pk_bf16_f32 v144, v56, v57
    v_cvt_pk_bf16_f32 v164, v76, v77
    v_cvt_pk_bf16_f32 v145, v58, v59
    v_cvt_pk_bf16_f32 v165, v78, v79
    s_mov_b64 exec, s[62:63]
    v_cvt_pk_bf16_f32 v144, v116, v117
    v_cvt_pk_bf16_f32 v164, v92, v93
    v_cvt_pk_bf16_f32 v145, v118, v119
    v_cvt_pk_bf16_f32 v165, v94, v95
    s_mov_b64 exec, s[58:59]
    v_cvt_pk_bf16_f32 v146, v60, v61
    v_cvt_pk_bf16_f32 v166, v80, v81
    v_cvt_pk_bf16_f32 v147, v62, v63
    v_cvt_pk_bf16_f32 v167, v82, v83
    s_mov_b64 exec, s[64:65]
    v_cvt_pk_bf16_f32 v146, v120, v121
    v_cvt_pk_bf16_f32 v166, v96, v97
    v_cvt_pk_bf16_f32 v147, v122, v123
    v_cvt_pk_bf16_f32 v167, v98, v99
    s_mov_b64 exec, -1
    v_cvt_pk_bf16_f32 v148, v124, v125
    v_cvt_pk_bf16_f32 v168, v100, v101
    v_cvt_pk_bf16_f32 v149, v126, v127
    v_cvt_pk_bf16_f32 v169, v102, v103
    s_lshl_b32 s3, s31, 4
    s_add_u32 s3, s3, s29
    s_lshl_b32 s3, s3, 2
    s_add_u32 s3, s3, s28
    s_mul_i32 s3, s3, 40960
    s_mul_i32 s4, s30, 2560
    s_add_u32 s3, s3, s4
    s_add_u32 s4, s3, 20480
    v_lshlrev_b32 v13, 4, v0
    v_lshlrev_b32 v14, 3, v0
    buffer_store_dwordx4 v[140:143], v13, s[16:19], s3 offen sc1
    buffer_store_dwordx4 v[144:147], v13, s[16:19], s3 offen offset:1024 sc1
    buffer_store_dwordx2 v[148:149], v14, s[16:19], s3 offen offset:2048 sc1
    buffer_store_dwordx4 v[160:163], v13, s[16:19], s4 offen sc1
    buffer_store_dwordx4 v[164:167], v13, s[16:19], s4 offen offset:1024 sc1
    buffer_store_dwordx2 v[168:169], v14, s[16:19], s4 offen offset:2048 sc1
    v_add_u32 v16, 0, v0
    v_mul_u32_u24 v17, 6554, v16
    v_lshrrev_b32 v17, 16, v17
    v_mul_u32_u24 v18, 10, v17
    v_sub_u32 v18, v16, v18
    v_mul_u32_u24 v17, 2560, v17
    v_lshl_add_u32 v220, v18, 4, v17
    v_add_u32 v16, 64, v0
    v_mul_u32_u24 v17, 6554, v16
    v_lshrrev_b32 v17, 16, v17
    v_mul_u32_u24 v18, 10, v17
    v_sub_u32 v18, v16, v18
    v_mul_u32_u24 v17, 2560, v17
    v_lshl_add_u32 v221, v18, 4, v17
    v_add_u32 v16, 128, v0
    v_mul_u32_u24 v17, 6554, v16
    v_lshrrev_b32 v17, 16, v17
    v_mul_u32_u24 v18, 10, v17
    v_sub_u32 v18, v16, v18
    v_mul_u32_u24 v17, 2560, v17
    v_lshl_add_u32 v222, v18, 4, v17
    v_add_u32 v16, 192, v0
    v_mul_u32_u24 v17, 6554, v16
    v_lshrrev_b32 v17, 16, v17
    v_mul_u32_u24 v18, 10, v17
    v_sub_u32 v18, v16, v18
    v_mul_u32_u24 v17, 2560, v17
    v_lshl_add_u32 v223, v18, 4, v17
    v_add_u32 v16, 256, v0
    v_mul_u32_u24 v17, 6554, v16
    v_lshrrev_b32 v17, 16, v17
    v_mul_u32_u24 v18, 10, v17
    v_sub_u32 v18, v16, v18
    v_mul_u32_u24 v17, 2560, v17
    v_lshl_add_u32 v224, v18, 4, v17
    v_lshlrev_b32 v226, 4, v0
    v_lshlrev_b32 v227, 3, v0
    v_add_u32 v228, 2560, v226
    v_add_u32 v229, 2560, v227
    v_and_b32 v16, 15, v0
    v_mul_u32_u24 v16, 160, v16
    v_lshrrev_b32 v17, 4, v0
    v_lshl_add_u32 v16, v17, 3, v16
    s_add_u32 s3, s42, 81920
    v_add_u32 v230, s3, v16
    v_add_u32 v231, s3, v226
    s_lshl_b32 s5, s31, 4
    s_add_u32 s5, s5, s29
    s_lshl_b32 s5, s5, 10
    s_add_u32 s5, s5, 9568256
    s_lshl_b32 s4, s30, 2
    s_add_u32 s4, s4, s5
    s_lshl_b32 s3, s31, 4
    s_add_u32 s3, s3, s29
    s_lshl_b32 s3, s3, 2
    s_add_u32 s3, s3, s28
    s_mul_i32 s3, s3, 40960
    s_mov_b32 s32, s3
    s_add_u32 s33, s3, 20480
    s_waitcnt vmcnt(0)
    s_barrier
    s_cmp_lg_u32 s28, 0
    s_cbranch_scc1 Lfl_14
    v_mov_b32 v13, 0
    v_mov_b32 v14, s43
    s_mov_b64 exec, 1
    buffer_store_dword v14, v13, s[16:19], s4 offen sc1
    s_mov_b64 exec, -1
Lfl_14:
    ds_read_b64_tr_b16 a[160:161], v2 offset:0
    ds_read_b64_tr_b16 a[162:163], v2 offset:2560
    ds_read_b64_tr_b16 a[164:165], v2 offset:32
    ds_read_b64_tr_b16 a[166:167], v2 offset:2592
    ds_read_b64_tr_b16 a[168:169], v2 offset:64
    ds_read_b64_tr_b16 a[170:171], v2 offset:2624
    ds_read_b64_tr_b16 a[172:173], v2 offset:96
    ds_read_b64_tr_b16 a[174:175], v2 offset:2656
    ds_read_b64_tr_b16 a[176:177], v2 offset:128
    ds_read_b64_tr_b16 a[178:179], v2 offset:2688
    ds_read_b64_tr_b16 a[180:181], v2 offset:5120
    ds_read_b64_tr_b16 a[182:183], v2 offset:7680
    ds_read_b64_tr_b16 a[184:185], v2 offset:5152
    ds_read_b64_tr_b16 a[186:187], v2 offset:7712
    v_lshlrev_b32 v16, 2, v0
    s_mov_b32 s68, 0xff
    s_mov_b32 s69, 0x0
    s_mov_b64 exec, s[68:69]
    s_mov_b32 s66, 0
Lpoll_15:
    buffer_load_dword v17, v16, s[16:19], s5 offen sc1
    s_waitcnt vmcnt(0)
    v_cmp_ne_u32 vcc, s43, v17
    s_cbranch_vccz Lpd_16
    s_add_u32 s66, s66, 1
    s_cmp_lt_u32 s66, 0x40000
    s_cbranch_scc1 Lpoll_15
Lpd_16:
    s_mov_b64 exec, -1
    buffer_load_dwordx4 a[0:3], v226, s[16:19], s32 offen offset:0 sc1
    buffer_load_dwordx4 a[20:23], v226, s[16:19], s33 offen offset:0 sc1
    buffer_load_dwordx4 a[4:7], v226, s[16:19], s32 offen offset:1024 sc1
    buffer_load_dwordx4 a[24:27], v226, s[16:19], s33 offen offset:1024 sc1
    buffer_load_dwordx4 a[8:11], v228, s[16:19], s32 offen offset:0 sc1
    buffer_load_dwordx4 a[28:31], v228, s[16:19], s33 offen offset:0 sc1
    buffer_load_dwordx4 a[12:15], v228, s[16:19], s32 offen offset:1024 sc1
    buffer_load_dwordx4 a[32:35], v228, s[16:19], s33 offen offset:1024 sc1
    buffer_load_dwordx2 a[16:17], v227, s[16:19], s32 offen offset:2048 sc1
    buffer_load_dwordx2 a[18:19], v229, s[16:19], s32 offen offset:2048 sc1
    s_add_u32 s32, s32, 5120
    buffer_load_dwordx2 a[36:37], v227, s[16:19], s33 offen offset:2048 sc1
    buffer_load_dwordx2 a[38:39], v229, s[16:19], s33 offen offset:2048 sc1
    s_add_u32 s33, s33, 5120
    s_waitcnt vmcnt(10)
    ds_read_b64_tr_b16 a[188:189], v2 offset:5184
    ds_read_b64_tr_b16 a[190:191], v2 offset:7744
    s_waitcnt lgkmcnt(14)
    v_mfma_f32_16x16x32_bf16 v[48:51], a[160:163], a[0:3], 0
    v_mfma_f32_16x16x32_bf16 v[68:71], a[160:163], a[20:23], 0
    s_waitcnt lgkmcnt(10)
    buffer_load_dwordx4 a[40:43], v226, s[16:19], s32 offen offset:0 sc1
    ds_read_b64_tr_b16 a[160:161], v2 offset:5216
    ds_read_b64_tr_b16 a[162:163], v2 offset:7776
    v_mfma_f32_16x16x32_bf16 v[52:55], a[164:167], a[0:3], 0
    v_mfma_f32_16x16x32_bf16 v[72:75], a[164:167], a[20:23], 0
    ds_read_b64_tr_b16 a[164:165], v2 offset:5248
    ds_read_b64_tr_b16 a[166:167], v2 offset:7808
    v_mfma_f32_16x16x32_bf16 v[56:59], a[168:171], a[0:3], 0
    v_mfma_f32_16x16x32_bf16 v[76:79], a[168:171], a[20:23], 0
    s_waitcnt lgkmcnt(10)
    buffer_load_dwordx4 a[60:63], v226, s[16:19], s33 offen offset:0 sc1
    ds_read_b64_tr_b16 a[168:169], v2 offset:12800
    ds_read_b64_tr_b16 a[170:171], v2 offset:15360
    v_mfma_f32_16x16x32_bf16 v[60:63], a[172:175], a[0:3], 0
    v_mfma_f32_16x16x32_bf16 v[80:83], a[172:175], a[20:23], 0
    ds_read_b64_tr_b16 a[172:173], v2 offset:12832
    ds_read_b64_tr_b16 a[174:175], v2 offset:15392
    v_mfma_f32_16x16x32_bf16 v[64:67], a[176:179], a[0:3], 0
    v_mfma_f32_16x16x32_bf16 v[84:87], a[176:179], a[20:23], 0
    s_waitcnt lgkmcnt(10)
    buffer_load_dwordx4 a[44:47], v226, s[16:19], s32 offen offset:1024 sc1
    s_waitcnt vmcnt(11)
    ds_read_b64_tr_b16 a[176:177], v2 offset:12864
    ds_read_b64_tr_b16 a[178:179], v2 offset:15424
    v_mfma_f32_16x16x32_bf16 v[48:51], a[180:183], a[4:7], v[48:51]
    v_mfma_f32_16x16x32_bf16 v[68:71], a[180:183], a[24:27], v[68:71]
    ds_read_b64_tr_b16 a[180:181], v2 offset:12896
    ds_read_b64_tr_b16 a[182:183], v2 offset:15456
    v_mfma_f32_16x16x32_bf16 v[52:55], a[184:187], a[4:7], v[52:55]
    v_mfma_f32_16x16x32_bf16 v[72:75], a[184:187], a[24:27], v[72:75]
    s_waitcnt lgkmcnt(10)
    buffer_load_dwordx4 a[64:67], v226, s[16:19], s33 offen offset:1024 sc1
    ds_read_b64_tr_b16 a[184:185], v2 offset:12928
    ds_read_b64_tr_b16 a[186:187], v2 offset:15488
    v_mfma_f32_16x16x32_bf16 v[56:59], a[188:191], a[4:7], v[56:59]
    v_mfma_f32_16x16x32_bf16 v[76:79], a[188:191], a[24:27], v[76:79]
    ds_read_b64_tr_b16 a[188:189], v2 offset:17920
    ds_read_b64_tr_b16 a[190:191], v3 offset:20480
    v_mfma_f32_16x16x32_bf16 v[60:63], a[160:163], a[4:7], v[60:63]
    v_mfma_f32_16x16x32_bf16 v[80:83], a[160:163], a[24:27], v[80:83]
    s_waitcnt lgkmcnt(10)
    buffer_load_dwordx4 a[48:51], v228, s[16:19], s32 offen offset:0 sc1
    ds_read_b64_tr_b16 a[160:161], v2 offset:17952
    ds_read_b64_tr_b16 a[162:163], v3 offset:20512
    v_mfma_f32_16x16x32_bf16 v[64:67], a[164:167], a[4:7], v[64:67]
    v_mfma_f32_16x16x32_bf16 v[84:87], a[164:167], a[24:27], v[84:87]
    s_waitcnt vmcnt(11)
    ds_read_b64_tr_b16 a[164:165], v2 offset:17984
    ds_read_b64_tr_b16 a[166:167], v3 offset:20544
    v_mfma_f32_16x16x32_bf16 v[48:51], a[168:171], a[8:11], v[48:51]
    v_mfma_f32_16x16x32_bf16 v[68:71], a[168:171], a[28:31], v[68:71]
    s_waitcnt lgkmcnt(10)
    buffer_load_dwordx4 a[68:71], v228, s[16:19], s33 offen offset:0 sc1
    ds_read_b64_tr_b16 a[168:169], v2 offset:18016
    ds_read_b64_tr_b16 a[170:171], v3 offset:20576
    v_mfma_f32_16x16x32_bf16 v[52:55], a[172:175], a[8:11], v[52:55]
    v_mfma_f32_16x16x32_bf16 v[72:75], a[172:175], a[28:31], v[72:75]
    ds_read_b64_tr_b16 a[172:173], v2 offset:18048
    ds_read_b64_tr_b16 a[174:175], v3 offset:20608
    v_mfma_f32_16x16x32_bf16 v[56:59], a[176:179], a[8:11], v[56:59]
    v_mfma_f32_16x16x32_bf16 v[76:79], a[176:179], a[28:31], v[76:79]
    s_waitcnt lgkmcnt(10)
    buffer_load_dwordx4 a[52:55], v228, s[16:19], s32 offen offset:1024 sc1
    ds_read_b64_tr_b16 a[176:177], v2 offset:10240
    ds_read_b64_tr_b16 a[178:179], v3 offset:23040
    v_mfma_f32_16x16x32_bf16 v[60:63], a[180:183], a[8:11], v[60:63]
    v_mfma_f32_16x16x32_bf16 v[80:83], a[180:183], a[28:31], v[80:83]
    ds_read_b64_tr_b16 a[180:181], v2 offset:10272
    ds_read_b64_tr_b16 a[182:183], v3 offset:23072
    v_mfma_f32_16x16x32_bf16 v[64:67], a[184:187], a[8:11], v[64:67]
    v_mfma_f32_16x16x32_bf16 v[84:87], a[184:187], a[28:31], v[84:87]
    s_waitcnt lgkmcnt(10)
    buffer_load_dwordx4 a[72:75], v228, s[16:19], s33 offen offset:1024 sc1
    s_waitcnt vmcnt(12)
    ds_read_b64_tr_b16 a[184:185], v2 offset:10304
    ds_read_b64_tr_b16 a[186:187], v3 offset:23104
    v_mfma_f32_16x16x32_bf16 v[48:51], a[188:191], a[12:15], v[48:51]
    v_mfma_f32_16x16x32_bf16 v[68:71], a[188:191], a[32:35], v[68:71]
    ds_read_b64_tr_b16 a[188:189], v2 offset:10336
    ds_read_b64_tr_b16 a[190:191], v3 offset:23136
    v_mfma_f32_16x16x32_bf16 v[52:55], a[160:163], a[12:15], v[52:55]
    v_mfma_f32_16x16x32_bf16 v[72:75], a[160:163], a[32:35], v[72:75]
    s_waitcnt lgkmcnt(10)
    buffer_load_dwordx2 a[56:57], v227, s[16:19], s32 offen offset:2048 sc1
    buffer_load_dwordx2 a[58:59], v229, s[16:19], s32 offen offset:2048 sc1
    s_add_u32 s32, s32, 5120
    ds_read_b64_tr_b16 a[160:161], v2 offset:10368
    ds_read_b64_tr_b16 a[162:163], v3 offset:23168
    v_mfma_f32_16x16x32_bf16 v[56:59], a[164:167], a[12:15], v[56:59]
    v_mfma_f32_16x16x32_bf16 v[76:79], a[164:167], a[32:35], v[76:79]
    ds_read_b64_tr_b16 a[164:165], v3 offset:25600
    ds_read_b64_tr_b16 a[166:167], v3 offset:28160
    v_mfma_f32_16x16x32_bf16 v[60:63], a[168:171], a[12:15], v[60:63]
    v_mfma_f32_16x16x32_bf16 v[80:83], a[168:171], a[32:35], v[80:83]
    s_waitcnt lgkmcnt(10)
    buffer_load_dwordx2 a[76:77], v227, s[16:19], s33 offen offset:2048 sc1
    buffer_load_dwordx2 a[78:79], v229, s[16:19], s33 offen offset:2048 sc1
    s_add_u32 s33, s33, 5120
    ds_read_b64_tr_b16 a[168:169], v3 offset:25632
    ds_read_b64_tr_b16 a[170:171], v3 offset:28192
    v_mfma_f32_16x16x32_bf16 v[64:67], a[172:175], a[12:15], v[64:67]
    v_mfma_f32_16x16x32_bf16 v[84:87], a[172:175], a[32:35], v[84:87]
    s_waitcnt vmcnt(12)
    ds_read_b64_tr_b16 a[172:173], v3 offset:25664
    ds_read_b64_tr_b16 a[174:175], v3 offset:28224
    v_mfma_f32_16x16x32_bf16 v[48:51], a[176:179], a[16:19], v[48:51]
    v_mfma_f32_16x16x32_bf16 v[68:71], a[176:179], a[36:39], v[68:71]
    s_waitcnt lgkmcnt(10)
    buffer_load_dwordx4 a[80:83], v226, s[16:19], s32 offen offset:0 sc1
    ds_read_b64_tr_b16 a[176:177], v3 offset:25696
    ds_read_b64_tr_b16 a[178:179], v3 offset:28256
    v_mfma_f32_16x16x32_bf16 v[52:55], a[180:183], a[16:19], v[52:55]
    v_mfma_f32_16x16x32_bf16 v[72:75], a[180:183], a[36:39], v[72:75]
    ds_read_b64_tr_b16 a[180:181], v3 offset:25728
    ds_read_b64_tr_b16 a[182:183], v3 offset:28288
    v_mfma_f32_16x16x32_bf16 v[56:59], a[184:187], a[16:19], v[56:59]
    v_mfma_f32_16x16x32_bf16 v[76:79], a[184:187], a[36:39], v[76:79]
    s_waitcnt lgkmcnt(10)
    buffer_load_dwordx4 a[100:103], v226, s[16:19], s33 offen offset:0 sc1
    ds_read_b64_tr_b16 a[184:185], v3 offset:30720
    ds_read_b64_tr_b16 a[186:187], v3 offset:33280
    v_mfma_f32_16x16x32_bf16 v[60:63], a[188:191], a[16:19], v[60:63]
    v_mfma_f32_16x16x32_bf16 v[80:83], a[188:191], a[36:39], v[80:83]
    ds_read_b64_tr_b16 a[188:189], v3 offset:30752
    ds_read_b64_tr_b16 a[190:191], v3 offset:33312
    v_mfma_f32_16x16x32_bf16 v[64:67], a[160:163], a[16:19], v[64:67]
    v_mfma_f32_16x16x32_bf16 v[84:87], a[160:163], a[36:39], v[84:87]
    s_waitcnt lgkmcnt(10)
    buffer_load_dwordx4 a[84:87], v226, s[16:19], s32 offen offset:1024 sc1
    s_waitcnt vmcnt(13)
    ds_read_b64_tr_b16 a[160:161], v3 offset:30784
    ds_read_b64_tr_b16 a[162:163], v3 offset:33344
    v_mfma_f32_16x16x32_bf16 v[48:51], a[164:167], a[40:43], v[48:51]
    v_mfma_f32_16x16x32_bf16 v[68:71], a[164:167], a[60:63], v[68:71]
    ds_read_b64_tr_b16 a[164:165], v3 offset:30816
    ds_read_b64_tr_b16 a[166:167], v3 offset:33376
    v_mfma_f32_16x16x32_bf16 v[52:55], a[168:171], a[40:43], v[52:55]
    v_mfma_f32_16x16x32_bf16 v[72:75], a[168:171], a[60:63], v[72:75]
    s_waitcnt lgkmcnt(10)
    buffer_load_dwordx4 a[104:107], v226, s[16:19], s33 offen offset:1024 sc1
    ds_read_b64_tr_b16 a[168:169], v3 offset:30848
    ds_read_b64_tr_b16 a[170:171], v3 offset:33408
    v_mfma_f32_16x16x32_bf16 v[56:59], a[172:175], a[40:43], v[56:59]
    v_mfma_f32_16x16x32_bf16 v[76:79], a[172:175], a[60:63], v[76:79]
    ds_read_b64_tr_b16 a[172:173], v3 offset:38400
    ds_read_b64_tr_b16 a[174:175], v1 offset:0
    v_mfma_f32_16x16x32_bf16 v[60:63], a[176:179], a[40:43], v[60:63]
    v_mfma_f32_16x16x32_bf16 v[80:83], a[176:179], a[60:63], v[80:83]
    s_waitcnt lgkmcnt(10)
    buffer_load_dwordx4 a[88:91], v228, s[16:19], s32 offen offset:0 sc1
    ds_read_b64_tr_b16 a[176:177], v3 offset:38432
    ds_read_b64_tr_b16 a[178:179], v1 offset:32
    v_mfma_f32_16x16x32_bf16 v[64:67], a[180:183], a[40:43], v[64:67]
    v_mfma_f32_16x16x32_bf16 v[84:87], a[180:183], a[60:63], v[84:87]
    s_waitcnt vmcnt(13)
    ds_read_b64_tr_b16 a[180:181], v3 offset:38464
    ds_read_b64_tr_b16 a[182:183], v1 offset:64
    v_mfma_f32_16x16x32_bf16 v[48:51], a[184:187], a[44:47], v[48:51]
    v_mfma_f32_16x16x32_bf16 v[68:71], a[184:187], a[64:67], v[68:71]
    s_waitcnt lgkmcnt(10)
    buffer_load_dwordx4 a[108:111], v228, s[16:19], s33 offen offset:0 sc1
    ds_read_b64_tr_b16 a[184:185], v3 offset:38496
    ds_read_b64_tr_b16 a[186:187], v1 offset:96
    v_mfma_f32_16x16x32_bf16 v[52:55], a[188:191], a[44:47], v[52:55]
    v_mfma_f32_16x16x32_bf16 v[72:75], a[188:191], a[64:67], v[72:75]
    ds_read_b64_tr_b16 a[188:189], v3 offset:38528
    ds_read_b64_tr_b16 a[190:191], v1 offset:128
    v_mfma_f32_16x16x32_bf16 v[56:59], a[160:163], a[44:47], v[56:59]
    v_mfma_f32_16x16x32_bf16 v[76:79], a[160:163], a[64:67], v[76:79]
    s_waitcnt lgkmcnt(10)
    buffer_load_dwordx4 a[92:95], v228, s[16:19], s32 offen offset:1024 sc1
    ds_read_b64_tr_b16 a[160:161], v1 offset:2560
    ds_read_b64_tr_b16 a[162:163], v1 offset:5120
    v_mfma_f32_16x16x32_bf16 v[60:63], a[164:167], a[44:47], v[60:63]
    v_mfma_f32_16x16x32_bf16 v[80:83], a[164:167], a[64:67], v[80:83]
    ds_read_b64_tr_b16 a[164:165], v1 offset:2592
    ds_read_b64_tr_b16 a[166:167], v1 offset:5152
    v_mfma_f32_16x16x32_bf16 v[64:67], a[168:171], a[44:47], v[64:67]
    v_mfma_f32_16x16x32_bf16 v[84:87], a[168:171], a[64:67], v[84:87]
    s_waitcnt lgkmcnt(10)
    buffer_load_dwordx4 a[112:115], v228, s[16:19], s33 offen offset:1024 sc1
    s_waitcnt vmcnt(14)
    ds_read_b64_tr_b16 a[168:169], v1 offset:2624
    ds_read_b64_tr_b16 a[170:171], v1 offset:5184
    v_mfma_f32_16x16x32_bf16 v[48:51], a[172:175], a[48:51], v[48:51]
    v_mfma_f32_16x16x32_bf16 v[68:71], a[172:175], a[68:71], v[68:71]
    ds_read_b64_tr_b16 a[172:173], v1 offset:2656
    ds_read_b64_tr_b16 a[174:175], v1 offset:5216
    v_mfma_f32_16x16x32_bf16 v[52:55], a[176:179], a[48:51], v[52:55]
    v_mfma_f32_16x16x32_bf16 v[72:75], a[176:179], a[68:71], v[72:75]
    s_waitcnt lgkmcnt(10)
    buffer_load_dwordx2 a[96:97], v227, s[16:19], s32 offen offset:2048 sc1
    buffer_load_dwordx2 a[98:99], v229, s[16:19], s32 offen offset:2048 sc1
    s_add_u32 s32, s32, 5120
    ds_read_b64_tr_b16 a[176:177], v1 offset:2688
    ds_read_b64_tr_b16 a[178:179], v1 offset:5248
    v_mfma_f32_16x16x32_bf16 v[56:59], a[180:183], a[48:51], v[56:59]
    v_mfma_f32_16x16x32_bf16 v[76:79], a[180:183], a[68:71], v[76:79]
    ds_read_b64_tr_b16 a[180:181], v3 offset:35840
    ds_read_b64_tr_b16 a[182:183], v1 offset:7680
    v_mfma_f32_16x16x32_bf16 v[60:63], a[184:187], a[48:51], v[60:63]
    v_mfma_f32_16x16x32_bf16 v[80:83], a[184:187], a[68:71], v[80:83]
    s_waitcnt lgkmcnt(10)
    buffer_load_dwordx2 a[116:117], v227, s[16:19], s33 offen offset:2048 sc1
    buffer_load_dwordx2 a[118:119], v229, s[16:19], s33 offen offset:2048 sc1
    s_add_u32 s33, s33, 5120
    ds_read_b64_tr_b16 a[184:185], v3 offset:35872
    ds_read_b64_tr_b16 a[186:187], v1 offset:7712
    v_mfma_f32_16x16x32_bf16 v[64:67], a[188:191], a[48:51], v[64:67]
    v_mfma_f32_16x16x32_bf16 v[84:87], a[188:191], a[68:71], v[84:87]
    s_waitcnt vmcnt(16)
    ds_read_b64_tr_b16 a[188:189], v3 offset:35904
    ds_read_b64_tr_b16 a[190:191], v1 offset:7744
    v_mfma_f32_16x16x32_bf16 v[48:51], a[160:163], a[52:55], v[48:51]
    v_mfma_f32_16x16x32_bf16 v[68:71], a[160:163], a[72:75], v[68:71]
    s_waitcnt lgkmcnt(10)
    buffer_load_dwordx4 a[120:123], v226, s[16:19], s32 offen offset:0 sc1
    ds_read_b64_tr_b16 a[160:161], v3 offset:35936
    ds_read_b64_tr_b16 a[162:163], v1 offset:7776
    v_mfma_f32_16x16x32_bf16 v[52:55], a[164:167], a[52:55], v[52:55]
    v_mfma_f32_16x16x32_bf16 v[72:75], a[164:167], a[72:75], v[72:75]
    ds_read_b64_tr_b16 a[164:165], v3 offset:35968
    ds_read_b64_tr_b16 a[166:167], v1 offset:7808
    v_mfma_f32_16x16x32_bf16 v[56:59], a[168:171], a[52:55], v[56:59]
    v_mfma_f32_16x16x32_bf16 v[76:79], a[168:171], a[72:75], v[76:79]
    s_waitcnt lgkmcnt(10)
    buffer_load_dwordx4 a[140:143], v226, s[16:19], s33 offen offset:0 sc1
    ds_read_b64_tr_b16 a[168:169], v1 offset:10240
    ds_read_b64_tr_b16 a[170:171], v1 offset:12800
    v_mfma_f32_16x16x32_bf16 v[60:63], a[172:175], a[52:55], v[60:63]
    v_mfma_f32_16x16x32_bf16 v[80:83], a[172:175], a[72:75], v[80:83]
    ds_read_b64_tr_b16 a[172:173], v1 offset:10272
    ds_read_b64_tr_b16 a[174:175], v1 offset:12832
    v_mfma_f32_16x16x32_bf16 v[64:67], a[176:179], a[52:55], v[64:67]
    v_mfma_f32_16x16x32_bf16 v[84:87], a[176:179], a[72:75], v[84:87]
    s_waitcnt lgkmcnt(10)
    buffer_load_dwordx4 a[124:127], v226, s[16:19], s32 offen offset:1024 sc1
    s_waitcnt vmcnt(15)
    ds_read_b64_tr_b16 a[176:177], v1 offset:10304
    ds_read_b64_tr_b16 a[178:179], v1 offset:12864
    v_mfma_f32_16x16x32_bf16 v[48:51], a[180:183], a[56:59], v[48:51]
    v_mfma_f32_16x16x32_bf16 v[68:71], a[180:183], a[76:79], v[68:71]
    ds_read_b64_tr_b16 a[180:181], v1 offset:10336
    ds_read_b64_tr_b16 a[182:183], v1 offset:12896
    v_mfma_f32_16x16x32_bf16 v[52:55], a[184:187], a[56:59], v[52:55]
    v_mfma_f32_16x16x32_bf16 v[72:75], a[184:187], a[76:79], v[72:75]
    s_waitcnt lgkmcnt(10)
    buffer_load_dwordx4 a[144:147], v226, s[16:19], s33 offen offset:1024 sc1
    ds_read_b64_tr_b16 a[184:185], v1 offset:10368
    ds_read_b64_tr_b16 a[186:187], v1 offset:12928
    v_mfma_f32_16x16x32_bf16 v[56:59], a[188:191], a[56:59], v[56:59]
    v_mfma_f32_16x16x32_bf16 v[76:79], a[188:191], a[76:79], v[76:79]
    ds_read_b64_tr_b16 a[188:189], v1 offset:15360
    ds_read_b64_tr_b16 a[190:191], v1 offset:17920
    v_mfma_f32_16x16x32_bf16 v[60:63], a[160:163], a[56:59], v[60:63]
    v_mfma_f32_16x16x32_bf16 v[80:83], a[160:163], a[76:79], v[80:83]
    s_waitcnt lgkmcnt(10)
    buffer_load_dwordx4 a[128:131], v228, s[16:19], s32 offen offset:0 sc1
    ds_read_b64_tr_b16 a[160:161], v1 offset:15392
    ds_read_b64_tr_b16 a[162:163], v1 offset:17952
    v_mfma_f32_16x16x32_bf16 v[64:67], a[164:167], a[56:59], v[64:67]
    v_mfma_f32_16x16x32_bf16 v[84:87], a[164:167], a[76:79], v[84:87]
    s_waitcnt vmcnt(15)
    ds_read_b64_tr_b16 a[164:165], v1 offset:15424
    ds_read_b64_tr_b16 a[166:167], v1 offset:17984
    v_mfma_f32_16x16x32_bf16 v[48:51], a[168:171], a[80:83], v[48:51]
    v_mfma_f32_16x16x32_bf16 v[68:71], a[168:171], a[100:103], v[68:71]
    s_waitcnt lgkmcnt(10)
    buffer_load_dwordx4 a[148:151], v228, s[16:19], s33 offen offset:0 sc1
    ds_read_b64_tr_b16 a[168:169], v1 offset:15456
    ds_read_b64_tr_b16 a[170:171], v1 offset:18016
    v_mfma_f32_16x16x32_bf16 v[52:55], a[172:175], a[80:83], v[52:55]
    v_mfma_f32_16x16x32_bf16 v[72:75], a[172:175], a[100:103], v[72:75]
    ds_read_b64_tr_b16 a[172:173], v1 offset:15488
    ds_read_b64_tr_b16 a[174:175], v1 offset:18048
    v_mfma_f32_16x16x32_bf16 v[56:59], a[176:179], a[80:83], v[56:59]
    v_mfma_f32_16x16x32_bf16 v[76:79], a[176:179], a[100:103], v[76:79]
    s_waitcnt lgkmcnt(10)
    buffer_load_dwordx4 a[132:135], v228, s[16:19], s32 offen offset:1024 sc1
    ds_read_b64_tr_b16 a[176:177], v1 offset:23040
    ds_read_b64_tr_b16 a[178:179], v1 offset:25600
    v_mfma_f32_16x16x32_bf16 v[60:63], a[180:183], a[80:83], v[60:63]
    v_mfma_f32_16x16x32_bf16 v[80:83], a[180:183], a[100:103], v[80:83]
    ds_read_b64_tr_b16 a[180:181], v1 offset:23072
    ds_read_b64_tr_b16 a[182:183], v1 offset:25632
    v_mfma_f32_16x16x32_bf16 v[64:67], a[184:187], a[80:83], v[64:67]
    v_mfma_f32_16x16x32_bf16 v[84:87], a[184:187], a[100:103], v[84:87]
    s_waitcnt lgkmcnt(10)
    buffer_load_dwordx4 a[152:155], v228, s[16:19], s33 offen offset:1024 sc1
    s_waitcnt vmcnt(16)
    ds_read_b64_tr_b16 a[184:185], v1 offset:23104
    ds_read_b64_tr_b16 a[186:187], v1 offset:25664
    v_mfma_f32_16x16x32_bf16 v[48:51], a[188:191], a[84:87], v[48:51]
    v_mfma_f32_16x16x32_bf16 v[68:71], a[188:191], a[104:107], v[68:71]
    ds_read_b64_tr_b16 a[188:189], v1 offset:23136
    ds_read_b64_tr_b16 a[190:191], v1 offset:25696
    v_mfma_f32_16x16x32_bf16 v[52:55], a[160:163], a[84:87], v[52:55]
    v_mfma_f32_16x16x32_bf16 v[72:75], a[160:163], a[104:107], v[72:75]
    s_waitcnt lgkmcnt(10)
    buffer_load_dwordx2 a[136:137], v227, s[16:19], s32 offen offset:2048 sc1
    buffer_load_dwordx2 a[138:139], v229, s[16:19], s32 offen offset:2048 sc1
    ds_read_b64_tr_b16 a[160:161], v1 offset:23168
    ds_read_b64_tr_b16 a[162:163], v1 offset:25728
    v_mfma_f32_16x16x32_bf16 v[56:59], a[164:167], a[84:87], v[56:59]
    v_mfma_f32_16x16x32_bf16 v[76:79], a[164:167], a[104:107], v[76:79]
    ds_read_b64_tr_b16 a[164:165], v1 offset:28160
    ds_read_b64_tr_b16 a[166:167], v1 offset:30720
    v_mfma_f32_16x16x32_bf16 v[60:63], a[168:171], a[84:87], v[60:63]
    v_mfma_f32_16x16x32_bf16 v[80:83], a[168:171], a[104:107], v[80:83]
    s_waitcnt lgkmcnt(10)
    buffer_load_dwordx2 a[156:157], v227, s[16:19], s33 offen offset:2048 sc1
    buffer_load_dwordx2 a[158:159], v229, s[16:19], s33 offen offset:2048 sc1
    ds_read_b64_tr_b16 a[168:169], v1 offset:28192
    ds_read_b64_tr_b16 a[170:171], v1 offset:30752
    v_mfma_f32_16x16x32_bf16 v[64:67], a[172:175], a[84:87], v[64:67]
    v_mfma_f32_16x16x32_bf16 v[84:87], a[172:175], a[104:107], v[84:87]
    s_waitcnt vmcnt(18)
    ds_read_b64_tr_b16 a[172:173], v1 offset:28224
    ds_read_b64_tr_b16 a[174:175], v1 offset:30784
    v_mfma_f32_16x16x32_bf16 v[48:51], a[176:179], a[88:91], v[48:51]
    v_mfma_f32_16x16x32_bf16 v[68:71], a[176:179], a[108:111], v[68:71]
    s_waitcnt lgkmcnt(10)
    ds_read_b64_tr_b16 a[176:177], v1 offset:28256
    ds_read_b64_tr_b16 a[178:179], v1 offset:30816
    v_mfma_f32_16x16x32_bf16 v[52:55], a[180:183], a[88:91], v[52:55]
    v_mfma_f32_16x16x32_bf16 v[72:75], a[180:183], a[108:111], v[72:75]
    ds_read_b64_tr_b16 a[180:181], v1 offset:28288
    ds_read_b64_tr_b16 a[182:183], v1 offset:30848
    v_mfma_f32_16x16x32_bf16 v[56:59], a[184:187], a[88:91], v[56:59]
    v_mfma_f32_16x16x32_bf16 v[76:79], a[184:187], a[108:111], v[76:79]
    s_waitcnt lgkmcnt(10)
    ds_read_b64_tr_b16 a[184:185], v1 offset:20480
    ds_read_b64_tr_b16 a[186:187], v1 offset:33280
    v_mfma_f32_16x16x32_bf16 v[60:63], a[188:191], a[88:91], v[60:63]
    v_mfma_f32_16x16x32_bf16 v[80:83], a[188:191], a[108:111], v[80:83]
    ds_read_b64_tr_b16 a[188:189], v1 offset:20512
    ds_read_b64_tr_b16 a[190:191], v1 offset:33312
    v_mfma_f32_16x16x32_bf16 v[64:67], a[160:163], a[88:91], v[64:67]
    v_mfma_f32_16x16x32_bf16 v[84:87], a[160:163], a[108:111], v[84:87]
    s_waitcnt lgkmcnt(10)
    s_waitcnt vmcnt(16)
    ds_read_b64_tr_b16 a[160:161], v1 offset:20544
    ds_read_b64_tr_b16 a[162:163], v1 offset:33344
    v_mfma_f32_16x16x32_bf16 v[48:51], a[164:167], a[92:95], v[48:51]
    v_mfma_f32_16x16x32_bf16 v[68:71], a[164:167], a[112:115], v[68:71]
    ds_read_b64_tr_b16 a[164:165], v1 offset:20576
    ds_read_b64_tr_b16 a[166:167], v1 offset:33376
    v_mfma_f32_16x16x32_bf16 v[52:55], a[168:171], a[92:95], v[52:55]
    v_mfma_f32_16x16x32_bf16 v[72:75], a[168:171], a[112:115], v[72:75]
    s_waitcnt lgkmcnt(10)
    ds_read_b64_tr_b16 a[168:169], v1 offset:20608
    ds_read_b64_tr_b16 a[170:171], v1 offset:33408
    v_mfma_f32_16x16x32_bf16 v[56:59], a[172:175], a[92:95], v[56:59]
    v_mfma_f32_16x16x32_bf16 v[76:79], a[172:175], a[112:115], v[76:79]
    ds_read_b64_tr_b16 a[172:173], v1 offset:35840
    ds_read_b64_tr_b16 a[174:175], v1 offset:38400
    v_mfma_f32_16x16x32_bf16 v[60:63], a[176:179], a[92:95], v[60:63]
    v_mfma_f32_16x16x32_bf16 v[80:83], a[176:179], a[112:115], v[80:83]
    s_waitcnt lgkmcnt(10)
    ds_read_b64_tr_b16 a[176:177], v1 offset:35872
    ds_read_b64_tr_b16 a[178:179], v1 offset:38432
    v_mfma_f32_16x16x32_bf16 v[64:67], a[180:183], a[92:95], v[64:67]
    v_mfma_f32_16x16x32_bf16 v[84:87], a[180:183], a[112:115], v[84:87]
    s_waitcnt vmcnt(12)
    ds_read_b64_tr_b16 a[180:181], v1 offset:35904
    ds_read_b64_tr_b16 a[182:183], v1 offset:38464
    v_mfma_f32_16x16x32_bf16 v[48:51], a[184:187], a[96:99], v[48:51]
    v_mfma_f32_16x16x32_bf16 v[68:71], a[184:187], a[116:119], v[68:71]
    s_waitcnt lgkmcnt(10)
    ds_read_b64_tr_b16 a[184:185], v1 offset:35936
    ds_read_b64_tr_b16 a[186:187], v1 offset:38496
    v_mfma_f32_16x16x32_bf16 v[52:55], a[188:191], a[96:99], v[52:55]
    v_mfma_f32_16x16x32_bf16 v[72:75], a[188:191], a[116:119], v[72:75]
    ds_read_b64_tr_b16 a[188:189], v1 offset:35968
    ds_read_b64_tr_b16 a[190:191], v1 offset:38528
    v_mfma_f32_16x16x32_bf16 v[56:59], a[160:163], a[96:99], v[56:59]
    v_mfma_f32_16x16x32_bf16 v[76:79], a[160:163], a[116:119], v[76:79]
    s_waitcnt lgkmcnt(10)
    ds_read_b64_tr_b16 a[160:161], v1 offset:40960
    ds_read_b64_tr_b16 a[162:163], v1 offset:43520
    v_mfma_f32_16x16x32_bf16 v[60:63], a[164:167], a[96:99], v[60:63]
    v_mfma_f32_16x16x32_bf16 v[80:83], a[164:167], a[116:119], v[80:83]
    ds_read_b64_tr_b16 a[164:165], v1 offset:40992
    ds_read_b64_tr_b16 a[166:167], v1 offset:43552
    v_mfma_f32_16x16x32_bf16 v[64:67], a[168:171], a[96:99], v[64:67]
    v_mfma_f32_16x16x32_bf16 v[84:87], a[168:171], a[116:119], v[84:87]
    s_waitcnt lgkmcnt(10)
    s_waitcnt vmcnt(10)
    ds_read_b64_tr_b16 a[168:169], v1 offset:41024
    ds_read_b64_tr_b16 a[170:171], v1 offset:43584
    v_mfma_f32_16x16x32_bf16 v[48:51], a[172:175], a[120:123], v[48:51]
    v_mfma_f32_16x16x32_bf16 v[68:71], a[172:175], a[140:143], v[68:71]
    ds_read_b64_tr_b16 a[172:173], v1 offset:41056
    ds_read_b64_tr_b16 a[174:175], v1 offset:43616
    v_mfma_f32_16x16x32_bf16 v[52:55], a[176:179], a[120:123], v[52:55]
    v_mfma_f32_16x16x32_bf16 v[72:75], a[176:179], a[140:143], v[72:75]
    s_waitcnt lgkmcnt(10)
    ds_read_b64_tr_b16 a[176:177], v1 offset:41088
    ds_read_b64_tr_b16 a[178:179], v1 offset:43648
    v_mfma_f32_16x16x32_bf16 v[56:59], a[180:183], a[120:123], v[56:59]
    v_mfma_f32_16x16x32_bf16 v[76:79], a[180:183], a[140:143], v[76:79]
    ds_read_b64_tr_b16 a[180:181], v1 offset:48640
    ds_read_b64_tr_b16 a[182:183], v1 offset:51200
    v_mfma_f32_16x16x32_bf16 v[60:63], a[184:187], a[120:123], v[60:63]
    v_mfma_f32_16x16x32_bf16 v[80:83], a[184:187], a[140:143], v[80:83]
    s_waitcnt lgkmcnt(10)
    ds_read_b64_tr_b16 a[184:185], v1 offset:48672
    ds_read_b64_tr_b16 a[186:187], v1 offset:51232
    v_mfma_f32_16x16x32_bf16 v[64:67], a[188:191], a[120:123], v[64:67]
    v_mfma_f32_16x16x32_bf16 v[84:87], a[188:191], a[140:143], v[84:87]
    s_waitcnt vmcnt(8)
    ds_read_b64_tr_b16 a[188:189], v1 offset:48704
    ds_read_b64_tr_b16 a[190:191], v1 offset:51264
    v_mfma_f32_16x16x32_bf16 v[48:51], a[160:163], a[124:127], v[48:51]
    v_mfma_f32_16x16x32_bf16 v[68:71], a[160:163], a[144:147], v[68:71]
    s_waitcnt lgkmcnt(10)
    ds_read_b64_tr_b16 a[160:161], v1 offset:48736
    ds_read_b64_tr_b16 a[162:163], v1 offset:51296
    v_mfma_f32_16x16x32_bf16 v[52:55], a[164:167], a[124:127], v[52:55]
    v_mfma_f32_16x16x32_bf16 v[72:75], a[164:167], a[144:147], v[72:75]
    ds_read_b64_tr_b16 a[164:165], v1 offset:48768
    ds_read_b64_tr_b16 a[166:167], v1 offset:51328
    v_mfma_f32_16x16x32_bf16 v[56:59], a[168:171], a[124:127], v[56:59]
    v_mfma_f32_16x16x32_bf16 v[76:79], a[168:171], a[144:147], v[76:79]
    s_waitcnt lgkmcnt(10)
    ds_read_b64_tr_b16 a[168:169], v1 offset:53760
    ds_read_b64_tr_b16 a[170:171], v1 offset:56320
    v_mfma_f32_16x16x32_bf16 v[60:63], a[172:175], a[124:127], v[60:63]
    v_mfma_f32_16x16x32_bf16 v[80:83], a[172:175], a[144:147], v[80:83]
    ds_read_b64_tr_b16 a[172:173], v1 offset:53792
    ds_read_b64_tr_b16 a[174:175], v1 offset:56352
    v_mfma_f32_16x16x32_bf16 v[64:67], a[176:179], a[124:127], v[64:67]
    v_mfma_f32_16x16x32_bf16 v[84:87], a[176:179], a[144:147], v[84:87]
    s_waitcnt lgkmcnt(10)
    s_waitcnt vmcnt(6)
    ds_read_b64_tr_b16 a[176:177], v1 offset:53824
    ds_read_b64_tr_b16 a[178:179], v1 offset:56384
    v_mfma_f32_16x16x32_bf16 v[48:51], a[180:183], a[128:131], v[48:51]
    v_mfma_f32_16x16x32_bf16 v[68:71], a[180:183], a[148:151], v[68:71]
    ds_read_b64_tr_b16 a[180:181], v1 offset:53856
    ds_read_b64_tr_b16 a[182:183], v1 offset:56416
    v_mfma_f32_16x16x32_bf16 v[52:55], a[184:187], a[128:131], v[52:55]
    v_mfma_f32_16x16x32_bf16 v[72:75], a[184:187], a[148:151], v[72:75]
    s_waitcnt lgkmcnt(10)
    ds_read_b64_tr_b16 a[184:185], v1 offset:53888
    ds_read_b64_tr_b16 a[186:187], v1 offset:56448
    v_mfma_f32_16x16x32_bf16 v[56:59], a[188:191], a[128:131], v[56:59]
    v_mfma_f32_16x16x32_bf16 v[76:79], a[188:191], a[148:151], v[76:79]
    ds_read_b64_tr_b16 a[188:189], v1 offset:46080
    ds_read_b64_tr_b16 a[190:191], v1 offset:58880
    v_mfma_f32_16x16x32_bf16 v[60:63], a[160:163], a[128:131], v[60:63]
    v_mfma_f32_16x16x32_bf16 v[80:83], a[160:163], a[148:151], v[80:83]
    s_waitcnt lgkmcnt(10)
    ds_read_b64_tr_b16 a[160:161], v1 offset:46112
    ds_read_b64_tr_b16 a[162:163], v1 offset:58912
    v_mfma_f32_16x16x32_bf16 v[64:67], a[164:167], a[128:131], v[64:67]
    v_mfma_f32_16x16x32_bf16 v[84:87], a[164:167], a[148:151], v[84:87]
    s_waitcnt vmcnt(4)
    ds_read_b64_tr_b16 a[164:165], v1 offset:46144
    ds_read_b64_tr_b16 a[166:167], v1 offset:58944
    v_mfma_f32_16x16x32_bf16 v[48:51], a[168:171], a[132:135], v[48:51]
    v_mfma_f32_16x16x32_bf16 v[68:71], a[168:171], a[152:155], v[68:71]
    s_waitcnt lgkmcnt(10)
    ds_read_b64_tr_b16 a[168:169], v1 offset:46176
    ds_read_b64_tr_b16 a[170:171], v1 offset:58976
    v_mfma_f32_16x16x32_bf16 v[52:55], a[172:175], a[132:135], v[52:55]
    v_mfma_f32_16x16x32_bf16 v[72:75], a[172:175], a[152:155], v[72:75]
    s_waitcnt vmcnt(0)
    ds_read_b64_tr_b16 a[172:173], v1 offset:46208
    ds_read_b64_tr_b16 a[174:175], v1 offset:59008
    v_mfma_f32_16x16x32_bf16 v[56:59], a[176:179], a[132:135], v[56:59]
    v_mfma_f32_16x16x32_bf16 v[76:79], a[176:179], a[152:155], v[76:79]
    s_waitcnt lgkmcnt(10)
    v_mfma_f32_16x16x32_bf16 v[60:63], a[180:183], a[132:135], v[60:63]
    v_mfma_f32_16x16x32_bf16 v[80:83], a[180:183], a[152:155], v[80:83]
    v_mfma_f32_16x16x32_bf16 v[64:67], a[184:187], a[132:135], v[64:67]
    v_mfma_f32_16x16x32_bf16 v[84:87], a[184:187], a[152:155], v[84:87]
    s_waitcnt lgkmcnt(6)
    v_mfma_f32_16x16x32_bf16 v[48:51], a[188:191], a[136:139], v[48:51]
    v_mfma_f32_16x16x32_bf16 v[68:71], a[188:191], a[156:159], v[68:71]
    v_mfma_f32_16x16x32_bf16 v[52:55], a[160:163], a[136:139], v[52:55]
    v_mfma_f32_16x16x32_bf16 v[72:75], a[160:163], a[156:159], v[72:75]
    s_waitcnt lgkmcnt(2)
    v_mfma_f32_16x16x32_bf16 v[56:59], a[164:167], a[136:139], v[56:59]
    v_mfma_f32_16x16x32_bf16 v[76:79], a[164:167], a[156:159], v[76:79]
    v_mfma_f32_16x16x32_bf16 v[60:63], a[168:171], a[136:139], v[60:63]
    v_mfma_f32_16x16x32_bf16 v[80:83], a[168:171], a[156:159], v[80:83]
    s_waitcnt lgkmcnt(0)
    v_mfma_f32_16x16x32_bf16 v[64:67], a[172:175], a[136:139], v[64:67]
    v_mfma_f32_16x16x32_bf16 v[84:87], a[172:175], a[156:159], v[84:87]
    v_cvt_pk_bf16_f32 v88, v48, v49
    v_cvt_pk_bf16_f32 v100, v68, v69
    v_cvt_pk_bf16_f32 v89, v50, v51
    v_cvt_pk_bf16_f32 v101, v70, v71
    v_cvt_pk_bf16_f32 v90, v52, v53
    v_cvt_pk_bf16_f32 v102, v72, v73
    v_cvt_pk_bf16_f32 v91, v54, v55
    v_cvt_pk_bf16_f32 v103, v74, v75
    v_cvt_pk_bf16_f32 v92, v56, v57
    v_cvt_pk_bf16_f32 v104, v76, v77
    v_cvt_pk_bf16_f32 v93, v58, v59
    v_cvt_pk_bf16_f32 v105, v78, v79
    v_cvt_pk_bf16_f32 v94, v60, v61
    v_cvt_pk_bf16_f32 v106, v80, v81
    v_cvt_pk_bf16_f32 v95, v62, v63
    v_cvt_pk_bf16_f32 v107, v82, v83
    v_cvt_pk_bf16_f32 v96, v64, v65
    v_cvt_pk_bf16_f32 v108, v84, v85
    v_cvt_pk_bf16_f32 v97, v66, v67
    v_cvt_pk_bf16_f32 v109, v86, v87
    ds_write_b64 v230, v[88:89] offset:0
    ds_write_b64 v230, v[90:91] offset:32
    ds_write_b64 v230, v[92:93] offset:64
    ds_write_b64 v230, v[94:95] offset:96
    ds_write_b64 v230, v[96:97] offset:128
    ds_write_b64 v230, v[100:101] offset:2560
    ds_write_b64 v230, v[102:103] offset:2592
    ds_write_b64 v230, v[104:105] offset:2624
    ds_write_b64 v230, v[106:107] offset:2656
    ds_write_b64 v230, v[108:109] offset:2688
    s_lshl_b32 s3, s29, 2
    s_add_u32 s3, s3, s28
    s_mul_i32 s3, s3, 81920
    s_mul_i32 s4, s31, 1280
    s_add_u32 s3, s3, s4
    s_mul_i32 s4, s30, 160
    s_add_u32 s3, s3, s4
    s_waitcnt lgkmcnt(0)
    ds_read_b128 v[48:51], v231 offset:0
    ds_read_b128 v[52:55], v231 offset:1024
    ds_read_b128 v[56:59], v231 offset:2048
    ds_read_b128 v[60:63], v231 offset:3072
    ds_read_b128 v[64:67], v231 offset:4096
    s_waitcnt lgkmcnt(4)
    buffer_store_dwordx4 v[48:51], v220, s[96:99], s3 offen
    s_waitcnt lgkmcnt(3)
    buffer_store_dwordx4 v[52:55], v221, s[96:99], s3 offen
    s_waitcnt lgkmcnt(2)
    buffer_store_dwordx4 v[56:59], v222, s[96:99], s3 offen
    s_waitcnt lgkmcnt(1)
    buffer_store_dwordx4 v[60:63], v223, s[96:99], s3 offen
    s_waitcnt lgkmcnt(0)
    buffer_store_dwordx4 v[64:67], v224, s[96:99], s3 offen
    s_endpgm
L_A:
    s_mov_b32 s31, 0
    s_and_b32 s29, s2, 3
    s_lshl_b32 s29, s29, 2
    s_bfe_u32 s5, s2, 0x20004
    s_add_u32 s29, s29, s5
    s_and_b32 s30, s2, 4
    s_bfe_u32 s6, s2, 0x20006
    s_add_u32 s30, s30, s6
    v_lshrrev_b32 v13, 6, v0
    s_nop 0
    v_readfirstlane_b32 s28, v13
    v_and_b32 v0, 63, v0
    s_add_u32 s5, s5, s6
    s_and_b32 s6, s2, 3
    s_add_u32 s5, s5, s6
    s_bfe_u32 s6, s2, 0x10002
    s_mul_i32 s6, s6, 2
    s_add_u32 s5, s5, s6
    s_cmp_ge_u32 s5, 10
    s_cselect_b32 s6, 10, 0
    s_sub_u32 s5, s5, s6
    s_cmp_ge_u32 s5, 5
    s_cselect_b32 s6, 5, 0
    s_sub_u32 s5, s5, s6
    s_and_b32 s3, s30, 3
    s_add_u32 s93, s5, 9
    s_sub_u32 s93, s93, s3
    s_cmp_ge_u32 s93, 10
    s_cselect_b32 s6, 10, 0
    s_sub_u32 s93, s93, s6
    s_cmp_ge_u32 s93, 5
    s_cselect_b32 s6, 5, 0
    s_sub_u32 s93, s93, s6
    s_lshl_b32 s93, s93, 8
    s_lshl_b32 s6, s29, 2
    s_add_u32 s6, s6, s3
    s_mul_i32 s6, s6, 40960
    s_add_u32 s93, s93, s6
    s_lshl_b32 s3, s29, 2
    s_add_u32 s3, s3, s28
    s_mul_i32 s3, s3, 40960
    s_mul_i32 s4, s30, 160
    s_lshl_b32 s32, s5, 8
    s_add_u32 s32, s32, s3
    s_mul_i32 s37, s5, 491520
    s_add_u32 s37, s37, s4
    s_add_u32 s5, s5, 1
    s_cmp_ge_u32 s5, 5
    s_cselect_b32 s5, 0, s5
    s_lshl_b32 s33, s5, 8
    s_add_u32 s33, s33, s3
    s_mul_i32 s38, s5, 491520
    s_add_u32 s38, s38, s4
    s_add_u32 s5, s5, 1
    s_cmp_ge_u32 s5, 5
    s_cselect_b32 s5, 0, s5
    s_lshl_b32 s34, s5, 8
    s_add_u32 s34, s34, s3
    s_mul_i32 s39, s5, 491520
    s_add_u32 s39, s39, s4
    s_add_u32 s5, s5, 1
    s_cmp_ge_u32 s5, 5
    s_cselect_b32 s5, 0, s5
    s_lshl_b32 s35, s5, 8
    s_add_u32 s35, s35, s3
    s_mul_i32 s40, s5, 491520
    s_add_u32 s40, s40, s4
    s_add_u32 s5, s5, 1
    s_cmp_ge_u32 s5, 5
    s_cselect_b32 s5, 0, s5
    s_lshl_b32 s36, s5, 8
    s_add_u32 s36, s36, s3
    s_mul_i32 s41, s5, 491520
    s_add_u32 s41, s41, s4
    s_mul_i32 s42, s28, 5120
    s_lshl_b32 s92, s28, 13
    v_lshrrev_b32 v16, 3, v0
    v_lshrrev_b32 v17, 4, v0
    v_and_b32 v18, 7, v0
    v_xor_b32 v17, v17, v18
    v_mul_u32_u24 v16, 1280, v16
    v_lshl_add_u32 v9, v17, 4, v16
    v_xor_b32 v10, 64, v9
    v_add_u32 v10, 10240, v10
    s_mul_i32 s3, s28, 122880
    v_add_u32 v16, 0, v0
    v_mul_u32_u24 v17, 6554, v16
    v_lshrrev_b32 v17, 16, v17
    v_mul_u32_u24 v18, 10, v17
    v_sub_u32 v18, v16, v18
    v_and_b32 v19, 12, v17
    v_lshrrev_b32 v20, 2, v17
    v_and_b32 v20, 4, v20
    v_and_b32 v17, 3, v17
    v_lshl_add_u32 v17, v19, 1, v17
    v_add_u32 v17, v17, v20
    v_mul_u32_u24 v17, 3840, v17
    v_lshlrev_b32 v18, 4, v18
    v_add3_u32 v4, v17, v18, s3
    v_add_u32 v16, 64, v0
    v_mul_u32_u24 v17, 6554, v16
    v_lshrrev_b32 v17, 16, v17
    v_mul_u32_u24 v18, 10, v17
    v_sub_u32 v18, v16, v18
    v_and_b32 v19, 12, v17
    v_lshrrev_b32 v20, 2, v17
    v_and_b32 v20, 4, v20
    v_and_b32 v17, 3, v17
    v_lshl_add_u32 v17, v19, 1, v17
    v_add_u32 v17, v17, v20
    v_mul_u32_u24 v17, 3840, v17
    v_lshlrev_b32 v18, 4, v18
    v_add3_u32 v5, v17, v18, s3
    v_add_u32 v16, 128, v0
    v_mul_u32_u24 v17, 6554, v16
    v_lshrrev_b32 v17, 16, v17
    v_mul_u32_u24 v18, 10, v17
    v_sub_u32 v18, v16, v18
    v_and_b32 v19, 12, v17
    v_lshrrev_b32 v20, 2, v17
    v_and_b32 v20, 4, v20
    v_and_b32 v17, 3, v17
    v_lshl_add_u32 v17, v19, 1, v17
    v_add_u32 v17, v17, v20
    v_mul_u32_u24 v17, 3840, v17
    v_lshlrev_b32 v18, 4, v18
    v_add3_u32 v6, v17, v18, s3
    v_add_u32 v16, 192, v0
    v_mul_u32_u24 v17, 6554, v16
    v_lshrrev_b32 v17, 16, v17
    v_mul_u32_u24 v18, 10, v17
    v_sub_u32 v18, v16, v18
    v_and_b32 v19, 12, v17
    v_lshrrev_b32 v20, 2, v17
    v_and_b32 v20, 4, v20
    v_and_b32 v17, 3, v17
    v_lshl_add_u32 v17, v19, 1, v17
    v_add_u32 v17, v17, v20
    v_mul_u32_u24 v17, 3840, v17
    v_lshlrev_b32 v18, 4, v18
    v_add3_u32 v7, v17, v18, s3
    v_add_u32 v16, 256, v0
    v_mul_u32_u24 v17, 6554, v16
    v_lshrrev_b32 v17, 16, v17
    v_mul_u32_u24 v18, 10, v17
    v_sub_u32 v18, v16, v18
    v_and_b32 v19, 12, v17
    v_lshrrev_b32 v20, 2, v17
    v_and_b32 v20, 4, v20
    v_and_b32 v17, 3, v17
    v_lshl_add_u32 v17, v19, 1, v17
    v_add_u32 v17, v17, v20
    v_mul_u32_u24 v17, 3840, v17
    v_lshlrev_b32 v18, 4, v18
    v_add3_u32 v8, v17, v18, s3
    s_waitcnt lgkmcnt(0)
    s_mov_b32 s8, s50
    s_mov_b32 s9, s51
    s_mov_b32 s10, 2621440
    s_mov_b32 s11, 0x20000
    s_cmp_lg_u32 s28, 0
    s_cbranch_scc1 Lxh_17
    v_lshrrev_b32 v16, 1, v0
    v_mul_u32_u24 v16, 1280, v16
    v_and_b32 v17, 1, v0
    v_lshl_add_u32 v16, v17, 7, v16
    buffer_load_dword v254, v16, s[8:11], s93 offen
Lxh_17:
    s_mov_b32 s8, s44
    s_mov_b32 s9, s45
    s_mov_b32 s10, 2621440
    s_mov_b32 s11, 0x20000
    s_mov_b32 s12, s46
    s_mov_b32 s13, s47
    s_mov_b32 s14, 2457600
    s_mov_b32 s15, 0x20000
    s_mov_b32 s20, s60
    s_mov_b32 s21, s61
    s_mov_b32 s22, 256
    s_mov_b32 s23, 0x20000
    s_mov_b32 s16, s62
    s_mov_b32 s17, s63
    s_mov_b32 s18, 33554432
    s_mov_b32 s19, 0x20000
    s_mov_b32 s24, s52
    s_mov_b32 s25, s53
    s_mov_b32 s26, 2457600
    s_mov_b32 s27, 0x20000
    s_mov_b32 s88, s56
    s_mov_b32 s89, s57
    s_mov_b32 s90, 819200
    s_mov_b32 s91, 0x20000
    s_mov_b32 s44, s48
    s_mov_b32 s45, s49
    s_mov_b32 s46, 819200
    s_mov_b32 s47, 0x20000
    s_mov_b32 s96, s58
    s_mov_b32 s97, s59
    s_mov_b32 s98, 5242880
    s_mov_b32 s99, 0x20000
    s_or_b32 s3, s2, s28
    s_cmp_lg_u32 s3, 0
    s_cbranch_scc1 Lnonce_18
    s_or_b32 s43, s94, 1
    v_mov_b32 v88, s43
    v_mov_b32 v89, 0
    s_mov_b64 exec, 1
    buffer_store_dword v88, v89, s[20:23], 0 offen sc1
    s_mov_b64 exec, -1
Lnonce_18:
    v_and_b32 v16, 15, v0
    v_lshrrev_b32 v17, 1, v16
    v_lshrrev_b32 v18, 4, v0
    v_xor_b32 v17, v17, v18
    v_lshlrev_b32 v16, 7, v16
    v_lshl_add_u32 v16, v17, 4, v16
    s_add_u32 s3, s92, 81920
    v_add_u32 v11, s3, v16
    v_xor_b32 v12, 64, v11
    v_lshrrev_b32 v16, 2, v0
    v_mul_u32_u24 v16, 160, v16
    v_and_b32 v17, 3, v0
    v_lshl_add_u32 v1, v17, 3, v16
    v_add_u32 v2, 61440, v1
    v_add_u32 v3, 122880, v1
    s_mov_b32 s54, 0xffff0000
    s_mov_b32 s55, 0xffffffff
    s_mov_b32 s56, 0x0
    s_mov_b32 s57, 0xffffffff
    s_mov_b32 s58, 0x0
    s_mov_b32 s59, 0xffff0000
    s_mov_b32 s60, 0xffff
    s_mov_b32 s61, 0x0
    s_mov_b32 s62, 0xffffffff
    s_mov_b32 s63, 0x0
    s_mov_b32 s64, 0xffffffff
    s_mov_b32 s65, 0xffff
    s_mov_b32 s48, 0x3fb8aa3b
    s_mov_b32 s49, 0x3fb8aa3b
    v_and_b32 v240, 15, v0
    v_lshrrev_b32 v241, 4, v0
    v_mul_u32_u24 v221, 160, v240
    v_lshrrev_b32 v16, 2, v240
    v_xor_b32 v16, v16, v241
    v_lshl_add_u32 v221, v16, 3, v221
    v_lshlrev_b32 v16, 3, v241
    v_xor_b32 v242, v16, v1
    s_mul_i32 s3, s28, 2560
    s_add_u32 s3, s3, 143360
    v_lshl_add_u32 v220, v0, 3, s3
    v_lshlrev_b32 v241, 2, v241
    v_mov_b32 v16, 0xf149f2ca
    v_sub_u32 v17, v240, v241
    v_subrev_u32 v17, 0, v17
    v_and_b32 v18, 0x80000001, v17
    v_cmp_eq_u32 vcc, 0, v18
    s_nop 1
    v_cndmask_b32_e64 v222, v16, 0, vcc
    v_cmp_eq_u32 vcc, 0x80000000, v18
    s_nop 1
    v_cndmask_b32_e64 v226, v16, 0, vcc
    v_mov_b32 v236, v226
    v_sub_u32 v17, v240, v241
    v_subrev_u32 v17, 1, v17
    v_and_b32 v18, 0x80000001, v17
    v_cmp_eq_u32 vcc, 0, v18
    s_nop 1
    v_cndmask_b32_e64 v223, v16, 0, vcc
    v_cmp_eq_u32 vcc, 0x80000000, v18
    s_nop 1
    v_cndmask_b32_e64 v227, v16, 0, vcc
    v_mov_b32 v237, v227
    v_sub_u32 v17, v240, v241
    v_subrev_u32 v17, 2, v17
    v_and_b32 v18, 0x80000001, v17
    v_cmp_eq_u32 vcc, 0, v18
    s_nop 1
    v_cndmask_b32_e64 v224, v16, 0, vcc
    v_cmp_eq_u32 vcc, 0x80000000, v18
    s_nop 1
    v_cndmask_b32_e64 v228, v16, 0, vcc
    v_mov_b32 v238, v228
    v_sub_u32 v17, v240, v241
    v_subrev_u32 v17, 3, v17
    v_and_b32 v18, 0x80000001, v17
    v_cmp_eq_u32 vcc, 0, v18
    s_nop 1
    v_cndmask_b32_e64 v225, v16, 0, vcc
    v_cmp_eq_u32 vcc, 0x80000000, v18
    s_nop 1
    v_cndmask_b32_e64 v229, v16, 0, vcc
    v_mov_b32 v239, v229
    v_and_b32 v17, 1, v240
    v_lshlrev_b32 v18, 4, v17
    v_mov_b32 v19, 0xffff
    v_lshlrev_b32 v19, v18, v19
    v_add_u32 v18, 0, v241
    v_cmp_le_u32 vcc, v18, v240
    s_nop 1
    v_cndmask_b32_e64 v232, 0, v19, vcc
    v_cndmask_b32_e64 v230, v19, 0, vcc
    v_add_u32 v18, 2, v241
    v_cmp_le_u32 vcc, v18, v240
    s_nop 1
    v_cndmask_b32_e64 v233, 0, v19, vcc
    v_cndmask_b32_e64 v231, v19, 0, vcc
    s_add_u32 s3, s42, 102400
    v_add_u32 v235, s3, v242
    s_sub_u32 s3, s3, 2560
    s_cmp_eq_u32 s28, 0
    s_cselect_b32 s3, 153600, s3
    v_add_u32 v234, s3, v242
    s_add_u32 m0, s42, 0
    s_add_u32 s7, s37, 1280
    buffer_load_dwordx4 v4, s[12:15], s7 offen lds
    s_add_u32 m0, s42, 1024
    s_add_u32 s7, s37, 1280
    buffer_load_dwordx4 v5, s[12:15], s7 offen lds
    s_add_u32 m0, s42, 2048
    s_add_u32 s7, s37, 1280
    buffer_load_dwordx4 v6, s[12:15], s7 offen lds
    s_add_u32 m0, s42, 3072
    s_add_u32 s7, s37, 1280
    buffer_load_dwordx4 v7, s[12:15], s7 offen lds
    s_add_u32 m0, s42, 4096
    s_add_u32 s7, s37, 1280
    buffer_load_dwordx4 v8, s[12:15], s7 offen lds
    s_add_u32 m0, s92, 81920
    s_nop 0
    buffer_load_dwordx4 v9, s[8:11], s32 offen lds
    s_add_u32 m0, s92, 82944
    s_nop 0
    buffer_load_dwordx4 v10, s[8:11], s32 offen lds
    s_add_u32 m0, s92, 83968
    s_add_u32 s7, s32, 20480
    buffer_load_dwordx4 v9, s[8:11], s7 offen lds
    s_add_u32 m0, s92, 84992
    s_add_u32 s7, s32, 20480
    buffer_load_dwordx4 v10, s[8:11], s7 offen lds
    s_add_u32 m0, s92, 86016
    s_add_u32 s7, s32, 128
    buffer_load_dwordx4 v9, s[8:11], s7 offen lds
    s_add_u32 m0, s92, 87040
    s_add_u32 s7, s32, 128
    buffer_load_dwordx4 v10, s[8:11], s7 offen lds
    s_add_u32 m0, s92, 88064
    s_add_u32 s7, s32, 20608
    buffer_load_dwordx4 v9, s[8:11], s7 offen lds
    s_add_u32 m0, s92, 89088
    s_add_u32 s7, s32, 20608
    buffer_load_dwordx4 v10, s[8:11], s7 offen lds
    s_barrier
    s_add_u32 m0, s42, 20480
    s_add_u32 s7, s38, 1280
    buffer_load_dwordx4 v4, s[12:15], s7 offen lds
    s_add_u32 m0, s42, 21504
    s_add_u32 s7, s38, 1280
    buffer_load_dwordx4 v5, s[12:15], s7 offen lds
    s_add_u32 m0, s42, 22528
    s_add_u32 s7, s38, 1280
    buffer_load_dwordx4 v6, s[12:15], s7 offen lds
    s_add_u32 m0, s42, 23552
    s_add_u32 s7, s38, 1280
    buffer_load_dwordx4 v7, s[12:15], s7 offen lds
    s_add_u32 m0, s42, 24576
    s_add_u32 s7, s38, 1280
    buffer_load_dwordx4 v8, s[12:15], s7 offen lds
    s_add_u32 m0, s92, 122880
    s_nop 0
    buffer_load_dwordx4 v9, s[8:11], s33 offen lds
    s_add_u32 m0, s92, 123904
    s_nop 0
    buffer_load_dwordx4 v10, s[8:11], s33 offen lds
    s_add_u32 m0, s92, 124928
    s_add_u32 s7, s33, 20480
    buffer_load_dwordx4 v9, s[8:11], s7 offen lds
    s_add_u32 m0, s92, 125952
    s_add_u32 s7, s33, 20480
    buffer_load_dwordx4 v10, s[8:11], s7 offen lds
    s_add_u32 m0, s92, 126976
    s_add_u32 s7, s33, 128
    buffer_load_dwordx4 v9, s[8:11], s7 offen lds
    s_add_u32 m0, s92, 128000
    s_add_u32 s7, s33, 128
    buffer_load_dwordx4 v10, s[8:11], s7 offen lds
    s_add_u32 m0, s92, 129024
    s_add_u32 s7, s33, 20608
    buffer_load_dwordx4 v9, s[8:11], s7 offen lds
    s_add_u32 m0, s92, 130048
    s_add_u32 s7, s33, 20608
    buffer_load_dwordx4 v10, s[8:11], s7 offen lds
    s_waitcnt vmcnt(17)
    s_barrier
    ds_read_b128 a[0:3], v11 offset:0
    ds_read_b128 a[4:7], v11 offset:2048
    ds_read_b128 a[8:11], v12 offset:0
    ds_read_b128 a[12:15], v12 offset:2048
    ds_read_b64_tr_b16 a[160:161], v1 offset:0
    ds_read_b64_tr_b16 a[162:163], v1 offset:2560
    s_add_u32 m0, s42, 40960
    s_add_u32 s7, s39, 1280
    buffer_load_dwordx4 v4, s[12:15], s7 offen lds
    ds_read_b64_tr_b16 a[164:165], v1 offset:32
    ds_read_b64_tr_b16 a[166:167], v1 offset:2592
    s_add_u32 m0, s42, 41984
    s_add_u32 s7, s39, 1280
    buffer_load_dwordx4 v5, s[12:15], s7 offen lds
    ds_read_b64_tr_b16 a[168:169], v1 offset:64
    ds_read_b64_tr_b16 a[170:171], v1 offset:2624
    ds_read_b64_tr_b16 a[172:173], v1 offset:96
    ds_read_b64_tr_b16 a[174:175], v1 offset:2656
    s_add_u32 m0, s42, 43008
    s_add_u32 s7, s39, 1280
    buffer_load_dwordx4 v6, s[12:15], s7 offen lds
    ds_read_b64_tr_b16 a[176:177], v1 offset:128
    ds_read_b64_tr_b16 a[178:179], v1 offset:2688
    s_add_u32 m0, s42, 44032
    s_add_u32 s7, s39, 1280
    buffer_load_dwordx4 v7, s[12:15], s7 offen lds
    ds_read_b64_tr_b16 a[180:181], v1 offset:5120
    ds_read_b64_tr_b16 a[182:183], v1 offset:7680
    ds_read_b64_tr_b16 a[184:185], v1 offset:5152
    ds_read_b64_tr_b16 a[186:187], v1 offset:7712
    s_add_u32 m0, s42, 45056
    s_add_u32 s7, s39, 1280
    buffer_load_dwordx4 v8, s[12:15], s7 offen lds
    ds_read_b64_tr_b16 a[188:189], v1 offset:5184
    ds_read_b64_tr_b16 a[190:191], v1 offset:7744
    s_waitcnt lgkmcnt(14)
    v_mfma_f32_16x16x32_bf16 v[48:51], a[160:163], a[0:3], 0
    v_mfma_f32_16x16x32_bf16 v[68:71], a[160:163], a[4:7], 0
    s_waitcnt lgkmcnt(10)
    ds_read_b64_tr_b16 a[160:161], v1 offset:5216
    ds_read_b64_tr_b16 a[162:163], v1 offset:7776
    v_mfma_f32_16x16x32_bf16 v[52:55], a[164:167], a[0:3], 0
    v_mfma_f32_16x16x32_bf16 v[72:75], a[164:167], a[4:7], 0
    s_waitcnt vmcnt(18)
    ds_read_b128 a[16:19], v11 offset:4096
    ds_read_b128 a[20:23], v11 offset:6144
    ds_read_b128 a[24:27], v12 offset:4096
    ds_read_b128 a[28:31], v12 offset:6144
    ds_read_b64_tr_b16 a[164:165], v1 offset:5248
    ds_read_b64_tr_b16 a[166:167], v1 offset:7808
    v_mfma_f32_16x16x32_bf16 v[56:59], a[168:171], a[0:3], 0
    v_mfma_f32_16x16x32_bf16 v[76:79], a[168:171], a[4:7], 0
    s_waitcnt lgkmcnt(14)
    ds_read_b64_tr_b16 a[168:169], v1 offset:10240
    ds_read_b64_tr_b16 a[170:171], v1 offset:12800
    v_mfma_f32_16x16x32_bf16 v[60:63], a[172:175], a[0:3], 0
    v_mfma_f32_16x16x32_bf16 v[80:83], a[172:175], a[4:7], 0
    s_waitcnt lgkmcnt(4)
    s_add_u32 m0, s92, 81920
    s_nop 0
    buffer_load_dwordx4 v9, s[8:11], s34 offen lds
    ds_read_b64_tr_b16 a[172:173], v1 offset:10272
    ds_read_b64_tr_b16 a[174:175], v1 offset:12832
    v_mfma_f32_16x16x32_bf16 v[64:67], a[176:179], a[0:3], 0
    v_mfma_f32_16x16x32_bf16 v[84:87], a[176:179], a[4:7], 0
    s_add_u32 m0, s92, 82944
    s_nop 0
    buffer_load_dwordx4 v10, s[8:11], s34 offen lds
    ds_read_b64_tr_b16 a[176:177], v1 offset:10304
    ds_read_b64_tr_b16 a[178:179], v1 offset:12864
    v_mfma_f32_16x16x32_bf16 v[48:51], a[180:183], a[8:11], v[48:51]
    v_mfma_f32_16x16x32_bf16 v[68:71], a[180:183], a[12:15], v[68:71]
    s_add_u32 m0, s92, 83968
    s_add_u32 s7, s34, 20480
    buffer_load_dwordx4 v9, s[8:11], s7 offen lds
    ds_read_b64_tr_b16 a[180:181], v1 offset:10336
    ds_read_b64_tr_b16 a[182:183], v1 offset:12896
    v_mfma_f32_16x16x32_bf16 v[52:55], a[184:187], a[8:11], v[52:55]
    v_mfma_f32_16x16x32_bf16 v[72:75], a[184:187], a[12:15], v[72:75]
    s_add_u32 m0, s92, 84992
    s_add_u32 s7, s34, 20480
    buffer_load_dwordx4 v10, s[8:11], s7 offen lds
    s_waitcnt vmcnt(9)
    ds_read_b128 a[32:35], v11 offset:40960
    ds_read_b128 a[36:39], v11 offset:43008
    ds_read_b128 a[40:43], v12 offset:40960
    ds_read_b128 a[44:47], v12 offset:43008
    ds_read_b128 a[48:51], v11 offset:45056
    ds_read_b128 a[52:55], v11 offset:47104
    ds_read_b128 a[56:59], v12 offset:45056
    ds_read_b128 a[60:63], v12 offset:47104
    ds_read_b64_tr_b16 a[184:185], v1 offset:10368
    ds_read_b64_tr_b16 a[186:187], v1 offset:12928
    v_mfma_f32_16x16x32_bf16 v[56:59], a[188:191], a[8:11], v[56:59]
    v_mfma_f32_16x16x32_bf16 v[76:79], a[188:191], a[12:15], v[76:79]
    s_add_u32 m0, s92, 86016
    s_add_u32 s7, s34, 128
    buffer_load_dwordx4 v9, s[8:11], s7 offen lds
    ds_read_b64_tr_b16 a[188:189], v1 offset:15360
    ds_read_b64_tr_b16 a[190:191], v1 offset:17920
    v_mfma_f32_16x16x32_bf16 v[60:63], a[160:163], a[8:11], v[60:63]
    v_mfma_f32_16x16x32_bf16 v[80:83], a[160:163], a[12:15], v[80:83]
    s_waitcnt lgkmcnt(15)
    s_add_u32 m0, s92, 87040
    s_add_u32 s7, s34, 128
    buffer_load_dwordx4 v10, s[8:11], s7 offen lds
    ds_read_b64_tr_b16 a[160:161], v1 offset:15392
    ds_read_b64_tr_b16 a[162:163], v1 offset:17952
    v_mfma_f32_16x16x32_bf16 v[64:67], a[164:167], a[8:11], v[64:67]
    v_mfma_f32_16x16x32_bf16 v[84:87], a[164:167], a[12:15], v[84:87]
    s_add_u32 m0, s92, 88064
    s_add_u32 s7, s34, 20608
    buffer_load_dwordx4 v9, s[8:11], s7 offen lds
    ds_read_b64_tr_b16 a[164:165], v1 offset:15424
    ds_read_b64_tr_b16 a[166:167], v1 offset:17984
    v_mfma_f32_16x16x32_bf16 v[48:51], a[168:171], a[16:19], v[48:51]
    v_mfma_f32_16x16x32_bf16 v[68:71], a[168:171], a[20:23], v[68:71]
    s_add_u32 m0, s92, 89088
    s_add_u32 s7, s34, 20608
    buffer_load_dwordx4 v10, s[8:11], s7 offen lds
    ds_read_b64_tr_b16 a[168:169], v1 offset:15456
    ds_read_b64_tr_b16 a[170:171], v1 offset:18016
    v_mfma_f32_16x16x32_bf16 v[52:55], a[172:175], a[16:19], v[52:55]
    v_mfma_f32_16x16x32_bf16 v[72:75], a[172:175], a[20:23], v[72:75]
    s_waitcnt lgkmcnt(15)
    s_waitcnt lgkmcnt(10)
    s_add_u32 m0, s92, 122880
    s_nop 0
    buffer_load_dwordx4 v9, s[8:11], s35 offen lds
    ds_read_b64_tr_b16 a[172:173], v1 offset:15488
    ds_read_b64_tr_b16 a[174:175], v1 offset:18048
    v_mfma_f32_16x16x32_bf16 v[56:59], a[176:179], a[16:19], v[56:59]
    v_mfma_f32_16x16x32_bf16 v[76:79], a[176:179], a[20:23], v[76:79]
    s_add_u32 m0, s92, 123904
    s_nop 0
    buffer_load_dwordx4 v10, s[8:11], s35 offen lds
    s_waitcnt vmcnt(23)
    s_barrier
    ds_read_b64_tr_b16 a[176:177], v1 offset:20480
    ds_read_b64_tr_b16 a[178:179], v1 offset:23040
    v_mfma_f32_16x16x32_bf16 v[60:63], a[180:183], a[16:19], v[60:63]
    v_mfma_f32_16x16x32_bf16 v[80:83], a[180:183], a[20:23], v[80:83]
    s_waitcnt lgkmcnt(10)
    s_add_u32 m0, s92, 124928
    s_add_u32 s7, s35, 20480
    buffer_load_dwordx4 v9, s[8:11], s7 offen lds
    ds_read_b64_tr_b16 a[180:181], v1 offset:20512
    ds_read_b64_tr_b16 a[182:183], v1 offset:23072
    v_mfma_f32_16x16x32_bf16 v[64:67], a[184:187], a[16:19], v[64:67]
    v_mfma_f32_16x16x32_bf16 v[84:87], a[184:187], a[20:23], v[84:87]
    s_add_u32 m0, s92, 125952
    s_add_u32 s7, s35, 20480
    buffer_load_dwordx4 v10, s[8:11], s7 offen lds
    ds_read_b64_tr_b16 a[184:185], v1 offset:20544
    ds_read_b64_tr_b16 a[186:187], v1 offset:23104
    v_mfma_f32_16x16x32_bf16 v[48:51], a[188:191], a[24:27], v[48:51]
    v_mfma_f32_16x16x32_bf16 v[68:71], a[188:191], a[28:31], v[68:71]
    s_waitcnt lgkmcnt(10)
    s_add_u32 m0, s92, 126976
    s_add_u32 s7, s35, 128
    buffer_load_dwordx4 v9, s[8:11], s7 offen lds
    ds_read_b64_tr_b16 a[188:189], v1 offset:20576
    ds_read_b64_tr_b16 a[190:191], v1 offset:23136
    v_mfma_f32_16x16x32_bf16 v[52:55], a[160:163], a[24:27], v[52:55]
    v_mfma_f32_16x16x32_bf16 v[72:75], a[160:163], a[28:31], v[72:75]
    s_add_u32 m0, s92, 128000
    s_add_u32 s7, s35, 128
    buffer_load_dwordx4 v10, s[8:11], s7 offen lds
    ds_read_b64_tr_b16 a[160:161], v1 offset:20608
    ds_read_b64_tr_b16 a[162:163], v1 offset:23168
    v_mfma_f32_16x16x32_bf16 v[56:59], a[164:167], a[24:27], v[56:59]
    v_mfma_f32_16x16x32_bf16 v[76:79], a[164:167], a[28:31], v[76:79]
    s_waitcnt lgkmcnt(10)
    s_add_u32 m0, s92, 129024
    s_add_u32 s7, s35, 20608
    buffer_load_dwordx4 v9, s[8:11], s7 offen lds
    ds_read_b64_tr_b16 a[164:165], v1 offset:25600
    ds_read_b64_tr_b16 a[166:167], v1 offset:28160
    v_mfma_f32_16x16x32_bf16 v[60:63], a[168:171], a[24:27], v[60:63]
    v_mfma_f32_16x16x32_bf16 v[80:83], a[168:171], a[28:31], v[80:83]
    s_add_u32 m0, s92, 130048
    s_add_u32 s7, s35, 20608
    buffer_load_dwordx4 v10, s[8:11], s7 offen lds
    ds_read_b64_tr_b16 a[168:169], v1 offset:25632
    ds_read_b64_tr_b16 a[170:171], v1 offset:28192
    v_mfma_f32_16x16x32_bf16 v[64:67], a[172:175], a[24:27], v[64:67]
    v_mfma_f32_16x16x32_bf16 v[84:87], a[172:175], a[28:31], v[84:87]
    s_waitcnt lgkmcnt(10)
    s_add_u32 m0, s42, 61440
    s_add_u32 s7, s40, 1280
    buffer_load_dwordx4 v4, s[12:15], s7 offen lds
    ds_read_b64_tr_b16 a[172:173], v1 offset:25664
    ds_read_b64_tr_b16 a[174:175], v1 offset:28224
    v_mfma_f32_16x16x32_bf16 v[48:51], a[176:179], a[32:35], v[48:51]
    v_mfma_f32_16x16x32_bf16 v[68:71], a[176:179], a[36:39], v[68:71]
    s_add_u32 m0, s42, 62464
    s_add_u32 s7, s40, 1280
    buffer_load_dwordx4 v5, s[12:15], s7 offen lds
    ds_read_b64_tr_b16 a[176:177], v1 offset:25696
    ds_read_b64_tr_b16 a[178:179], v1 offset:28256
    v_mfma_f32_16x16x32_bf16 v[52:55], a[180:183], a[32:35], v[52:55]
    v_mfma_f32_16x16x32_bf16 v[72:75], a[180:183], a[36:39], v[72:75]
    s_waitcnt lgkmcnt(10)
    s_add_u32 m0, s42, 63488
    s_add_u32 s7, s40, 1280
    buffer_load_dwordx4 v6, s[12:15], s7 offen lds
    ds_read_b64_tr_b16 a[180:181], v1 offset:25728
    ds_read_b64_tr_b16 a[182:183], v1 offset:28288
    v_mfma_f32_16x16x32_bf16 v[56:59], a[184:187], a[32:35], v[56:59]
    v_mfma_f32_16x16x32_bf16 v[76:79], a[184:187], a[36:39], v[76:79]
    s_add_u32 m0, s42, 64512
    s_add_u32 s7, s40, 1280
    buffer_load_dwordx4 v7, s[12:15], s7 offen lds
    ds_read_b64_tr_b16 a[184:185], v1 offset:30720
    ds_read_b64_tr_b16 a[186:187], v1 offset:33280
    v_mfma_f32_16x16x32_bf16 v[60:63], a[188:191], a[32:35], v[60:63]
    v_mfma_f32_16x16x32_bf16 v[80:83], a[188:191], a[36:39], v[80:83]
    s_waitcnt lgkmcnt(10)
    s_add_u32 m0, s42, 65536
    s_add_u32 s7, s40, 1280
    buffer_load_dwordx4 v8, s[12:15], s7 offen lds
    ds_read_b64_tr_b16 a[188:189], v1 offset:30752
    ds_read_b64_tr_b16 a[190:191], v1 offset:33312
    v_mfma_f32_16x16x32_bf16 v[64:67], a[160:163], a[32:35], v[64:67]
    v_mfma_f32_16x16x32_bf16 v[84:87], a[160:163], a[36:39], v[84:87]
    ds_read_b64_tr_b16 a[160:161], v1 offset:30784
    ds_read_b64_tr_b16 a[162:163], v1 offset:33344
    v_mfma_f32_16x16x32_bf16 v[48:51], a[164:167], a[40:43], v[48:51]
    v_mfma_f32_16x16x32_bf16 v[68:71], a[164:167], a[44:47], v[68:71]
    s_waitcnt lgkmcnt(10)
    ds_read_b64_tr_b16 a[164:165], v1 offset:30816
    ds_read_b64_tr_b16 a[166:167], v1 offset:33376
    v_mfma_f32_16x16x32_bf16 v[52:55], a[168:171], a[40:43], v[52:55]
    v_mfma_f32_16x16x32_bf16 v[72:75], a[168:171], a[44:47], v[72:75]
    s_waitcnt vmcnt(13)
    ds_read_b128 a[64:67], v11 offset:0
    ds_read_b128 a[68:71], v11 offset:2048
    ds_read_b128 a[72:75], v12 offset:0
    ds_read_b128 a[76:79], v12 offset:2048
    ds_read_b128 a[80:83], v11 offset:4096
    ds_read_b128 a[84:87], v11 offset:6144
    ds_read_b128 a[88:91], v12 offset:4096
    ds_read_b128 a[92:95], v12 offset:6144
    ds_read_b64_tr_b16 a[168:169], v1 offset:30848
    ds_read_b64_tr_b16 a[170:171], v1 offset:33408
    v_mfma_f32_16x16x32_bf16 v[56:59], a[172:175], a[40:43], v[56:59]
    v_mfma_f32_16x16x32_bf16 v[76:79], a[172:175], a[44:47], v[76:79]
    s_waitcnt lgkmcnt(15)
    ds_read_b64_tr_b16 a[172:173], v1 offset:35840
    ds_read_b64_tr_b16 a[174:175], v1 offset:38400
    v_mfma_f32_16x16x32_bf16 v[60:63], a[176:179], a[40:43], v[60:63]
    v_mfma_f32_16x16x32_bf16 v[80:83], a[176:179], a[44:47], v[80:83]
    ds_read_b64_tr_b16 a[176:177], v1 offset:35872
    ds_read_b64_tr_b16 a[178:179], v1 offset:38432
    v_mfma_f32_16x16x32_bf16 v[64:67], a[180:183], a[40:43], v[64:67]
    v_mfma_f32_16x16x32_bf16 v[84:87], a[180:183], a[44:47], v[84:87]
    ds_read_b64_tr_b16 a[180:181], v1 offset:35904
    ds_read_b64_tr_b16 a[182:183], v1 offset:38464
    v_mfma_f32_16x16x32_bf16 v[48:51], a[184:187], a[48:51], v[48:51]
    v_mfma_f32_16x16x32_bf16 v[68:71], a[184:187], a[52:55], v[68:71]
    s_waitcnt lgkmcnt(15)
    ds_read_b64_tr_b16 a[184:185], v1 offset:35936
    ds_read_b64_tr_b16 a[186:187], v1 offset:38496
    v_mfma_f32_16x16x32_bf16 v[52:55], a[188:191], a[48:51], v[52:55]
    v_mfma_f32_16x16x32_bf16 v[72:75], a[188:191], a[52:55], v[72:75]
    s_waitcnt lgkmcnt(10)
    s_add_u32 m0, s92, 81920
    s_nop 0
    buffer_load_dwordx4 v9, s[8:11], s36 offen lds
    ds_read_b64_tr_b16 a[188:189], v1 offset:35968
    ds_read_b64_tr_b16 a[190:191], v1 offset:38528
    v_mfma_f32_16x16x32_bf16 v[56:59], a[160:163], a[48:51], v[56:59]
    v_mfma_f32_16x16x32_bf16 v[76:79], a[160:163], a[52:55], v[76:79]
    s_add_u32 m0, s92, 82944
    s_nop 0
    buffer_load_dwordx4 v10, s[8:11], s36 offen lds
    s_waitcnt vmcnt(23)
    s_barrier
    ds_read_b64_tr_b16 a[160:161], v1 offset:40960
    ds_read_b64_tr_b16 a[162:163], v1 offset:43520
    v_mfma_f32_16x16x32_bf16 v[60:63], a[164:167], a[48:51], v[60:63]
    v_mfma_f32_16x16x32_bf16 v[80:83], a[164:167], a[52:55], v[80:83]
    s_waitcnt lgkmcnt(10)
    s_add_u32 m0, s92, 83968
    s_add_u32 s7, s36, 20480
    buffer_load_dwordx4 v9, s[8:11], s7 offen lds
    ds_read_b64_tr_b16 a[164:165], v1 offset:40992
    ds_read_b64_tr_b16 a[166:167], v1 offset:43552
    v_mfma_f32_16x16x32_bf16 v[64:67], a[168:171], a[48:51], v[64:67]
    v_mfma_f32_16x16x32_bf16 v[84:87], a[168:171], a[52:55], v[84:87]
    s_add_u32 m0, s92, 84992
    s_add_u32 s7, s36, 20480
    buffer_load_dwordx4 v10, s[8:11], s7 offen lds
    ds_read_b64_tr_b16 a[168:169], v1 offset:41024
    ds_read_b64_tr_b16 a[170:171], v1 offset:43584
    v_mfma_f32_16x16x32_bf16 v[48:51], a[172:175], a[56:59], v[48:51]
    v_mfma_f32_16x16x32_bf16 v[68:71], a[172:175], a[60:63], v[68:71]
    s_waitcnt lgkmcnt(10)
    s_add_u32 m0, s92, 86016
    s_add_u32 s7, s36, 128
    buffer_load_dwordx4 v9, s[8:11], s7 offen lds
    ds_read_b64_tr_b16 a[172:173], v1 offset:41056
    ds_read_b64_tr_b16 a[174:175], v1 offset:43616
    v_mfma_f32_16x16x32_bf16 v[52:55], a[176:179], a[56:59], v[52:55]
    v_mfma_f32_16x16x32_bf16 v[72:75], a[176:179], a[60:63], v[72:75]
    s_add_u32 m0, s92, 87040
    s_add_u32 s7, s36, 128
    buffer_load_dwordx4 v10, s[8:11], s7 offen lds
    ds_read_b64_tr_b16 a[176:177], v1 offset:41088
    ds_read_b64_tr_b16 a[178:179], v1 offset:43648
    v_mfma_f32_16x16x32_bf16 v[56:59], a[180:183], a[56:59], v[56:59]
    v_mfma_f32_16x16x32_bf16 v[76:79], a[180:183], a[60:63], v[76:79]
    s_waitcnt lgkmcnt(10)
    s_add_u32 m0, s92, 88064
    s_add_u32 s7, s36, 20608
    buffer_load_dwordx4 v9, s[8:11], s7 offen lds
    ds_read_b64_tr_b16 a[180:181], v1 offset:46080
    ds_read_b64_tr_b16 a[182:183], v1 offset:48640
    v_mfma_f32_16x16x32_bf16 v[60:63], a[184:187], a[56:59], v[60:63]
    v_mfma_f32_16x16x32_bf16 v[80:83], a[184:187], a[60:63], v[80:83]
    s_add_u32 m0, s92, 89088
    s_add_u32 s7, s36, 20608
    buffer_load_dwordx4 v10, s[8:11], s7 offen lds
    ds_read_b64_tr_b16 a[184:185], v1 offset:46112
    ds_read_b64_tr_b16 a[186:187], v1 offset:48672
    v_mfma_f32_16x16x32_bf16 v[64:67], a[188:191], a[56:59], v[64:67]
    v_mfma_f32_16x16x32_bf16 v[84:87], a[188:191], a[60:63], v[84:87]
    s_waitcnt lgkmcnt(10)
    s_add_u32 m0, s42, 0
    s_add_u32 s7, s41, 1280
    buffer_load_dwordx4 v4, s[12:15], s7 offen lds
    ds_read_b64_tr_b16 a[188:189], v1 offset:46144
    ds_read_b64_tr_b16 a[190:191], v1 offset:48704
    v_mfma_f32_16x16x32_bf16 v[48:51], a[160:163], a[64:67], v[48:51]
    v_mfma_f32_16x16x32_bf16 v[68:71], a[160:163], a[68:71], v[68:71]
    s_add_u32 m0, s42, 1024
    s_add_u32 s7, s41, 1280
    buffer_load_dwordx4 v5, s[12:15], s7 offen lds
    ds_read_b64_tr_b16 a[160:161], v1 offset:46176
    ds_read_b64_tr_b16 a[162:163], v1 offset:48736
    v_mfma_f32_16x16x32_bf16 v[52:55], a[164:167], a[64:67], v[52:55]
    v_mfma_f32_16x16x32_bf16 v[72:75], a[164:167], a[68:71], v[72:75]
    s_waitcnt lgkmcnt(10)
    s_add_u32 m0, s42, 2048
    s_add_u32 s7, s41, 1280
    buffer_load_dwordx4 v6, s[12:15], s7 offen lds
    ds_read_b64_tr_b16 a[164:165], v1 offset:46208
    ds_read_b64_tr_b16 a[166:167], v1 offset:48768
    v_mfma_f32_16x16x32_bf16 v[56:59], a[168:171], a[64:67], v[56:59]
    v_mfma_f32_16x16x32_bf16 v[76:79], a[168:171], a[68:71], v[76:79]
    s_add_u32 m0, s42, 3072
    s_add_u32 s7, s41, 1280
    buffer_load_dwordx4 v7, s[12:15], s7 offen lds
    ds_read_b64_tr_b16 a[168:169], v1 offset:51200
    ds_read_b64_tr_b16 a[170:171], v1 offset:53760
    v_mfma_f32_16x16x32_bf16 v[60:63], a[172:175], a[64:67], v[60:63]
    v_mfma_f32_16x16x32_bf16 v[80:83], a[172:175], a[68:71], v[80:83]
    s_waitcnt lgkmcnt(10)
    s_add_u32 m0, s42, 4096
    s_add_u32 s7, s41, 1280
    buffer_load_dwordx4 v8, s[12:15], s7 offen lds
    ds_read_b64_tr_b16 a[172:173], v1 offset:51232
    ds_read_b64_tr_b16 a[174:175], v1 offset:53792
    v_mfma_f32_16x16x32_bf16 v[64:67], a[176:179], a[64:67], v[64:67]
    v_mfma_f32_16x16x32_bf16 v[84:87], a[176:179], a[68:71], v[84:87]
    ds_read_b64_tr_b16 a[176:177], v1 offset:51264
    ds_read_b64_tr_b16 a[178:179], v1 offset:53824
    v_mfma_f32_16x16x32_bf16 v[48:51], a[180:183], a[72:75], v[48:51]
    v_mfma_f32_16x16x32_bf16 v[68:71], a[180:183], a[76:79], v[68:71]
    s_waitcnt lgkmcnt(10)
    ds_read_b64_tr_b16 a[180:181], v1 offset:51296
    ds_read_b64_tr_b16 a[182:183], v1 offset:53856
    v_mfma_f32_16x16x32_bf16 v[52:55], a[184:187], a[72:75], v[52:55]
    v_mfma_f32_16x16x32_bf16 v[72:75], a[184:187], a[76:79], v[72:75]
    s_waitcnt vmcnt(18)
    ds_read_b128 a[96:99], v11 offset:40960
    ds_read_b128 a[100:103], v11 offset:43008
    ds_read_b128 a[104:107], v12 offset:40960
    ds_read_b128 a[108:111], v12 offset:43008
    ds_read_b128 a[112:115], v11 offset:45056
    ds_read_b128 a[116:119], v11 offset:47104
    ds_read_b128 a[120:123], v12 offset:45056
    ds_read_b128 a[124:127], v12 offset:47104
    ds_read_b64_tr_b16 a[184:185], v1 offset:51328
    ds_read_b64_tr_b16 a[186:187], v1 offset:53888
    v_mfma_f32_16x16x32_bf16 v[56:59], a[188:191], a[72:75], v[56:59]
    v_mfma_f32_16x16x32_bf16 v[76:79], a[188:191], a[76:79], v[76:79]
    s_waitcnt lgkmcnt(15)
    ds_read_b64_tr_b16 a[188:189], v1 offset:56320
    ds_read_b64_tr_b16 a[190:191], v1 offset:58880
    v_mfma_f32_16x16x32_bf16 v[60:63], a[160:163], a[72:75], v[60:63]
    v_mfma_f32_16x16x32_bf16 v[80:83], a[160:163], a[76:79], v[80:83]
    ds_read_b64_tr_b16 a[160:161], v1 offset:56352
    ds_read_b64_tr_b16 a[162:163], v1 offset:58912
    v_mfma_f32_16x16x32_bf16 v[64:67], a[164:167], a[72:75], v[64:67]
    v_mfma_f32_16x16x32_bf16 v[84:87], a[164:167], a[76:79], v[84:87]
    v_mov_b32 v88, 0
    s_mov_b64 exec, 1
    buffer_load_dword v89, v88, s[20:23], 0 offen sc1
    s_mov_b64 exec, -1
    ds_read_b64_tr_b16 a[164:165], v1 offset:56384
    ds_read_b64_tr_b16 a[166:167], v1 offset:58944
    v_mfma_f32_16x16x32_bf16 v[48:51], a[168:171], a[80:83], v[48:51]
    v_mfma_f32_16x16x32_bf16 v[68:71], a[168:171], a[84:87], v[68:71]
    s_waitcnt lgkmcnt(15)
    ds_read_b64_tr_b16 a[168:169], v1 offset:56416
    ds_read_b64_tr_b16 a[170:171], v1 offset:58976
    v_mfma_f32_16x16x32_bf16 v[52:55], a[172:175], a[80:83], v[52:55]
    v_mfma_f32_16x16x32_bf16 v[72:75], a[172:175], a[84:87], v[72:75]
    s_mul_i32 s7, s28, 50
    v_add_u32 v13, s7, v0
    v_mul_u32_u24 v14, 13108, v13
    v_lshrrev_b32 v14, 16, v14
    v_mul_u32_u24 v15, 3200, v14
    v_lshl_add_u32 v15, v13, 7, v15
    v_cmp_gt_u32 vcc, 50, v0
    v_mov_b32 v14, 0x7ffffff0
    s_nop 0
    v_cndmask_b32 v15, v14, v15, vcc
    s_bfe_u32 s7, s2, 0x40004
    s_mul_i32 s7, s7, 153600
    s_lshr_b32 s6, s30, 2
    s_mul_i32 s6, s6, 640
    s_add_u32 s7, s7, s6
    buffer_load_dword v254, v15, s[24:27], s7 offen
    ds_read_b64_tr_b16 a[172:173], v1 offset:56448
    ds_read_b64_tr_b16 a[174:175], v1 offset:59008
    v_mfma_f32_16x16x32_bf16 v[56:59], a[176:179], a[80:83], v[56:59]
    v_mfma_f32_16x16x32_bf16 v[76:79], a[176:179], a[84:87], v[76:79]
    s_waitcnt vmcnt(15)
    s_barrier
    ds_read_b64_tr_b16 a[176:177], v2 offset:0
    ds_read_b64_tr_b16 a[178:179], v2 offset:2560
    v_mfma_f32_16x16x32_bf16 v[60:63], a[180:183], a[80:83], v[60:63]
    v_mfma_f32_16x16x32_bf16 v[80:83], a[180:183], a[84:87], v[80:83]
    s_waitcnt lgkmcnt(10)
    s_add_u32 m0, s42, 20480
    s_add_u32 s7, s37, 2560
    buffer_load_dwordx4 v4, s[12:15], s7 offen lds
    ds_read_b64_tr_b16 a[180:181], v2 offset:32
    ds_read_b64_tr_b16 a[182:183], v2 offset:2592
    v_mfma_f32_16x16x32_bf16 v[64:67], a[184:187], a[80:83], v[64:67]
    v_mfma_f32_16x16x32_bf16 v[84:87], a[184:187], a[84:87], v[84:87]
    ds_read_b64_tr_b16 a[184:185], v2 offset:64
    ds_read_b64_tr_b16 a[186:187], v2 offset:2624
    v_mfma_f32_16x16x32_bf16 v[48:51], a[188:191], a[88:91], v[48:51]
    v_mfma_f32_16x16x32_bf16 v[68:71], a[188:191], a[92:95], v[68:71]
    s_waitcnt lgkmcnt(10)
    s_add_u32 m0, s42, 21504
    s_add_u32 s7, s37, 2560
    buffer_load_dwordx4 v5, s[12:15], s7 offen lds
    ds_read_b64_tr_b16 a[188:189], v2 offset:96
    ds_read_b64_tr_b16 a[190:191], v2 offset:2656
    v_mfma_f32_16x16x32_bf16 v[52:55], a[160:163], a[88:91], v[52:55]
    v_mfma_f32_16x16x32_bf16 v[72:75], a[160:163], a[92:95], v[72:75]
    ds_read_b64_tr_b16 a[160:161], v2 offset:128
    ds_read_b64_tr_b16 a[162:163], v2 offset:2688
    v_mfma_f32_16x16x32_bf16 v[56:59], a[164:167], a[88:91], v[56:59]
    v_mfma_f32_16x16x32_bf16 v[76:79], a[164:167], a[92:95], v[76:79]
    s_waitcnt lgkmcnt(10)
    s_add_u32 m0, s42, 22528
    s_add_u32 s7, s37, 2560
    buffer_load_dwordx4 v6, s[12:15], s7 offen lds
    ds_read_b64_tr_b16 a[164:165], v2 offset:5120
    ds_read_b64_tr_b16 a[166:167], v2 offset:7680
    v_mfma_f32_16x16x32_bf16 v[60:63], a[168:171], a[88:91], v[60:63]
    v_mfma_f32_16x16x32_bf16 v[80:83], a[168:171], a[92:95], v[80:83]
    ds_read_b64_tr_b16 a[168:169], v2 offset:5152
    ds_read_b64_tr_b16 a[170:171], v2 offset:7712
    v_mfma_f32_16x16x32_bf16 v[64:67], a[172:175], a[88:91], v[64:67]
    v_mfma_f32_16x16x32_bf16 v[84:87], a[172:175], a[92:95], v[84:87]
    s_waitcnt lgkmcnt(10)
    s_add_u32 m0, s42, 23552
    s_add_u32 s7, s37, 2560
    buffer_load_dwordx4 v7, s[12:15], s7 offen lds
    ds_read_b64_tr_b16 a[172:173], v2 offset:5184
    ds_read_b64_tr_b16 a[174:175], v2 offset:7744
    v_mfma_f32_16x16x32_bf16 v[48:51], a[176:179], a[96:99], v[48:51]
    v_mfma_f32_16x16x32_bf16 v[68:71], a[176:179], a[100:103], v[68:71]
    ds_read_b64_tr_b16 a[176:177], v2 offset:5216
    ds_read_b64_tr_b16 a[178:179], v2 offset:7776
    v_mfma_f32_16x16x32_bf16 v[52:55], a[180:183], a[96:99], v[52:55]
    v_mfma_f32_16x16x32_bf16 v[72:75], a[180:183], a[100:103], v[72:75]
    s_waitcnt lgkmcnt(10)
    s_add_u32 m0, s42, 24576
    s_add_u32 s7, s37, 2560
    buffer_load_dwordx4 v8, s[12:15], s7 offen lds
    ds_read_b64_tr_b16 a[180:181], v2 offset:5248
    ds_read_b64_tr_b16 a[182:183], v2 offset:7808
    v_mfma_f32_16x16x32_bf16 v[56:59], a[184:187], a[96:99], v[56:59]
    v_mfma_f32_16x16x32_bf16 v[76:79], a[184:187], a[100:103], v[76:79]
    ds_read_b64_tr_b16 a[184:185], v2 offset:10240
    ds_read_b64_tr_b16 a[186:187], v2 offset:12800
    v_mfma_f32_16x16x32_bf16 v[60:63], a[188:191], a[96:99], v[60:63]
    v_mfma_f32_16x16x32_bf16 v[80:83], a[188:191], a[100:103], v[80:83]
    s_waitcnt lgkmcnt(10)
    ds_read_b64_tr_b16 a[188:189], v2 offset:10272
    ds_read_b64_tr_b16 a[190:191], v2 offset:12832
    v_mfma_f32_16x16x32_bf16 v[64:67], a[160:163], a[96:99], v[64:67]
    v_mfma_f32_16x16x32_bf16 v[84:87], a[160:163], a[100:103], v[84:87]
    ds_read_b64_tr_b16 a[160:161], v2 offset:10304
    ds_read_b64_tr_b16 a[162:163], v2 offset:12864
    v_mfma_f32_16x16x32_bf16 v[48:51], a[164:167], a[104:107], v[48:51]
    v_mfma_f32_16x16x32_bf16 v[68:71], a[164:167], a[108:111], v[68:71]
    s_waitcnt lgkmcnt(10)
    s_waitcnt vmcnt(12)
    ds_read_b128 a[128:131], v11 offset:0
    ds_read_b128 a[132:135], v11 offset:2048
    ds_read_b128 a[136:139], v12 offset:0
    ds_read_b128 a[140:143], v12 offset:2048
    ds_read_b128 a[144:147], v11 offset:4096
    ds_read_b128 a[148:151], v11 offset:6144
    ds_read_b128 a[152:155], v12 offset:4096
    ds_read_b128 a[156:159], v12 offset:6144
    ds_read_b64_tr_b16 a[164:165], v2 offset:10336
    ds_read_b64_tr_b16 a[166:167], v2 offset:12896
    v_mfma_f32_16x16x32_bf16 v[52:55], a[168:171], a[104:107], v[52:55]
    v_mfma_f32_16x16x32_bf16 v[72:75], a[168:171], a[108:111], v[72:75]
    ds_read_b64_tr_b16 a[168:169], v2 offset:10368
    ds_read_b64_tr_b16 a[170:171], v2 offset:12928
    v_mfma_f32_16x16x32_bf16 v[56:59], a[172:175], a[104:107], v[56:59]
    v_mfma_f32_16x16x32_bf16 v[76:79], a[172:175], a[108:111], v[76:79]
    s_waitcnt lgkmcnt(15)
    ds_read_b64_tr_b16 a[172:173], v2 offset:15360
    ds_read_b64_tr_b16 a[174:175], v2 offset:17920
    v_mfma_f32_16x16x32_bf16 v[60:63], a[176:179], a[104:107], v[60:63]
    v_mfma_f32_16x16x32_bf16 v[80:83], a[176:179], a[108:111], v[80:83]
    ds_read_b64_tr_b16 a[176:177], v2 offset:15392
    ds_read_b64_tr_b16 a[178:179], v2 offset:17952
    v_mfma_f32_16x16x32_bf16 v[64:67], a[180:183], a[104:107], v[64:67]
    v_mfma_f32_16x16x32_bf16 v[84:87], a[180:183], a[108:111], v[84:87]
    ds_read_b64_tr_b16 a[180:181], v2 offset:15424
    ds_read_b64_tr_b16 a[182:183], v2 offset:17984
    v_mfma_f32_16x16x32_bf16 v[48:51], a[184:187], a[112:115], v[48:51]
    v_mfma_f32_16x16x32_bf16 v[68:71], a[184:187], a[116:119], v[68:71]
    s_waitcnt lgkmcnt(15)
    ds_read_b64_tr_b16 a[184:185], v2 offset:15456
    ds_read_b64_tr_b16 a[186:187], v2 offset:18016
    v_mfma_f32_16x16x32_bf16 v[52:55], a[188:191], a[112:115], v[52:55]
    v_mfma_f32_16x16x32_bf16 v[72:75], a[188:191], a[116:119], v[72:75]
    s_mul_i32 s7, s28, 50
    v_add_u32 v13, s7, v0
    v_mul_u32_u24 v14, 13108, v13
    v_lshrrev_b32 v14, 16, v14
    v_mul_u32_u24 v15, 640, v14
    v_lshl_add_u32 v15, v13, 7, v15
    v_cmp_gt_u32 vcc, 50, v0
    v_mov_b32 v14, 0x7ffffff0
    s_nop 0
    v_cndmask_b32 v15, v14, v15, vcc
    s_bfe_u32 s7, s2, 0x40004
    s_mul_i32 s7, s7, 51200
    s_lshr_b32 s6, s30, 2
    s_mul_i32 s6, s6, 640
    s_add_u32 s7, s7, s6
    buffer_load_dword v254, v15, s[88:91], s7 offen
    ds_read_b64_tr_b16 a[188:189], v2 offset:15488
    ds_read_b64_tr_b16 a[190:191], v2 offset:18048
    v_mfma_f32_16x16x32_bf16 v[56:59], a[160:163], a[112:115], v[56:59]
    v_mfma_f32_16x16x32_bf16 v[76:79], a[160:163], a[116:119], v[76:79]
    s_waitcnt lgkmcnt(10)
    s_waitcnt vmcnt(8)
    s_barrier
    ds_read_b64_tr_b16 a[160:161], v1 offset:0
    ds_read_b64_tr_b16 a[162:163], v1 offset:2560
    v_mfma_f32_16x16x32_bf16 v[60:63], a[164:167], a[112:115], v[60:63]
    v_mfma_f32_16x16x32_bf16 v[80:83], a[164:167], a[116:119], v[80:83]
    s_add_u32 m0, s42, 40960
    s_add_u32 s7, s38, 2560
    buffer_load_dwordx4 v4, s[12:15], s7 offen lds
    ds_read_b64_tr_b16 a[164:165], v1 offset:32
    ds_read_b64_tr_b16 a[166:167], v1 offset:2592
    v_mfma_f32_16x16x32_bf16 v[64:67], a[168:171], a[112:115], v[64:67]
    v_mfma_f32_16x16x32_bf16 v[84:87], a[168:171], a[116:119], v[84:87]
    s_waitcnt lgkmcnt(10)
    ds_read_b64_tr_b16 a[168:169], v1 offset:64
    ds_read_b64_tr_b16 a[170:171], v1 offset:2624
    v_mfma_f32_16x16x32_bf16 v[48:51], a[172:175], a[120:123], v[48:51]
    v_mfma_f32_16x16x32_bf16 v[68:71], a[172:175], a[124:127], v[68:71]
    s_add_u32 m0, s42, 41984
    s_add_u32 s7, s38, 2560
    buffer_load_dwordx4 v5, s[12:15], s7 offen lds
    ds_read_b64_tr_b16 a[172:173], v1 offset:96
    ds_read_b64_tr_b16 a[174:175], v1 offset:2656
    v_mfma_f32_16x16x32_bf16 v[52:55], a[176:179], a[120:123], v[52:55]
    v_mfma_f32_16x16x32_bf16 v[72:75], a[176:179], a[124:127], v[72:75]
    s_waitcnt lgkmcnt(10)
    ds_read_b64_tr_b16 a[176:177], v1 offset:128
    ds_read_b64_tr_b16 a[178:179], v1 offset:2688
    v_mfma_f32_16x16x32_bf16 v[56:59], a[180:183], a[120:123], v[56:59]
    v_mfma_f32_16x16x32_bf16 v[76:79], a[180:183], a[124:127], v[76:79]
    s_add_u32 m0, s42, 43008
    s_add_u32 s7, s38, 2560
    buffer_load_dwordx4 v6, s[12:15], s7 offen lds
    ds_read_b64_tr_b16 a[180:181], v1 offset:5120
    ds_read_b64_tr_b16 a[182:183], v1 offset:7680
    v_mfma_f32_16x16x32_bf16 v[60:63], a[184:187], a[120:123], v[60:63]
    v_mfma_f32_16x16x32_bf16 v[80:83], a[184:187], a[124:127], v[80:83]
    s_waitcnt lgkmcnt(10)
    ds_read_b64_tr_b16 a[184:185], v1 offset:5152
    ds_read_b64_tr_b16 a[186:187], v1 offset:7712
    v_mfma_f32_16x16x32_bf16 v[64:67], a[188:191], a[120:123], v[64:67]
    v_mfma_f32_16x16x32_bf16 v[84:87], a[188:191], a[124:127], v[84:87]
    s_add_u32 m0, s42, 44032
    s_add_u32 s7, s38, 2560
    buffer_load_dwordx4 v7, s[12:15], s7 offen lds
    ds_read_b64_tr_b16 a[188:189], v1 offset:5184
    ds_read_b64_tr_b16 a[190:191], v1 offset:7744
    v_mfma_f32_16x16x32_bf16 v[48:51], a[160:163], a[128:131], v[48:51]
    v_mfma_f32_16x16x32_bf16 v[68:71], a[160:163], a[132:135], v[68:71]
    s_waitcnt lgkmcnt(10)
    ds_read_b64_tr_b16 a[160:161], v1 offset:5216
    ds_read_b64_tr_b16 a[162:163], v1 offset:7776
    v_mfma_f32_16x16x32_bf16 v[52:55], a[164:167], a[128:131], v[52:55]
    v_mfma_f32_16x16x32_bf16 v[72:75], a[164:167], a[132:135], v[72:75]
    s_add_u32 m0, s42, 45056
    s_add_u32 s7, s38, 2560
    buffer_load_dwordx4 v8, s[12:15], s7 offen lds
    ds_read_b64_tr_b16 a[164:165], v1 offset:5248
    ds_read_b64_tr_b16 a[166:167], v1 offset:7808
    v_mfma_f32_16x16x32_bf16 v[56:59], a[168:171], a[128:131], v[56:59]
    v_mfma_f32_16x16x32_bf16 v[76:79], a[168:171], a[132:135], v[76:79]
    s_waitcnt lgkmcnt(10)
    ds_read_b64_tr_b16 a[168:169], v1 offset:10240
    ds_read_b64_tr_b16 a[170:171], v1 offset:12800
    v_mfma_f32_16x16x32_bf16 v[60:63], a[172:175], a[128:131], v[60:63]
    v_mfma_f32_16x16x32_bf16 v[80:83], a[172:175], a[132:135], v[80:83]
    s_add_u32 m0, s42, 81920
    s_add_u32 s7, s39, 2560
    buffer_load_dwordx4 v4, s[12:15], s7 offen lds
    ds_read_b64_tr_b16 a[172:173], v1 offset:10272
    ds_read_b64_tr_b16 a[174:175], v1 offset:12832
    v_mfma_f32_16x16x32_bf16 v[64:67], a[176:179], a[128:131], v[64:67]
    v_mfma_f32_16x16x32_bf16 v[84:87], a[176:179], a[132:135], v[84:87]
    s_waitcnt lgkmcnt(10)
    ds_read_b64_tr_b16 a[176:177], v1 offset:10304
    ds_read_b64_tr_b16 a[178:179], v1 offset:12864
    v_mfma_f32_16x16x32_bf16 v[48:51], a[180:183], a[136:139], v[48:51]
    v_mfma_f32_16x16x32_bf16 v[68:71], a[180:183], a[140:143], v[68:71]
    s_add_u32 m0, s42, 82944
    s_add_u32 s7, s39, 2560
    buffer_load_dwordx4 v5, s[12:15], s7 offen lds
    ds_read_b64_tr_b16 a[180:181], v1 offset:10336
    ds_read_b64_tr_b16 a[182:183], v1 offset:12896
    v_mfma_f32_16x16x32_bf16 v[52:55], a[184:187], a[136:139], v[52:55]
    v_mfma_f32_16x16x32_bf16 v[72:75], a[184:187], a[140:143], v[72:75]
    s_waitcnt lgkmcnt(10)
    ds_read_b64_tr_b16 a[184:185], v1 offset:10368
    ds_read_b64_tr_b16 a[186:187], v1 offset:12928
    v_mfma_f32_16x16x32_bf16 v[56:59], a[188:191], a[136:139], v[56:59]
    v_mfma_f32_16x16x32_bf16 v[76:79], a[188:191], a[140:143], v[76:79]
    s_add_u32 m0, s42, 83968
    s_add_u32 s7, s39, 2560
    buffer_load_dwordx4 v6, s[12:15], s7 offen lds
    ds_read_b64_tr_b16 a[188:189], v1 offset:15360
    ds_read_b64_tr_b16 a[190:191], v1 offset:17920
    v_mfma_f32_16x16x32_bf16 v[60:63], a[160:163], a[136:139], v[60:63]
    v_mfma_f32_16x16x32_bf16 v[80:83], a[160:163], a[140:143], v[80:83]
    s_waitcnt lgkmcnt(10)
    ds_read_b64_tr_b16 a[160:161], v1 offset:15392
    ds_read_b64_tr_b16 a[162:163], v1 offset:17952
    v_mfma_f32_16x16x32_bf16 v[64:67], a[164:167], a[136:139], v[64:67]
    v_mfma_f32_16x16x32_bf16 v[84:87], a[164:167], a[140:143], v[84:87]
    s_add_u32 m0, s42, 84992
    s_add_u32 s7, s39, 2560
    buffer_load_dwordx4 v7, s[12:15], s7 offen lds
    ds_read_b64_tr_b16 a[164:165], v1 offset:15424
    ds_read_b64_tr_b16 a[166:167], v1 offset:17984
    v_mfma_f32_16x16x32_bf16 v[48:51], a[168:171], a[144:147], v[48:51]
    v_mfma_f32_16x16x32_bf16 v[68:71], a[168:171], a[148:151], v[68:71]
    s_waitcnt lgkmcnt(10)
    ds_read_b64_tr_b16 a[168:169], v1 offset:15456
    ds_read_b64_tr_b16 a[170:171], v1 offset:18016
    v_mfma_f32_16x16x32_bf16 v[52:55], a[172:175], a[144:147], v[52:55]
    v_mfma_f32_16x16x32_bf16 v[72:75], a[172:175], a[148:151], v[72:75]
    s_add_u32 m0, s42, 86016
    s_add_u32 s7, s39, 2560
    buffer_load_dwordx4 v8, s[12:15], s7 offen lds
    s_waitcnt vmcnt(17)
    s_mov_b32 s66, 0
Lng_19:
    v_readfirstlane_b32 s43, v89
    s_cmp_lg_u32 s43, 0
    s_cbranch_scc1 Lngd_20
    s_mov_b64 exec, 1
    buffer_load_dword v89, v88, s[20:23], 0 offen sc1
    s_mov_b64 exec, -1
    s_waitcnt vmcnt(0)
    s_add_u32 s66, s66, 1
    s_cmp_lt_u32 s66, 0x40000
    s_cbranch_scc1 Lng_19
Lngd_20:
    ds_read_b64_tr_b16 a[172:173], v1 offset:15488
    ds_read_b64_tr_b16 a[174:175], v1 offset:18048
    v_mfma_f32_16x16x32_bf16 v[56:59], a[176:179], a[144:147], v[56:59]
    v_mfma_f32_16x16x32_bf16 v[76:79], a[176:179], a[148:151], v[76:79]
    s_waitcnt lgkmcnt(10)
    s_waitcnt vmcnt(11)
    s_barrier
    ds_read_b64_tr_b16 a[176:177], v1 offset:20480
    ds_read_b64_tr_b16 a[178:179], v1 offset:23040
    v_mfma_f32_16x16x32_bf16 v[60:63], a[180:183], a[144:147], v[60:63]
    v_mfma_f32_16x16x32_bf16 v[80:83], a[180:183], a[148:151], v[80:83]
    ds_read_b64_tr_b16 a[180:181], v1 offset:20512
    ds_read_b64_tr_b16 a[182:183], v1 offset:23072
    v_mfma_f32_16x16x32_bf16 v[64:67], a[184:187], a[144:147], v[64:67]
    v_mfma_f32_16x16x32_bf16 v[84:87], a[184:187], a[148:151], v[84:87]
    s_waitcnt lgkmcnt(10)
    ds_read_b64_tr_b16 a[184:185], v1 offset:20544
    ds_read_b64_tr_b16 a[186:187], v1 offset:23104
    v_mfma_f32_16x16x32_bf16 v[48:51], a[188:191], a[152:155], v[48:51]
    v_mfma_f32_16x16x32_bf16 v[68:71], a[188:191], a[156:159], v[68:71]
    ds_read_b64_tr_b16 a[188:189], v1 offset:20576
    ds_read_b64_tr_b16 a[190:191], v1 offset:23136
    v_mfma_f32_16x16x32_bf16 v[52:55], a[160:163], a[152:155], v[52:55]
    v_mfma_f32_16x16x32_bf16 v[72:75], a[160:163], a[156:159], v[72:75]
    s_waitcnt lgkmcnt(10)
    ds_read_b64_tr_b16 a[160:161], v1 offset:20608
    ds_read_b64_tr_b16 a[162:163], v1 offset:23168
    v_mfma_f32_16x16x32_bf16 v[56:59], a[164:167], a[152:155], v[56:59]
    v_mfma_f32_16x16x32_bf16 v[76:79], a[164:167], a[156:159], v[76:79]
    ds_read_b64_tr_b16 a[164:165], v1 offset:25600
    ds_read_b64_tr_b16 a[166:167], v1 offset:28160
    v_mfma_f32_16x16x32_bf16 v[60:63], a[168:171], a[152:155], v[60:63]
    v_mfma_f32_16x16x32_bf16 v[80:83], a[168:171], a[156:159], v[80:83]
    s_waitcnt lgkmcnt(10)
    ds_read_b64_tr_b16 a[168:169], v1 offset:25632
    ds_read_b64_tr_b16 a[170:171], v1 offset:28192
    v_mfma_f32_16x16x32_bf16 v[64:67], a[172:175], a[152:155], v[64:67]
    v_mfma_f32_16x16x32_bf16 v[84:87], a[172:175], a[156:159], v[84:87]
    v_cvt_pk_bf16_f32 v88, v48, v49
    v_cvt_pk_bf16_f32 v100, v68, v69
    v_cvt_pk_bf16_f32 v89, v50, v51
    v_cvt_pk_bf16_f32 v101, v70, v71
    v_cvt_pk_bf16_f32 v90, v52, v53
    v_cvt_pk_bf16_f32 v102, v72, v73
    v_cvt_pk_bf16_f32 v91, v54, v55
    v_cvt_pk_bf16_f32 v103, v74, v75
    v_cvt_pk_bf16_f32 v92, v56, v57
    v_cvt_pk_bf16_f32 v104, v76, v77
    v_cvt_pk_bf16_f32 v93, v58, v59
    v_cvt_pk_bf16_f32 v105, v78, v79
    v_cvt_pk_bf16_f32 v94, v60, v61
    v_cvt_pk_bf16_f32 v106, v80, v81
    v_cvt_pk_bf16_f32 v95, v62, v63
    v_cvt_pk_bf16_f32 v107, v82, v83
    v_cvt_pk_bf16_f32 v96, v64, v65
    v_cvt_pk_bf16_f32 v108, v84, v85
    v_cvt_pk_bf16_f32 v97, v66, v67
    v_cvt_pk_bf16_f32 v109, v86, v87
    ds_write_b64 v220, v[100:101] offset:0
    ds_write_b64 v220, v[102:103] offset:512
    ds_write_b64 v220, v[104:105] offset:1024
    ds_write_b64 v220, v[106:107] offset:1536
    ds_write_b64 v220, v[108:109] offset:2048
    ds_read_b64_tr_b16 a[172:173], v1 offset:25664
    ds_read_b64_tr_b16 a[174:175], v1 offset:28224
    v_mfma_f32_16x16x32_bf16 v[48:51], a[176:179], a[0:3], 0
    v_mfma_f32_16x16x32_bf16 v[68:71], a[176:179], a[4:7], 0
    s_waitcnt lgkmcnt(15)
    s_add_u32 m0, s42, 102400
    s_add_u32 s7, s40, 2560
    buffer_load_dwordx4 v4, s[12:15], s7 offen lds
    ds_read_b64_tr_b16 a[176:177], v1 offset:25696
    ds_read_b64_tr_b16 a[178:179], v1 offset:28256
    v_mfma_f32_16x16x32_bf16 v[52:55], a[180:183], a[0:3], 0
    v_mfma_f32_16x16x32_bf16 v[72:75], a[180:183], a[4:7], 0
    ds_read_b64_tr_b16 a[180:181], v1 offset:25728
    ds_read_b64_tr_b16 a[182:183], v1 offset:28288
    v_mfma_f32_16x16x32_bf16 v[56:59], a[184:187], a[0:3], 0
    v_mfma_f32_16x16x32_bf16 v[76:79], a[184:187], a[4:7], 0
    s_waitcnt lgkmcnt(15)
    s_add_u32 m0, s42, 103424
    s_add_u32 s7, s40, 2560
    buffer_load_dwordx4 v5, s[12:15], s7 offen lds
    ds_read_b64_tr_b16 a[184:185], v1 offset:30720
    ds_read_b64_tr_b16 a[186:187], v1 offset:33280
    v_mfma_f32_16x16x32_bf16 v[60:63], a[188:191], a[0:3], 0
    v_mfma_f32_16x16x32_bf16 v[80:83], a[188:191], a[4:7], 0
    ds_read_b64_tr_b16 a[188:189], v1 offset:30752
    ds_read_b64_tr_b16 a[190:191], v1 offset:33312
    v_mfma_f32_16x16x32_bf16 v[64:67], a[160:163], a[0:3], 0
    v_mfma_f32_16x16x32_bf16 v[84:87], a[160:163], a[4:7], 0
    s_waitcnt lgkmcnt(15)
    ds_read_b64_tr_b16 a[160:161], v1 offset:30784
    ds_read_b64_tr_b16 a[162:163], v1 offset:33344
    v_mfma_f32_16x16x32_bf16 v[48:51], a[164:167], a[8:11], v[48:51]
    v_mfma_f32_16x16x32_bf16 v[68:71], a[164:167], a[12:15], v[68:71]
    s_add_u32 m0, s42, 104448
    s_add_u32 s7, s40, 2560
    buffer_load_dwordx4 v6, s[12:15], s7 offen lds
    ds_read_b64_tr_b16 a[164:165], v1 offset:30816
    ds_read_b64_tr_b16 a[166:167], v1 offset:33376
    v_mfma_f32_16x16x32_bf16 v[52:55], a[168:171], a[8:11], v[52:55]
    v_mfma_f32_16x16x32_bf16 v[72:75], a[168:171], a[12:15], v[72:75]
    s_waitcnt lgkmcnt(10)
    ds_read_b64_tr_b16 a[168:169], v1 offset:30848
    ds_read_b64_tr_b16 a[170:171], v1 offset:33408
    v_mfma_f32_16x16x32_bf16 v[56:59], a[172:175], a[8:11], v[56:59]
    v_mfma_f32_16x16x32_bf16 v[76:79], a[172:175], a[12:15], v[76:79]
    s_add_u32 m0, s42, 105472
    s_add_u32 s7, s40, 2560
    buffer_load_dwordx4 v7, s[12:15], s7 offen lds
    ds_read_b64_tr_b16 a[172:173], v1 offset:35840
    ds_read_b64_tr_b16 a[174:175], v1 offset:38400
    v_mfma_f32_16x16x32_bf16 v[60:63], a[176:179], a[8:11], v[60:63]
    v_mfma_f32_16x16x32_bf16 v[80:83], a[176:179], a[12:15], v[80:83]
    s_waitcnt lgkmcnt(10)
    ds_read_b64_tr_b16 a[176:177], v1 offset:35872
    ds_read_b64_tr_b16 a[178:179], v1 offset:38432
    v_mfma_f32_16x16x32_bf16 v[64:67], a[180:183], a[8:11], v[64:67]
    v_mfma_f32_16x16x32_bf16 v[84:87], a[180:183], a[12:15], v[84:87]
    ds_read_b64_tr_b16 a[180:181], v1 offset:35904
    ds_read_b64_tr_b16 a[182:183], v1 offset:38464
    v_mfma_f32_16x16x32_bf16 v[48:51], a[184:187], a[16:19], v[48:51]
    v_mfma_f32_16x16x32_bf16 v[68:71], a[184:187], a[20:23], v[68:71]
    s_waitcnt lgkmcnt(10)
    s_add_u32 m0, s42, 106496
    s_add_u32 s7, s40, 2560
    buffer_load_dwordx4 v8, s[12:15], s7 offen lds
    ds_read_b64_tr_b16 a[184:185], v1 offset:35936
    ds_read_b64_tr_b16 a[186:187], v1 offset:38496
    v_mfma_f32_16x16x32_bf16 v[52:55], a[188:191], a[16:19], v[52:55]
    v_mfma_f32_16x16x32_bf16 v[72:75], a[188:191], a[20:23], v[72:75]
    ds_read_b64_tr_b16 a[188:189], v1 offset:35968
    ds_read_b64_tr_b16 a[190:191], v1 offset:38528
    v_mfma_f32_16x16x32_bf16 v[56:59], a[160:163], a[16:19], v[56:59]
    v_mfma_f32_16x16x32_bf16 v[76:79], a[160:163], a[20:23], v[76:79]
    s_waitcnt lgkmcnt(10)
    s_waitcnt vmcnt(10)
    s_barrier
    ds_read_b64_tr_b16 a[160:161], v1 offset:40960
    ds_read_b64_tr_b16 a[162:163], v1 offset:43520
    v_mfma_f32_16x16x32_bf16 v[60:63], a[164:167], a[16:19], v[60:63]
    v_mfma_f32_16x16x32_bf16 v[80:83], a[164:167], a[20:23], v[80:83]
    ds_read_b64_tr_b16 a[164:165], v1 offset:40992
    ds_read_b64_tr_b16 a[166:167], v1 offset:43552
    v_mfma_f32_16x16x32_bf16 v[64:67], a[168:171], a[16:19], v[64:67]
    v_mfma_f32_16x16x32_bf16 v[84:87], a[168:171], a[20:23], v[84:87]
    s_waitcnt lgkmcnt(10)
    s_add_u32 m0, s42, 122880
    s_add_u32 s7, s41, 2560
    buffer_load_dwordx4 v4, s[12:15], s7 offen lds
    ds_read_b64_tr_b16 a[168:169], v1 offset:41024
    ds_read_b64_tr_b16 a[170:171], v1 offset:43584
    v_mfma_f32_16x16x32_bf16 v[48:51], a[172:175], a[24:27], v[48:51]
    v_mfma_f32_16x16x32_bf16 v[68:71], a[172:175], a[28:31], v[68:71]
    ds_read_b64_tr_b16 a[172:173], v1 offset:41056
    ds_read_b64_tr_b16 a[174:175], v1 offset:43616
    v_mfma_f32_16x16x32_bf16 v[52:55], a[176:179], a[24:27], v[52:55]
    v_mfma_f32_16x16x32_bf16 v[72:75], a[176:179], a[28:31], v[72:75]
    s_waitcnt lgkmcnt(10)
    ds_read_b64_tr_b16 a[176:177], v1 offset:41088
    ds_read_b64_tr_b16 a[178:179], v1 offset:43648
    v_mfma_f32_16x16x32_bf16 v[56:59], a[180:183], a[24:27], v[56:59]
    v_mfma_f32_16x16x32_bf16 v[76:79], a[180:183], a[28:31], v[76:79]
    s_add_u32 m0, s42, 123904
    s_add_u32 s7, s41, 2560
    buffer_load_dwordx4 v5, s[12:15], s7 offen lds
    ds_read_b64_tr_b16 a[180:181], v1 offset:46080
    ds_read_b64_tr_b16 a[182:183], v1 offset:48640
    v_mfma_f32_16x16x32_bf16 v[60:63], a[184:187], a[24:27], v[60:63]
    v_mfma_f32_16x16x32_bf16 v[80:83], a[184:187], a[28:31], v[80:83]
    s_waitcnt lgkmcnt(10)
    ds_read_b64_tr_b16 a[184:185], v1 offset:46112
    ds_read_b64_tr_b16 a[186:187], v1 offset:48672
    v_mfma_f32_16x16x32_bf16 v[64:67], a[188:191], a[24:27], v[64:67]
    v_mfma_f32_16x16x32_bf16 v[84:87], a[188:191], a[28:31], v[84:87]
    ds_read_b64_tr_b16 a[188:189], v1 offset:46144
    ds_read_b64_tr_b16 a[190:191], v1 offset:48704
    v_mfma_f32_16x16x32_bf16 v[48:51], a[160:163], a[32:35], v[48:51]
    v_mfma_f32_16x16x32_bf16 v[68:71], a[160:163], a[36:39], v[68:71]
    s_waitcnt lgkmcnt(10)
    ds_read_b64_tr_b16 a[160:161], v1 offset:46176
    ds_read_b64_tr_b16 a[162:163], v1 offset:48736
    v_mfma_f32_16x16x32_bf16 v[52:55], a[164:167], a[32:35], v[52:55]
    v_mfma_f32_16x16x32_bf16 v[72:75], a[164:167], a[36:39], v[72:75]
    s_add_u32 m0, s42, 124928
    s_add_u32 s7, s41, 2560
    buffer_load_dwordx4 v6, s[12:15], s7 offen lds
    ds_read_b64_tr_b16 a[164:165], v1 offset:46208
    ds_read_b64_tr_b16 a[166:167], v1 offset:48768
    v_mfma_f32_16x16x32_bf16 v[56:59], a[168:171], a[32:35], v[56:59]
    v_mfma_f32_16x16x32_bf16 v[76:79], a[168:171], a[36:39], v[76:79]
    s_waitcnt lgkmcnt(10)
    ds_read_b64_tr_b16 a[168:169], v1 offset:51200
    ds_read_b64_tr_b16 a[170:171], v1 offset:53760
    v_mfma_f32_16x16x32_bf16 v[60:63], a[172:175], a[32:35], v[60:63]
    v_mfma_f32_16x16x32_bf16 v[80:83], a[172:175], a[36:39], v[80:83]
    ds_read_b64_tr_b16 a[172:173], v1 offset:51232
    ds_read_b64_tr_b16 a[174:175], v1 offset:53792
    v_mfma_f32_16x16x32_bf16 v[64:67], a[176:179], a[32:35], v[64:67]
    v_mfma_f32_16x16x32_bf16 v[84:87], a[176:179], a[36:39], v[84:87]
    s_waitcnt lgkmcnt(10)
    s_add_u32 m0, s42, 125952
    s_add_u32 s7, s41, 2560
    buffer_load_dwordx4 v7, s[12:15], s7 offen lds
    ds_read_b64_tr_b16 a[176:177], v1 offset:51264
    ds_read_b64_tr_b16 a[178:179], v1 offset:53824
    v_mfma_f32_16x16x32_bf16 v[48:51], a[180:183], a[40:43], v[48:51]
    v_mfma_f32_16x16x32_bf16 v[68:71], a[180:183], a[44:47], v[68:71]
    ds_read_b64_tr_b16 a[180:181], v1 offset:51296
    ds_read_b64_tr_b16 a[182:183], v1 offset:53856
    v_mfma_f32_16x16x32_bf16 v[52:55], a[184:187], a[40:43], v[52:55]
    v_mfma_f32_16x16x32_bf16 v[72:75], a[184:187], a[44:47], v[72:75]
    s_waitcnt lgkmcnt(10)
    ds_read_b64_tr_b16 a[184:185], v1 offset:51328
    ds_read_b64_tr_b16 a[186:187], v1 offset:53888
    v_mfma_f32_16x16x32_bf16 v[56:59], a[188:191], a[40:43], v[56:59]
    v_mfma_f32_16x16x32_bf16 v[76:79], a[188:191], a[44:47], v[76:79]
    ds_read_b64_tr_b16 a[188:189], v1 offset:56320
    ds_read_b64_tr_b16 a[190:191], v1 offset:58880
    v_mfma_f32_16x16x32_bf16 v[60:63], a[160:163], a[40:43], v[60:63]
    v_mfma_f32_16x16x32_bf16 v[80:83], a[160:163], a[44:47], v[80:83]
    s_waitcnt lgkmcnt(10)
    s_add_u32 m0, s42, 126976
    s_add_u32 s7, s41, 2560
    buffer_load_dwordx4 v8, s[12:15], s7 offen lds
    ds_read_b64_tr_b16 a[160:161], v1 offset:56352
    ds_read_b64_tr_b16 a[162:163], v1 offset:58912
    v_mfma_f32_16x16x32_bf16 v[64:67], a[164:167], a[40:43], v[64:67]
    v_mfma_f32_16x16x32_bf16 v[84:87], a[164:167], a[44:47], v[84:87]
    ds_read_b64_tr_b16 a[164:165], v1 offset:56384
    ds_read_b64_tr_b16 a[166:167], v1 offset:58944
    v_mfma_f32_16x16x32_bf16 v[48:51], a[168:171], a[48:51], v[48:51]
    v_mfma_f32_16x16x32_bf16 v[68:71], a[168:171], a[52:55], v[68:71]
    s_waitcnt lgkmcnt(10)
    ds_read_b64_tr_b16 a[168:169], v1 offset:56416
    ds_read_b64_tr_b16 a[170:171], v1 offset:58976
    v_mfma_f32_16x16x32_bf16 v[52:55], a[172:175], a[48:51], v[52:55]
    v_mfma_f32_16x16x32_bf16 v[72:75], a[172:175], a[52:55], v[72:75]
    ds_read_b64_tr_b16 a[172:173], v1 offset:56448
    ds_read_b64_tr_b16 a[174:175], v1 offset:59008
    v_mfma_f32_16x16x32_bf16 v[56:59], a[176:179], a[48:51], v[56:59]
    v_mfma_f32_16x16x32_bf16 v[76:79], a[176:179], a[52:55], v[76:79]
    s_waitcnt lgkmcnt(10)
    s_waitcnt vmcnt(10)
    s_barrier
    ds_read_b64_tr_b16 a[176:177], v2 offset:20480
    ds_read_b64_tr_b16 a[178:179], v2 offset:23040
    v_mfma_f32_16x16x32_bf16 v[60:63], a[180:183], a[48:51], v[60:63]
    v_mfma_f32_16x16x32_bf16 v[80:83], a[180:183], a[52:55], v[80:83]
    ds_read_b64_tr_b16 a[180:181], v2 offset:20512
    ds_read_b64_tr_b16 a[182:183], v2 offset:23072
    v_mfma_f32_16x16x32_bf16 v[64:67], a[184:187], a[48:51], v[64:67]
    v_mfma_f32_16x16x32_bf16 v[84:87], a[184:187], a[52:55], v[84:87]
    s_waitcnt lgkmcnt(10)
    s_add_u32 m0, s42, 61440
    s_nop 0
    buffer_load_dwordx4 v4, s[12:15], s37 offen lds
    ds_read_b64_tr_b16 a[184:185], v2 offset:20544
    ds_read_b64_tr_b16 a[186:187], v2 offset:23104
    v_mfma_f32_16x16x32_bf16 v[48:51], a[188:191], a[56:59], v[48:51]
    v_mfma_f32_16x16x32_bf16 v[68:71], a[188:191], a[60:63], v[68:71]
    ds_read_b64_tr_b16 a[188:189], v2 offset:20576
    ds_read_b64_tr_b16 a[190:191], v2 offset:23136
    v_mfma_f32_16x16x32_bf16 v[52:55], a[160:163], a[56:59], v[52:55]
    v_mfma_f32_16x16x32_bf16 v[72:75], a[160:163], a[60:63], v[72:75]
    s_waitcnt lgkmcnt(10)
    ds_read_b64_tr_b16 a[160:161], v2 offset:20608
    ds_read_b64_tr_b16 a[162:163], v2 offset:23168
    v_mfma_f32_16x16x32_bf16 v[56:59], a[164:167], a[56:59], v[56:59]
    v_mfma_f32_16x16x32_bf16 v[76:79], a[164:167], a[60:63], v[76:79]
    s_add_u32 m0, s42, 62464
    s_nop 0
    buffer_load_dwordx4 v5, s[12:15], s37 offen lds
    ds_read_b64_tr_b16 a[164:165], v2 offset:25600
    ds_read_b64_tr_b16 a[166:167], v2 offset:28160
    v_mfma_f32_16x16x32_bf16 v[60:63], a[168:171], a[56:59], v[60:63]
    v_mfma_f32_16x16x32_bf16 v[80:83], a[168:171], a[60:63], v[80:83]
    s_waitcnt lgkmcnt(10)
    ds_read_b64_tr_b16 a[168:169], v2 offset:25632
    ds_read_b64_tr_b16 a[170:171], v2 offset:28192
    v_mfma_f32_16x16x32_bf16 v[64:67], a[172:175], a[56:59], v[64:67]
    v_mfma_f32_16x16x32_bf16 v[84:87], a[172:175], a[60:63], v[84:87]
    ds_read_b64_tr_b16 a[172:173], v2 offset:25664
    ds_read_b64_tr_b16 a[174:175], v2 offset:28224
    v_mfma_f32_16x16x32_bf16 v[48:51], a[176:179], a[64:67], v[48:51]
    v_mfma_f32_16x16x32_bf16 v[68:71], a[176:179], a[68:71], v[68:71]
    s_waitcnt lgkmcnt(10)
    ds_read_b64_tr_b16 a[176:177], v2 offset:25696
    ds_read_b64_tr_b16 a[178:179], v2 offset:28256
    v_mfma_f32_16x16x32_bf16 v[52:55], a[180:183], a[64:67], v[52:55]
    v_mfma_f32_16x16x32_bf16 v[72:75], a[180:183], a[68:71], v[72:75]
    s_add_u32 m0, s42, 63488
    s_nop 0
    buffer_load_dwordx4 v6, s[12:15], s37 offen lds
    ds_read_b64_tr_b16 a[180:181], v2 offset:25728
    ds_read_b64_tr_b16 a[182:183], v2 offset:28288
    v_mfma_f32_16x16x32_bf16 v[56:59], a[184:187], a[64:67], v[56:59]
    v_mfma_f32_16x16x32_bf16 v[76:79], a[184:187], a[68:71], v[76:79]
    s_waitcnt lgkmcnt(10)
    ds_read_b64_tr_b16 a[184:185], v2 offset:30720
    ds_read_b64_tr_b16 a[186:187], v2 offset:33280
    v_mfma_f32_16x16x32_bf16 v[60:63], a[188:191], a[64:67], v[60:63]
    v_mfma_f32_16x16x32_bf16 v[80:83], a[188:191], a[68:71], v[80:83]
    ds_read_b64_tr_b16 a[188:189], v2 offset:30752
    ds_read_b64_tr_b16 a[190:191], v2 offset:33312
    v_mfma_f32_16x16x32_bf16 v[64:67], a[160:163], a[64:67], v[64:67]
    v_mfma_f32_16x16x32_bf16 v[84:87], a[160:163], a[68:71], v[84:87]
    s_waitcnt lgkmcnt(10)
    s_add_u32 m0, s42, 64512
    s_nop 0
    buffer_load_dwordx4 v7, s[12:15], s37 offen lds
    ds_read_b64_tr_b16 a[160:161], v2 offset:30784
    ds_read_b64_tr_b16 a[162:163], v2 offset:33344
    v_mfma_f32_16x16x32_bf16 v[48:51], a[164:167], a[72:75], v[48:51]
    v_mfma_f32_16x16x32_bf16 v[68:71], a[164:167], a[76:79], v[68:71]
    ds_read_b64_tr_b16 a[164:165], v2 offset:30816
    ds_read_b64_tr_b16 a[166:167], v2 offset:33376
    v_mfma_f32_16x16x32_bf16 v[52:55], a[168:171], a[72:75], v[52:55]
    v_mfma_f32_16x16x32_bf16 v[72:75], a[168:171], a[76:79], v[72:75]
    s_waitcnt lgkmcnt(10)
    ds_read_b64_tr_b16 a[168:169], v2 offset:30848
    ds_read_b64_tr_b16 a[170:171], v2 offset:33408
    v_mfma_f32_16x16x32_bf16 v[56:59], a[172:175], a[72:75], v[56:59]
    v_mfma_f32_16x16x32_bf16 v[76:79], a[172:175], a[76:79], v[76:79]
    ds_read_b64_tr_b16 a[172:173], v2 offset:35840
    ds_read_b64_tr_b16 a[174:175], v2 offset:38400
    v_mfma_f32_16x16x32_bf16 v[60:63], a[176:179], a[72:75], v[60:63]
    v_mfma_f32_16x16x32_bf16 v[80:83], a[176:179], a[76:79], v[80:83]
    s_waitcnt lgkmcnt(10)
    s_add_u32 m0, s42, 65536
    s_nop 0
    buffer_load_dwordx4 v8, s[12:15], s37 offen lds
    ds_read_b64_tr_b16 a[176:177], v2 offset:35872
    ds_read_b64_tr_b16 a[178:179], v2 offset:38432
    v_mfma_f32_16x16x32_bf16 v[64:67], a[180:183], a[72:75], v[64:67]
    v_mfma_f32_16x16x32_bf16 v[84:87], a[180:183], a[76:79], v[84:87]
    ds_read_b64_tr_b16 a[180:181], v2 offset:35904
    ds_read_b64_tr_b16 a[182:183], v2 offset:38464
    v_mfma_f32_16x16x32_bf16 v[48:51], a[184:187], a[80:83], v[48:51]
    v_mfma_f32_16x16x32_bf16 v[68:71], a[184:187], a[84:87], v[68:71]
    s_waitcnt lgkmcnt(10)
    ds_read_b64_tr_b16 a[184:185], v2 offset:35936
    ds_read_b64_tr_b16 a[186:187], v2 offset:38496
    v_mfma_f32_16x16x32_bf16 v[52:55], a[188:191], a[80:83], v[52:55]
    v_mfma_f32_16x16x32_bf16 v[72:75], a[188:191], a[84:87], v[72:75]
    ds_read_b64_tr_b16 a[188:189], v2 offset:35968
    ds_read_b64_tr_b16 a[190:191], v2 offset:38528
    v_mfma_f32_16x16x32_bf16 v[56:59], a[160:163], a[80:83], v[56:59]
    v_mfma_f32_16x16x32_bf16 v[76:79], a[160:163], a[84:87], v[76:79]
    s_waitcnt lgkmcnt(10)
    s_mul_i32 s7, s28, 50
    v_add_u32 v13, s7, v0
    v_mul_u32_u24 v14, 13108, v13
    v_lshrrev_b32 v14, 16, v14
    v_mul_u32_u24 v15, 640, v14
    v_lshl_add_u32 v15, v13, 7, v15
    v_cmp_gt_u32 vcc, 50, v0
    v_mov_b32 v14, 0x7ffffff0
    s_nop 0
    v_cndmask_b32 v15, v14, v15, vcc
    s_bfe_u32 s7, s2, 0x40004
    s_mul_i32 s7, s7, 51200
    s_lshr_b32 s6, s30, 2
    s_mul_i32 s6, s6, 640
    s_add_u32 s7, s7, s6
    buffer_load_dword v254, v15, s[44:47], s7 offen
    s_waitcnt vmcnt(11)
    s_barrier
    ds_read_b64_tr_b16 a[160:161], v2 offset:40960
    ds_read_b64_tr_b16 a[162:163], v2 offset:43520
    v_mfma_f32_16x16x32_bf16 v[60:63], a[164:167], a[80:83], v[60:63]
    v_mfma_f32_16x16x32_bf16 v[80:83], a[164:167], a[84:87], v[80:83]
    ds_read_b64_tr_b16 a[164:165], v2 offset:40992
    ds_read_b64_tr_b16 a[166:167], v2 offset:43552
    v_mfma_f32_16x16x32_bf16 v[64:67], a[168:171], a[80:83], v[64:67]
    v_mfma_f32_16x16x32_bf16 v[84:87], a[168:171], a[84:87], v[84:87]
    s_waitcnt lgkmcnt(10)
    s_add_u32 m0, s42, 0
    s_nop 0
    buffer_load_dwordx4 v4, s[12:15], s38 offen lds
    ds_read_b64_tr_b16 a[168:169], v2 offset:41024
    ds_read_b64_tr_b16 a[170:171], v2 offset:43584
    v_mfma_f32_16x16x32_bf16 v[48:51], a[172:175], a[88:91], v[48:51]
    v_mfma_f32_16x16x32_bf16 v[68:71], a[172:175], a[92:95], v[68:71]
    ds_read_b64_tr_b16 a[172:173], v2 offset:41056
    ds_read_b64_tr_b16 a[174:175], v2 offset:43616
    v_mfma_f32_16x16x32_bf16 v[52:55], a[176:179], a[88:91], v[52:55]
    v_mfma_f32_16x16x32_bf16 v[72:75], a[176:179], a[92:95], v[72:75]
    s_waitcnt lgkmcnt(10)
    ds_read_b64_tr_b16 a[176:177], v2 offset:41088
    ds_read_b64_tr_b16 a[178:179], v2 offset:43648
    v_mfma_f32_16x16x32_bf16 v[56:59], a[180:183], a[88:91], v[56:59]
    v_mfma_f32_16x16x32_bf16 v[76:79], a[180:183], a[92:95], v[76:79]
    s_add_u32 m0, s42, 1024
    s_nop 0
    buffer_load_dwordx4 v5, s[12:15], s38 offen lds
    ds_read_b64_tr_b16 a[180:181], v2 offset:46080
    ds_read_b64_tr_b16 a[182:183], v2 offset:48640
    v_mfma_f32_16x16x32_bf16 v[60:63], a[184:187], a[88:91], v[60:63]
    v_mfma_f32_16x16x32_bf16 v[80:83], a[184:187], a[92:95], v[80:83]
    s_waitcnt lgkmcnt(10)
    ds_read_b64_tr_b16 a[184:185], v2 offset:46112
    ds_read_b64_tr_b16 a[186:187], v2 offset:48672
    v_mfma_f32_16x16x32_bf16 v[64:67], a[188:191], a[88:91], v[64:67]
    v_mfma_f32_16x16x32_bf16 v[84:87], a[188:191], a[92:95], v[84:87]
    ds_read_b64_tr_b16 a[188:189], v2 offset:46144
    ds_read_b64_tr_b16 a[190:191], v2 offset:48704
    v_mfma_f32_16x16x32_bf16 v[48:51], a[160:163], a[96:99], v[48:51]
    v_mfma_f32_16x16x32_bf16 v[68:71], a[160:163], a[100:103], v[68:71]
    s_waitcnt lgkmcnt(10)
    ds_read_b64_tr_b16 a[160:161], v2 offset:46176
    ds_read_b64_tr_b16 a[162:163], v2 offset:48736
    v_mfma_f32_16x16x32_bf16 v[52:55], a[164:167], a[96:99], v[52:55]
    v_mfma_f32_16x16x32_bf16 v[72:75], a[164:167], a[100:103], v[72:75]
    s_add_u32 m0, s42, 2048
    s_nop 0
    buffer_load_dwordx4 v6, s[12:15], s38 offen lds
    ds_read_b64_tr_b16 a[164:165], v2 offset:46208
    ds_read_b64_tr_b16 a[166:167], v2 offset:48768
    v_mfma_f32_16x16x32_bf16 v[56:59], a[168:171], a[96:99], v[56:59]
    v_mfma_f32_16x16x32_bf16 v[76:79], a[168:171], a[100:103], v[76:79]
    s_waitcnt lgkmcnt(10)
    ds_read_b64_tr_b16 a[168:169], v2 offset:51200
    ds_read_b64_tr_b16 a[170:171], v2 offset:53760
    v_mfma_f32_16x16x32_bf16 v[60:63], a[172:175], a[96:99], v[60:63]
    v_mfma_f32_16x16x32_bf16 v[80:83], a[172:175], a[100:103], v[80:83]
    ds_read_b64_tr_b16 a[172:173], v2 offset:51232
    ds_read_b64_tr_b16 a[174:175], v2 offset:53792
    v_mfma_f32_16x16x32_bf16 v[64:67], a[176:179], a[96:99], v[64:67]
    v_mfma_f32_16x16x32_bf16 v[84:87], a[176:179], a[100:103], v[84:87]
    s_waitcnt lgkmcnt(10)
    s_add_u32 m0, s42, 3072
    s_nop 0
    buffer_load_dwordx4 v7, s[12:15], s38 offen lds
    ds_read_b64_tr_b16 a[176:177], v2 offset:51264
    ds_read_b64_tr_b16 a[178:179], v2 offset:53824
    v_mfma_f32_16x16x32_bf16 v[48:51], a[180:183], a[104:107], v[48:51]
    v_mfma_f32_16x16x32_bf16 v[68:71], a[180:183], a[108:111], v[68:71]
    ds_read_b64_tr_b16 a[180:181], v2 offset:51296
    ds_read_b64_tr_b16 a[182:183], v2 offset:53856
    v_mfma_f32_16x16x32_bf16 v[52:55], a[184:187], a[104:107], v[52:55]
    v_mfma_f32_16x16x32_bf16 v[72:75], a[184:187], a[108:111], v[72:75]
    s_waitcnt lgkmcnt(10)
    ds_read_b64_tr_b16 a[184:185], v2 offset:51328
    ds_read_b64_tr_b16 a[186:187], v2 offset:53888
    v_mfma_f32_16x16x32_bf16 v[56:59], a[188:191], a[104:107], v[56:59]
    v_mfma_f32_16x16x32_bf16 v[76:79], a[188:191], a[108:111], v[76:79]
    ds_read_b64_tr_b16 a[188:189], v2 offset:56320
    ds_read_b64_tr_b16 a[190:191], v2 offset:58880
    v_mfma_f32_16x16x32_bf16 v[60:63], a[160:163], a[104:107], v[60:63]
    v_mfma_f32_16x16x32_bf16 v[80:83], a[160:163], a[108:111], v[80:83]
    s_waitcnt lgkmcnt(10)
    s_add_u32 m0, s42, 4096
    s_nop 0
    buffer_load_dwordx4 v8, s[12:15], s38 offen lds
    ds_read_b64_tr_b16 a[160:161], v2 offset:56352
    ds_read_b64_tr_b16 a[162:163], v2 offset:58912
    v_mfma_f32_16x16x32_bf16 v[64:67], a[164:167], a[104:107], v[64:67]
    v_mfma_f32_16x16x32_bf16 v[84:87], a[164:167], a[108:111], v[84:87]
    ds_read_b64_tr_b16 a[164:165], v2 offset:56384
    ds_read_b64_tr_b16 a[166:167], v2 offset:58944
    v_mfma_f32_16x16x32_bf16 v[48:51], a[168:171], a[112:115], v[48:51]
    v_mfma_f32_16x16x32_bf16 v[68:71], a[168:171], a[116:119], v[68:71]
    s_waitcnt lgkmcnt(10)
    ds_read_b64_tr_b16 a[168:169], v2 offset:56416
    ds_read_b64_tr_b16 a[170:171], v2 offset:58976
    v_mfma_f32_16x16x32_bf16 v[52:55], a[172:175], a[112:115], v[52:55]
    v_mfma_f32_16x16x32_bf16 v[72:75], a[172:175], a[116:119], v[72:75]
    ds_read_b64_tr_b16 a[172:173], v2 offset:56448
    ds_read_b64_tr_b16 a[174:175], v2 offset:59008
    v_mfma_f32_16x16x32_bf16 v[56:59], a[176:179], a[112:115], v[56:59]
    v_mfma_f32_16x16x32_bf16 v[76:79], a[176:179], a[116:119], v[76:79]
    s_waitcnt lgkmcnt(10)
    s_waitcnt vmcnt(11)
    s_barrier
    ds_read_b64_tr_b16 a[176:177], v3 offset:0
    ds_read_b64_tr_b16 a[178:179], v3 offset:2560
    v_mfma_f32_16x16x32_bf16 v[60:63], a[180:183], a[112:115], v[60:63]
    v_mfma_f32_16x16x32_bf16 v[80:83], a[180:183], a[116:119], v[80:83]
    ds_read_b64_tr_b16 a[180:181], v3 offset:32
    ds_read_b64_tr_b16 a[182:183], v3 offset:2592
    v_mfma_f32_16x16x32_bf16 v[64:67], a[184:187], a[112:115], v[64:67]
    v_mfma_f32_16x16x32_bf16 v[84:87], a[184:187], a[116:119], v[84:87]
    s_waitcnt lgkmcnt(10)
    s_add_u32 m0, s42, 20480
    s_nop 0
    buffer_load_dwordx4 v4, s[12:15], s39 offen lds
    ds_read_b64_tr_b16 a[184:185], v3 offset:64
    ds_read_b64_tr_b16 a[186:187], v3 offset:2624
    v_mfma_f32_16x16x32_bf16 v[48:51], a[188:191], a[120:123], v[48:51]
    v_mfma_f32_16x16x32_bf16 v[68:71], a[188:191], a[124:127], v[68:71]
    ds_read_b64_tr_b16 a[188:189], v3 offset:96
    ds_read_b64_tr_b16 a[190:191], v3 offset:2656
    v_mfma_f32_16x16x32_bf16 v[52:55], a[160:163], a[120:123], v[52:55]
    v_mfma_f32_16x16x32_bf16 v[72:75], a[160:163], a[124:127], v[72:75]
    s_waitcnt lgkmcnt(10)
    ds_read_b64_tr_b16 a[160:161], v3 offset:128
    ds_read_b64_tr_b16 a[162:163], v3 offset:2688
    v_mfma_f32_16x16x32_bf16 v[56:59], a[164:167], a[120:123], v[56:59]
    v_mfma_f32_16x16x32_bf16 v[76:79], a[164:167], a[124:127], v[76:79]
    s_add_u32 m0, s42, 21504
    s_nop 0
    buffer_load_dwordx4 v5, s[12:15], s39 offen lds
    ds_read_b64_tr_b16 a[164:165], v3 offset:5120
    ds_read_b64_tr_b16 a[166:167], v3 offset:7680
    v_mfma_f32_16x16x32_bf16 v[60:63], a[168:171], a[120:123], v[60:63]
    v_mfma_f32_16x16x32_bf16 v[80:83], a[168:171], a[124:127], v[80:83]
    s_waitcnt lgkmcnt(10)
    ds_read_b64_tr_b16 a[168:169], v3 offset:5152
    ds_read_b64_tr_b16 a[170:171], v3 offset:7712
    v_mfma_f32_16x16x32_bf16 v[64:67], a[172:175], a[120:123], v[64:67]
    v_mfma_f32_16x16x32_bf16 v[84:87], a[172:175], a[124:127], v[84:87]
    ds_read_b64_tr_b16 a[172:173], v3 offset:5184
    ds_read_b64_tr_b16 a[174:175], v3 offset:7744
    v_mfma_f32_16x16x32_bf16 v[48:51], a[176:179], a[128:131], v[48:51]
    v_mfma_f32_16x16x32_bf16 v[68:71], a[176:179], a[132:135], v[68:71]
    s_waitcnt lgkmcnt(10)
    ds_read_b64_tr_b16 a[176:177], v3 offset:5216
    ds_read_b64_tr_b16 a[178:179], v3 offset:7776
    v_mfma_f32_16x16x32_bf16 v[52:55], a[180:183], a[128:131], v[52:55]
    v_mfma_f32_16x16x32_bf16 v[72:75], a[180:183], a[132:135], v[72:75]
    s_add_u32 m0, s42, 22528
    s_nop 0
    buffer_load_dwordx4 v6, s[12:15], s39 offen lds
    ds_read_b64_tr_b16 a[180:181], v3 offset:5248
    ds_read_b64_tr_b16 a[182:183], v3 offset:7808
    v_mfma_f32_16x16x32_bf16 v[56:59], a[184:187], a[128:131], v[56:59]
    v_mfma_f32_16x16x32_bf16 v[76:79], a[184:187], a[132:135], v[76:79]
    s_waitcnt lgkmcnt(10)
    ds_read_b64_tr_b16 a[184:185], v3 offset:10240
    ds_read_b64_tr_b16 a[186:187], v3 offset:12800
    v_mfma_f32_16x16x32_bf16 v[60:63], a[188:191], a[128:131], v[60:63]
    v_mfma_f32_16x16x32_bf16 v[80:83], a[188:191], a[132:135], v[80:83]
    ds_read_b64_tr_b16 a[188:189], v3 offset:10272
    ds_read_b64_tr_b16 a[190:191], v3 offset:12832
    v_mfma_f32_16x16x32_bf16 v[64:67], a[160:163], a[128:131], v[64:67]
    v_mfma_f32_16x16x32_bf16 v[84:87], a[160:163], a[132:135], v[84:87]
    s_waitcnt lgkmcnt(10)
    s_add_u32 m0, s42, 23552
    s_nop 0
    buffer_load_dwordx4 v7, s[12:15], s39 offen lds
    ds_read_b64_tr_b16 a[160:161], v3 offset:10304
    ds_read_b64_tr_b16 a[162:163], v3 offset:12864
    v_mfma_f32_16x16x32_bf16 v[48:51], a[164:167], a[136:139], v[48:51]
    v_mfma_f32_16x16x32_bf16 v[68:71], a[164:167], a[140:143], v[68:71]
    ds_read_b64_tr_b16 a[164:165], v3 offset:10336
    ds_read_b64_tr_b16 a[166:167], v3 offset:12896
    v_mfma_f32_16x16x32_bf16 v[52:55], a[168:171], a[136:139], v[52:55]
    v_mfma_f32_16x16x32_bf16 v[72:75], a[168:171], a[140:143], v[72:75]
    s_waitcnt lgkmcnt(10)
    ds_read_b64_tr_b16 a[168:169], v3 offset:10368
    ds_read_b64_tr_b16 a[170:171], v3 offset:12928
    v_mfma_f32_16x16x32_bf16 v[56:59], a[172:175], a[136:139], v[56:59]
    v_mfma_f32_16x16x32_bf16 v[76:79], a[172:175], a[140:143], v[76:79]
    ds_read_b64_tr_b16 a[172:173], v3 offset:15360
    ds_read_b64_tr_b16 a[174:175], v3 offset:17920
    v_mfma_f32_16x16x32_bf16 v[60:63], a[176:179], a[136:139], v[60:63]
    v_mfma_f32_16x16x32_bf16 v[80:83], a[176:179], a[140:143], v[80:83]
    s_waitcnt lgkmcnt(10)
    s_add_u32 m0, s42, 24576
    s_nop 0
    buffer_load_dwordx4 v8, s[12:15], s39 offen lds
    ds_read_b64_tr_b16 a[176:177], v3 offset:15392
    ds_read_b64_tr_b16 a[178:179], v3 offset:17952
    v_mfma_f32_16x16x32_bf16 v[64:67], a[180:183], a[136:139], v[64:67]
    v_mfma_f32_16x16x32_bf16 v[84:87], a[180:183], a[140:143], v[84:87]
    ds_read_b64_tr_b16 a[180:181], v3 offset:15424
    ds_read_b64_tr_b16 a[182:183], v3 offset:17984
    v_mfma_f32_16x16x32_bf16 v[48:51], a[184:187], a[144:147], v[48:51]
    v_mfma_f32_16x16x32_bf16 v[68:71], a[184:187], a[148:151], v[68:71]
    s_waitcnt lgkmcnt(10)
    ds_read_b64_tr_b16 a[184:185], v3 offset:15456
    ds_read_b64_tr_b16 a[186:187], v3 offset:18016
    v_mfma_f32_16x16x32_bf16 v[52:55], a[188:191], a[144:147], v[52:55]
    v_mfma_f32_16x16x32_bf16 v[72:75], a[188:191], a[148:151], v[72:75]
    ds_read_b64_tr_b16 a[188:189], v3 offset:15488
    ds_read_b64_tr_b16 a[190:191], v3 offset:18048
    v_mfma_f32_16x16x32_bf16 v[56:59], a[160:163], a[144:147], v[56:59]
    v_mfma_f32_16x16x32_bf16 v[76:79], a[160:163], a[148:151], v[76:79]
    s_waitcnt lgkmcnt(10)
    s_waitcnt vmcnt(11)
    s_barrier
    ds_read_b64_tr_b16 a[160:161], v2 offset:0
    ds_read_b64_tr_b16 a[162:163], v2 offset:2560
    v_mfma_f32_16x16x32_bf16 v[60:63], a[164:167], a[144:147], v[60:63]
    v_mfma_f32_16x16x32_bf16 v[80:83], a[164:167], a[148:151], v[80:83]
    ds_read_b64_tr_b16 a[164:165], v2 offset:32
    ds_read_b64_tr_b16 a[166:167], v2 offset:2592
    v_mfma_f32_16x16x32_bf16 v[64:67], a[168:171], a[144:147], v[64:67]
    v_mfma_f32_16x16x32_bf16 v[84:87], a[168:171], a[148:151], v[84:87]
    s_waitcnt lgkmcnt(10)
    ds_read_b64_tr_b16 a[168:169], v2 offset:64
    ds_read_b64_tr_b16 a[170:171], v2 offset:2624
    v_mfma_f32_16x16x32_bf16 v[48:51], a[172:175], a[152:155], v[48:51]
    v_mfma_f32_16x16x32_bf16 v[68:71], a[172:175], a[156:159], v[68:71]
    ds_read_b64_tr_b16 a[172:173], v2 offset:96
    ds_read_b64_tr_b16 a[174:175], v2 offset:2656
    v_mfma_f32_16x16x32_bf16 v[52:55], a[176:179], a[152:155], v[52:55]
    v_mfma_f32_16x16x32_bf16 v[72:75], a[176:179], a[156:159], v[72:75]
    s_waitcnt lgkmcnt(10)
    ds_read_b64_tr_b16 a[176:177], v2 offset:128
    ds_read_b64_tr_b16 a[178:179], v2 offset:2688
    v_mfma_f32_16x16x32_bf16 v[56:59], a[180:183], a[152:155], v[56:59]
    v_mfma_f32_16x16x32_bf16 v[76:79], a[180:183], a[156:159], v[76:79]
    ds_read_b64_tr_b16 a[180:181], v2 offset:5120
    ds_read_b64_tr_b16 a[182:183], v2 offset:7680
    v_mfma_f32_16x16x32_bf16 v[60:63], a[184:187], a[152:155], v[60:63]
    v_mfma_f32_16x16x32_bf16 v[80:83], a[184:187], a[156:159], v[80:83]
    s_waitcnt lgkmcnt(10)
    ds_read_b64_tr_b16 a[184:185], v2 offset:5152
    ds_read_b64_tr_b16 a[186:187], v2 offset:7712
    v_mfma_f32_16x16x32_bf16 v[64:67], a[188:191], a[152:155], v[64:67]
    v_mfma_f32_16x16x32_bf16 v[84:87], a[188:191], a[156:159], v[84:87]
    v_cvt_pk_bf16_f32 v120, v48, v49
    v_cvt_pk_bf16_f32 v110, v68, v69
    v_cvt_pk_bf16_f32 v121, v50, v51
    v_cvt_pk_bf16_f32 v111, v70, v71
    v_cvt_pk_bf16_f32 v122, v52, v53
    v_cvt_pk_bf16_f32 v112, v72, v73
    v_cvt_pk_bf16_f32 v123, v54, v55
    v_cvt_pk_bf16_f32 v113, v74, v75
    v_cvt_pk_bf16_f32 v124, v56, v57
    v_cvt_pk_bf16_f32 v114, v76, v77
    v_cvt_pk_bf16_f32 v125, v58, v59
    v_cvt_pk_bf16_f32 v115, v78, v79
    v_cvt_pk_bf16_f32 v126, v60, v61
    v_cvt_pk_bf16_f32 v116, v80, v81
    v_cvt_pk_bf16_f32 v127, v62, v63
    v_cvt_pk_bf16_f32 v117, v82, v83
    v_cvt_pk_bf16_f32 v128, v64, v65
    v_cvt_pk_bf16_f32 v118, v84, v85
    v_cvt_pk_bf16_f32 v129, v66, v67
    v_cvt_pk_bf16_f32 v119, v86, v87
    s_add_u32 s3, s42, 102400
    v_add_u32 v16, s3, v221
    ds_write_b64 v16, v[120:121] offset:0
    ds_write_b64 v16, v[122:123] offset:32
    ds_write_b64 v16, v[124:125] offset:64
    ds_write_b64 v16, v[126:127] offset:96
    ds_write_b64 v16, v[128:129] offset:128
    ds_write_b64 v16, v[110:111] offset:2560
    ds_write_b64 v16, v[112:113] offset:2592
    ds_write_b64 v16, v[114:115] offset:2624
    ds_write_b64 v16, v[116:117] offset:2656
    ds_write_b64 v16, v[118:119] offset:2688
    s_cmp_lg_u32 s28, 3
    s_cbranch_scc1 Lhalo_21
    s_lshl_b32 s3, s29, 3
    s_add_u32 s3, s3, s30
    s_mul_i32 s3, s3, 5120
    s_add_u32 s3, s3, 6291456
    v_lshlrev_b32 v17, 4, v0
    buffer_store_dwordx4 v[100:103], v17, s[16:19], s3 offen offset:0 sc1
    buffer_store_dwordx4 v[104:107], v17, s[16:19], s3 offen offset:1024 sc1
    buffer_store_dwordx4 v[108:111], v17, s[16:19], s3 offen offset:2048 sc1
    buffer_store_dwordx4 v[112:115], v17, s[16:19], s3 offen offset:3072 sc1
    s_add_u32 s3, s3, 4096
    buffer_store_dwordx4 v[116:119], v17, s[16:19], s3 offen offset:0 sc1
Lhalo_21:
    ds_read_b64_tr_b16 a[188:189], v2 offset:5184
    ds_read_b64_tr_b16 a[190:191], v2 offset:7744
    v_mfma_f32_16x16x32_bf16 v[48:51], a[160:163], a[0:3], 0
    v_mfma_f32_16x16x32_bf16 v[68:71], a[160:163], a[4:7], 0
    s_waitcnt lgkmcnt(15)
    s_add_u32 m0, s42, 40960
    s_nop 0
    buffer_load_dwordx4 v4, s[12:15], s40 offen lds
    ds_read_b64_tr_b16 a[160:161], v2 offset:5216
    ds_read_b64_tr_b16 a[162:163], v2 offset:7776
    v_mfma_f32_16x16x32_bf16 v[52:55], a[164:167], a[0:3], 0
    v_mfma_f32_16x16x32_bf16 v[72:75], a[164:167], a[4:7], 0
    ds_read_b64_tr_b16 a[164:165], v2 offset:5248
    ds_read_b64_tr_b16 a[166:167], v2 offset:7808
    v_mfma_f32_16x16x32_bf16 v[56:59], a[168:171], a[0:3], 0
    v_mfma_f32_16x16x32_bf16 v[76:79], a[168:171], a[4:7], 0
    s_add_u32 m0, s42, 41984
    s_nop 0
    buffer_load_dwordx4 v5, s[12:15], s40 offen lds
    ds_read_b64_tr_b16 a[168:169], v2 offset:10240
    ds_read_b64_tr_b16 a[170:171], v2 offset:12800
    v_mfma_f32_16x16x32_bf16 v[60:63], a[172:175], a[0:3], 0
    v_mfma_f32_16x16x32_bf16 v[80:83], a[172:175], a[4:7], 0
    ds_read_b64_tr_b16 a[172:173], v2 offset:10272
    ds_read_b64_tr_b16 a[174:175], v2 offset:12832
    v_mfma_f32_16x16x32_bf16 v[64:67], a[176:179], a[0:3], 0
    v_mfma_f32_16x16x32_bf16 v[84:87], a[176:179], a[4:7], 0
    s_waitcnt lgkmcnt(15)
    ds_read_b64_tr_b16 a[176:177], v2 offset:10304
    ds_read_b64_tr_b16 a[178:179], v2 offset:12864
    v_mfma_f32_16x16x32_bf16 v[48:51], a[180:183], a[8:11], v[48:51]
    v_mfma_f32_16x16x32_bf16 v[68:71], a[180:183], a[12:15], v[68:71]
    s_add_u32 m0, s42, 43008
    s_nop 0
    buffer_load_dwordx4 v6, s[12:15], s40 offen lds
    ds_read_b64_tr_b16 a[180:181], v2 offset:10336
    ds_read_b64_tr_b16 a[182:183], v2 offset:12896
    v_mfma_f32_16x16x32_bf16 v[52:55], a[184:187], a[8:11], v[52:55]
    v_mfma_f32_16x16x32_bf16 v[72:75], a[184:187], a[12:15], v[72:75]
    s_waitcnt lgkmcnt(10)
    ds_read_b64_tr_b16 a[184:185], v2 offset:10368
    ds_read_b64_tr_b16 a[186:187], v2 offset:12928
    v_mfma_f32_16x16x32_bf16 v[56:59], a[188:191], a[8:11], v[56:59]
    v_mfma_f32_16x16x32_bf16 v[76:79], a[188:191], a[12:15], v[76:79]
    s_add_u32 m0, s42, 44032
    s_nop 0
    buffer_load_dwordx4 v7, s[12:15], s40 offen lds
    ds_read_b64_tr_b16 a[188:189], v2 offset:15360
    ds_read_b64_tr_b16 a[190:191], v2 offset:17920
    v_mfma_f32_16x16x32_bf16 v[60:63], a[160:163], a[8:11], v[60:63]
    v_mfma_f32_16x16x32_bf16 v[80:83], a[160:163], a[12:15], v[80:83]
    s_waitcnt lgkmcnt(10)
    ds_read_b64_tr_b16 a[160:161], v2 offset:15392
    ds_read_b64_tr_b16 a[162:163], v2 offset:17952
    v_mfma_f32_16x16x32_bf16 v[64:67], a[164:167], a[8:11], v[64:67]
    v_mfma_f32_16x16x32_bf16 v[84:87], a[164:167], a[12:15], v[84:87]
    ds_read_b64_tr_b16 a[164:165], v2 offset:15424
    ds_read_b64_tr_b16 a[166:167], v2 offset:17984
    v_mfma_f32_16x16x32_bf16 v[48:51], a[168:171], a[16:19], v[48:51]
    v_mfma_f32_16x16x32_bf16 v[68:71], a[168:171], a[20:23], v[68:71]
    s_waitcnt lgkmcnt(10)
    s_add_u32 m0, s42, 45056
    s_nop 0
    buffer_load_dwordx4 v8, s[12:15], s40 offen lds
    ds_read_b64_tr_b16 a[168:169], v2 offset:15456
    ds_read_b64_tr_b16 a[170:171], v2 offset:18016
    v_mfma_f32_16x16x32_bf16 v[52:55], a[172:175], a[16:19], v[52:55]
    v_mfma_f32_16x16x32_bf16 v[72:75], a[172:175], a[20:23], v[72:75]
    ds_read_b64_tr_b16 a[172:173], v2 offset:15488
    ds_read_b64_tr_b16 a[174:175], v2 offset:18048
    v_mfma_f32_16x16x32_bf16 v[56:59], a[176:179], a[16:19], v[56:59]
    v_mfma_f32_16x16x32_bf16 v[76:79], a[176:179], a[20:23], v[76:79]
    s_waitcnt lgkmcnt(10)
    s_waitcnt vmcnt(10)
    s_barrier
    ds_read_b64_tr_b16 a[176:177], v1 offset:0
    ds_read_b64_tr_b16 a[178:179], v1 offset:2560
    v_mfma_f32_16x16x32_bf16 v[60:63], a[180:183], a[16:19], v[60:63]
    v_mfma_f32_16x16x32_bf16 v[80:83], a[180:183], a[20:23], v[80:83]
    ds_read_b64_tr_b16 a[180:181], v1 offset:32
    ds_read_b64_tr_b16 a[182:183], v1 offset:2592
    v_mfma_f32_16x16x32_bf16 v[64:67], a[184:187], a[16:19], v[64:67]
    v_mfma_f32_16x16x32_bf16 v[84:87], a[184:187], a[20:23], v[84:87]
    s_waitcnt lgkmcnt(10)
    s_add_u32 m0, s42, 81920
    s_nop 0
    buffer_load_dwordx4 v4, s[12:15], s41 offen lds
    ds_read_b64_tr_b16 a[184:185], v1 offset:64
    ds_read_b64_tr_b16 a[186:187], v1 offset:2624
    v_mfma_f32_16x16x32_bf16 v[48:51], a[188:191], a[24:27], v[48:51]
    v_mfma_f32_16x16x32_bf16 v[68:71], a[188:191], a[28:31], v[68:71]
    ds_read_b64_tr_b16 a[188:189], v1 offset:96
    ds_read_b64_tr_b16 a[190:191], v1 offset:2656
    v_mfma_f32_16x16x32_bf16 v[52:55], a[160:163], a[24:27], v[52:55]
    v_mfma_f32_16x16x32_bf16 v[72:75], a[160:163], a[28:31], v[72:75]
    s_waitcnt lgkmcnt(10)
    ds_read_b64_tr_b16 a[160:161], v1 offset:128
    ds_read_b64_tr_b16 a[162:163], v1 offset:2688
    v_mfma_f32_16x16x32_bf16 v[56:59], a[164:167], a[24:27], v[56:59]
    v_mfma_f32_16x16x32_bf16 v[76:79], a[164:167], a[28:31], v[76:79]
    s_add_u32 m0, s42, 82944
    s_nop 0
    buffer_load_dwordx4 v5, s[12:15], s41 offen lds
    ds_read_b64_tr_b16 a[164:165], v1 offset:5120
    ds_read_b64_tr_b16 a[166:167], v1 offset:7680
    v_mfma_f32_16x16x32_bf16 v[60:63], a[168:171], a[24:27], v[60:63]
    v_mfma_f32_16x16x32_bf16 v[80:83], a[168:171], a[28:31], v[80:83]
    s_waitcnt lgkmcnt(10)
    ds_read_b64_tr_b16 a[168:169], v1 offset:5152
    ds_read_b64_tr_b16 a[170:171], v1 offset:7712
    v_mfma_f32_16x16x32_bf16 v[64:67], a[172:175], a[24:27], v[64:67]
    v_mfma_f32_16x16x32_bf16 v[84:87], a[172:175], a[28:31], v[84:87]
    ds_read_b64_tr_b16 a[172:173], v1 offset:5184
    ds_read_b64_tr_b16 a[174:175], v1 offset:7744
    v_mfma_f32_16x16x32_bf16 v[48:51], a[176:179], a[32:35], v[48:51]
    v_mfma_f32_16x16x32_bf16 v[68:71], a[176:179], a[36:39], v[68:71]
    s_waitcnt lgkmcnt(10)
    s_add_u32 m0, s42, 83968
    s_nop 0
    buffer_load_dwordx4 v6, s[12:15], s41 offen lds
    ds_read_b64_tr_b16 a[176:177], v1 offset:5216
    ds_read_b64_tr_b16 a[178:179], v1 offset:7776
    v_mfma_f32_16x16x32_bf16 v[52:55], a[180:183], a[32:35], v[52:55]
    v_mfma_f32_16x16x32_bf16 v[72:75], a[180:183], a[36:39], v[72:75]
    ds_read_b64_tr_b16 a[180:181], v1 offset:5248
    ds_read_b64_tr_b16 a[182:183], v1 offset:7808
    v_mfma_f32_16x16x32_bf16 v[56:59], a[184:187], a[32:35], v[56:59]
    v_mfma_f32_16x16x32_bf16 v[76:79], a[184:187], a[36:39], v[76:79]
    s_waitcnt lgkmcnt(10)
    ds_read_b64_tr_b16 a[184:185], v1 offset:10240
    ds_read_b64_tr_b16 a[186:187], v1 offset:12800
    v_mfma_f32_16x16x32_bf16 v[60:63], a[188:191], a[32:35], v[60:63]
    v_mfma_f32_16x16x32_bf16 v[80:83], a[188:191], a[36:39], v[80:83]
    ds_read_b64_tr_b16 a[188:189], v1 offset:10272
    ds_read_b64_tr_b16 a[190:191], v1 offset:12832
    v_mfma_f32_16x16x32_bf16 v[64:67], a[160:163], a[32:35], v[64:67]
    v_mfma_f32_16x16x32_bf16 v[84:87], a[160:163], a[36:39], v[84:87]
    s_waitcnt lgkmcnt(10)
    s_add_u32 m0, s42, 84992
    s_nop 0
    buffer_load_dwordx4 v7, s[12:15], s41 offen lds
    ds_read_b64_tr_b16 a[160:161], v1 offset:10304
    ds_read_b64_tr_b16 a[162:163], v1 offset:12864
    v_mfma_f32_16x16x32_bf16 v[48:51], a[164:167], a[40:43], v[48:51]
    v_mfma_f32_16x16x32_bf16 v[68:71], a[164:167], a[44:47], v[68:71]
    ds_read_b64_tr_b16 a[164:165], v1 offset:10336
    ds_read_b64_tr_b16 a[166:167], v1 offset:12896
    v_mfma_f32_16x16x32_bf16 v[52:55], a[168:171], a[40:43], v[52:55]
    v_mfma_f32_16x16x32_bf16 v[72:75], a[168:171], a[44:47], v[72:75]
    s_waitcnt lgkmcnt(10)
    ds_read_b64_tr_b16 a[168:169], v1 offset:10368
    ds_read_b64_tr_b16 a[170:171], v1 offset:12928
    v_mfma_f32_16x16x32_bf16 v[56:59], a[172:175], a[40:43], v[56:59]
    v_mfma_f32_16x16x32_bf16 v[76:79], a[172:175], a[44:47], v[76:79]
    s_add_u32 m0, s42, 86016
    s_nop 0
    buffer_load_dwordx4 v8, s[12:15], s41 offen lds
    ds_read_b64_tr_b16 a[172:173], v1 offset:15360
    ds_read_b64_tr_b16 a[174:175], v1 offset:17920
    v_mfma_f32_16x16x32_bf16 v[60:63], a[176:179], a[40:43], v[60:63]
    v_mfma_f32_16x16x32_bf16 v[80:83], a[176:179], a[44:47], v[80:83]
    s_waitcnt lgkmcnt(10)
    ds_read_b64_tr_b16 a[176:177], v1 offset:15392
    ds_read_b64_tr_b16 a[178:179], v1 offset:17952
    v_mfma_f32_16x16x32_bf16 v[64:67], a[180:183], a[40:43], v[64:67]
    v_mfma_f32_16x16x32_bf16 v[84:87], a[180:183], a[44:47], v[84:87]
    ds_read_b64_tr_b16 a[180:181], v1 offset:15424
    ds_read_b64_tr_b16 a[182:183], v1 offset:17984
    v_mfma_f32_16x16x32_bf16 v[48:51], a[184:187], a[48:51], v[48:51]
    v_mfma_f32_16x16x32_bf16 v[68:71], a[184:187], a[52:55], v[68:71]
    s_waitcnt lgkmcnt(10)
    ds_read_b64_tr_b16 a[184:185], v1 offset:15456
    ds_read_b64_tr_b16 a[186:187], v1 offset:18016
    v_mfma_f32_16x16x32_bf16 v[52:55], a[188:191], a[48:51], v[52:55]
    v_mfma_f32_16x16x32_bf16 v[72:75], a[188:191], a[52:55], v[72:75]
    ds_read_b64_tr_b16 a[188:189], v1 offset:15488
    ds_read_b64_tr_b16 a[190:191], v1 offset:18048
    v_mfma_f32_16x16x32_bf16 v[56:59], a[160:163], a[48:51], v[56:59]
    v_mfma_f32_16x16x32_bf16 v[76:79], a[160:163], a[52:55], v[76:79]
    s_waitcnt lgkmcnt(10)
    v_add_u32 v13, 0, v0
    v_mul_u32_u24 v14, 6554, v13
    v_lshrrev_b32 v14, 16, v14
    v_mul_u32_u24 v15, 10, v14
    v_sub_u32 v15, v13, v15
    v_mul_u32_u24 v14, 1280, v14
    v_lshl_add_u32 v4, v15, 4, v14
    v_add_u32 v13, 64, v0
    v_mul_u32_u24 v14, 6554, v13
    v_lshrrev_b32 v14, 16, v14
    v_mul_u32_u24 v15, 10, v14
    v_sub_u32 v15, v13, v15
    v_mul_u32_u24 v14, 1280, v14
    v_lshl_add_u32 v5, v15, 4, v14
    v_add_u32 v13, 128, v0
    v_mul_u32_u24 v14, 6554, v13
    v_lshrrev_b32 v14, 16, v14
    v_mul_u32_u24 v15, 10, v14
    v_sub_u32 v15, v13, v15
    v_mul_u32_u24 v14, 1280, v14
    v_lshl_add_u32 v6, v15, 4, v14
    v_add_u32 v13, 192, v0
    v_mul_u32_u24 v14, 6554, v13
    v_lshrrev_b32 v14, 16, v14
    v_mul_u32_u24 v15, 10, v14
    v_sub_u32 v15, v13, v15
    v_mul_u32_u24 v14, 1280, v14
    v_lshl_add_u32 v7, v15, 4, v14
    v_add_u32 v13, 256, v0
    v_mul_u32_u24 v14, 6554, v13
    v_lshrrev_b32 v14, 16, v14
    v_mul_u32_u24 v15, 10, v14
    v_sub_u32 v15, v13, v15
    v_mul_u32_u24 v14, 1280, v14
    v_lshl_add_u32 v8, v15, 4, v14
    s_mul_i32 s37, s28, 40960
    s_mul_i32 s7, s30, 160
    s_add_u32 s37, s37, s7
    s_waitcnt vmcnt(10)
    s_barrier
    s_lshl_b32 s4, s29, 3
    s_add_u32 s4, s4, s30
    s_lshl_b32 s4, s4, 7
    s_add_u32 s4, s4, 9437184
    s_cmp_lg_u32 s28, 0
    s_cbranch_scc1 Lfl_22
    v_mov_b32 v13, 0
    v_mov_b32 v14, s43
    s_mov_b64 exec, 1
    buffer_store_dword v14, v13, s[16:19], s4 offen sc1
    s_mov_b64 exec, -1
Lfl_22:
    ds_read_b64_tr_b16 a[160:161], v1 offset:20480
    ds_read_b64_tr_b16 a[162:163], v1 offset:23040
    v_mfma_f32_16x16x32_bf16 v[60:63], a[164:167], a[48:51], v[60:63]
    v_mfma_f32_16x16x32_bf16 v[80:83], a[164:167], a[52:55], v[80:83]
    ds_read_b64_tr_b16 a[164:165], v1 offset:20512
    ds_read_b64_tr_b16 a[166:167], v1 offset:23072
    v_mfma_f32_16x16x32_bf16 v[64:67], a[168:171], a[48:51], v[64:67]
    v_mfma_f32_16x16x32_bf16 v[84:87], a[168:171], a[52:55], v[84:87]
    s_waitcnt lgkmcnt(10)
    s_add_u32 m0, s42, 122880
    s_nop 0
    buffer_load_dwordx4 v4, s[44:47], s37 offen lds
    ds_read_b64_tr_b16 a[168:169], v1 offset:20544
    ds_read_b64_tr_b16 a[170:171], v1 offset:23104
    v_mfma_f32_16x16x32_bf16 v[48:51], a[172:175], a[56:59], v[48:51]
    v_mfma_f32_16x16x32_bf16 v[68:71], a[172:175], a[60:63], v[68:71]
    ds_read_b64_tr_b16 a[172:173], v1 offset:20576
    ds_read_b64_tr_b16 a[174:175], v1 offset:23136
    v_mfma_f32_16x16x32_bf16 v[52:55], a[176:179], a[56:59], v[52:55]
    v_mfma_f32_16x16x32_bf16 v[72:75], a[176:179], a[60:63], v[72:75]
    s_waitcnt lgkmcnt(10)
    ds_read_b64_tr_b16 a[176:177], v1 offset:20608
    ds_read_b64_tr_b16 a[178:179], v1 offset:23168
    v_mfma_f32_16x16x32_bf16 v[56:59], a[180:183], a[56:59], v[56:59]
    v_mfma_f32_16x16x32_bf16 v[76:79], a[180:183], a[60:63], v[76:79]
    s_add_u32 m0, s42, 123904
    s_nop 0
    buffer_load_dwordx4 v5, s[44:47], s37 offen lds
    ds_read_b64_tr_b16 a[180:181], v1 offset:25600
    ds_read_b64_tr_b16 a[182:183], v1 offset:28160
    v_mfma_f32_16x16x32_bf16 v[60:63], a[184:187], a[56:59], v[60:63]
    v_mfma_f32_16x16x32_bf16 v[80:83], a[184:187], a[60:63], v[80:83]
    s_waitcnt lgkmcnt(10)
    ds_read_b64_tr_b16 a[184:185], v1 offset:25632
    ds_read_b64_tr_b16 a[186:187], v1 offset:28192
    v_mfma_f32_16x16x32_bf16 v[64:67], a[188:191], a[56:59], v[64:67]
    v_mfma_f32_16x16x32_bf16 v[84:87], a[188:191], a[60:63], v[84:87]
    ds_read_b64_tr_b16 a[188:189], v1 offset:25664
    ds_read_b64_tr_b16 a[190:191], v1 offset:28224
    v_mfma_f32_16x16x32_bf16 v[48:51], a[160:163], a[64:67], v[48:51]
    v_mfma_f32_16x16x32_bf16 v[68:71], a[160:163], a[68:71], v[68:71]
    s_waitcnt lgkmcnt(10)
    ds_read_b64_tr_b16 a[160:161], v1 offset:25696
    ds_read_b64_tr_b16 a[162:163], v1 offset:28256
    v_mfma_f32_16x16x32_bf16 v[52:55], a[164:167], a[64:67], v[52:55]
    v_mfma_f32_16x16x32_bf16 v[72:75], a[164:167], a[68:71], v[72:75]
    s_add_u32 m0, s42, 124928
    s_nop 0
    buffer_load_dwordx4 v6, s[44:47], s37 offen lds
    ds_read_b64_tr_b16 a[164:165], v1 offset:25728
    ds_read_b64_tr_b16 a[166:167], v1 offset:28288
    v_mfma_f32_16x16x32_bf16 v[56:59], a[168:171], a[64:67], v[56:59]
    v_mfma_f32_16x16x32_bf16 v[76:79], a[168:171], a[68:71], v[76:79]
    s_waitcnt lgkmcnt(10)
    ds_read_b64_tr_b16 a[168:169], v1 offset:30720
    ds_read_b64_tr_b16 a[170:171], v1 offset:33280
    v_mfma_f32_16x16x32_bf16 v[60:63], a[172:175], a[64:67], v[60:63]
    v_mfma_f32_16x16x32_bf16 v[80:83], a[172:175], a[68:71], v[80:83]
    ds_read_b64_tr_b16 a[172:173], v1 offset:30752
    ds_read_b64_tr_b16 a[174:175], v1 offset:33312
    v_mfma_f32_16x16x32_bf16 v[64:67], a[176:179], a[64:67], v[64:67]
    v_mfma_f32_16x16x32_bf16 v[84:87], a[176:179], a[68:71], v[84:87]
    s_waitcnt lgkmcnt(10)
    s_add_u32 m0, s42, 125952
    s_nop 0
    buffer_load_dwordx4 v7, s[44:47], s37 offen lds
    ds_read_b64_tr_b16 a[176:177], v1 offset:30784
    ds_read_b64_tr_b16 a[178:179], v1 offset:33344
    v_mfma_f32_16x16x32_bf16 v[48:51], a[180:183], a[72:75], v[48:51]
    v_mfma_f32_16x16x32_bf16 v[68:71], a[180:183], a[76:79], v[68:71]
    ds_read_b64_tr_b16 a[180:181], v1 offset:30816
    ds_read_b64_tr_b16 a[182:183], v1 offset:33376
    v_mfma_f32_16x16x32_bf16 v[52:55], a[184:187], a[72:75], v[52:55]
    v_mfma_f32_16x16x32_bf16 v[72:75], a[184:187], a[76:79], v[72:75]
    s_waitcnt lgkmcnt(10)
    ds_read_b64_tr_b16 a[184:185], v1 offset:30848
    ds_read_b64_tr_b16 a[186:187], v1 offset:33408
    v_mfma_f32_16x16x32_bf16 v[56:59], a[188:191], a[72:75], v[56:59]
    v_mfma_f32_16x16x32_bf16 v[76:79], a[188:191], a[76:79], v[76:79]
    ds_read_b64_tr_b16 a[188:189], v1 offset:35840
    ds_read_b64_tr_b16 a[190:191], v1 offset:38400
    v_mfma_f32_16x16x32_bf16 v[60:63], a[160:163], a[72:75], v[60:63]
    v_mfma_f32_16x16x32_bf16 v[80:83], a[160:163], a[76:79], v[80:83]
    s_waitcnt lgkmcnt(10)
    s_add_u32 m0, s42, 126976
    s_nop 0
    buffer_load_dwordx4 v8, s[44:47], s37 offen lds
    ds_read_b64_tr_b16 a[160:161], v1 offset:35872
    ds_read_b64_tr_b16 a[162:163], v1 offset:38432
    v_mfma_f32_16x16x32_bf16 v[64:67], a[164:167], a[72:75], v[64:67]
    v_mfma_f32_16x16x32_bf16 v[84:87], a[164:167], a[76:79], v[84:87]
    ds_read_b64_tr_b16 a[164:165], v1 offset:35904
    ds_read_b64_tr_b16 a[166:167], v1 offset:38464
    v_mfma_f32_16x16x32_bf16 v[48:51], a[168:171], a[80:83], v[48:51]
    v_mfma_f32_16x16x32_bf16 v[68:71], a[168:171], a[84:87], v[68:71]
    s_waitcnt lgkmcnt(10)
    ds_read_b64_tr_b16 a[168:169], v1 offset:35936
    ds_read_b64_tr_b16 a[170:171], v1 offset:38496
    v_mfma_f32_16x16x32_bf16 v[52:55], a[172:175], a[80:83], v[52:55]
    v_mfma_f32_16x16x32_bf16 v[72:75], a[172:175], a[84:87], v[72:75]
    ds_read_b64_tr_b16 a[172:173], v1 offset:35968
    ds_read_b64_tr_b16 a[174:175], v1 offset:38528
    v_mfma_f32_16x16x32_bf16 v[56:59], a[176:179], a[80:83], v[56:59]
    v_mfma_f32_16x16x32_bf16 v[76:79], a[176:179], a[84:87], v[76:79]
    s_waitcnt lgkmcnt(10)
    s_waitcnt vmcnt(10)
    s_barrier
    ds_read_b64_tr_b16 a[176:177], v1 offset:40960
    ds_read_b64_tr_b16 a[178:179], v1 offset:43520
    v_mfma_f32_16x16x32_bf16 v[60:63], a[180:183], a[80:83], v[60:63]
    v_mfma_f32_16x16x32_bf16 v[80:83], a[180:183], a[84:87], v[80:83]
    ds_read_b64_tr_b16 a[180:181], v1 offset:40992
    ds_read_b64_tr_b16 a[182:183], v1 offset:43552
    v_mfma_f32_16x16x32_bf16 v[64:67], a[184:187], a[80:83], v[64:67]
    v_mfma_f32_16x16x32_bf16 v[84:87], a[184:187], a[84:87], v[84:87]
    s_waitcnt lgkmcnt(10)
    s_add_u32 m0, s42, 61440
    s_add_u32 s7, s37, 163840
    buffer_load_dwordx4 v4, s[44:47], s7 offen lds
    ds_read_b64_tr_b16 a[184:185], v1 offset:41024
    ds_read_b64_tr_b16 a[186:187], v1 offset:43584
    v_mfma_f32_16x16x32_bf16 v[48:51], a[188:191], a[88:91], v[48:51]
    v_mfma_f32_16x16x32_bf16 v[68:71], a[188:191], a[92:95], v[68:71]
    ds_read_b64_tr_b16 a[188:189], v1 offset:41056
    ds_read_b64_tr_b16 a[190:191], v1 offset:43616
    v_mfma_f32_16x16x32_bf16 v[52:55], a[160:163], a[88:91], v[52:55]
    v_mfma_f32_16x16x32_bf16 v[72:75], a[160:163], a[92:95], v[72:75]
    s_waitcnt lgkmcnt(10)
    ds_read_b64_tr_b16 a[160:161], v1 offset:41088
    ds_read_b64_tr_b16 a[162:163], v1 offset:43648
    v_mfma_f32_16x16x32_bf16 v[56:59], a[164:167], a[88:91], v[56:59]
    v_mfma_f32_16x16x32_bf16 v[76:79], a[164:167], a[92:95], v[76:79]
    s_add_u32 m0, s42, 62464
    s_add_u32 s7, s37, 163840
    buffer_load_dwordx4 v5, s[44:47], s7 offen lds
    ds_read_b64_tr_b16 a[164:165], v1 offset:46080
    ds_read_b64_tr_b16 a[166:167], v1 offset:48640
    v_mfma_f32_16x16x32_bf16 v[60:63], a[168:171], a[88:91], v[60:63]
    v_mfma_f32_16x16x32_bf16 v[80:83], a[168:171], a[92:95], v[80:83]
    s_waitcnt lgkmcnt(10)
    ds_read_b64_tr_b16 a[168:169], v1 offset:46112
    ds_read_b64_tr_b16 a[170:171], v1 offset:48672
    v_mfma_f32_16x16x32_bf16 v[64:67], a[172:175], a[88:91], v[64:67]
    v_mfma_f32_16x16x32_bf16 v[84:87], a[172:175], a[92:95], v[84:87]
    ds_read_b64_tr_b16 a[172:173], v1 offset:46144
    ds_read_b64_tr_b16 a[174:175], v1 offset:48704
    v_mfma_f32_16x16x32_bf16 v[48:51], a[176:179], a[96:99], v[48:51]
    v_mfma_f32_16x16x32_bf16 v[68:71], a[176:179], a[100:103], v[68:71]
    s_waitcnt lgkmcnt(10)
    ds_read_b64_tr_b16 a[176:177], v1 offset:46176
    ds_read_b64_tr_b16 a[178:179], v1 offset:48736
    v_mfma_f32_16x16x32_bf16 v[52:55], a[180:183], a[96:99], v[52:55]
    v_mfma_f32_16x16x32_bf16 v[72:75], a[180:183], a[100:103], v[72:75]
    s_add_u32 m0, s42, 63488
    s_add_u32 s7, s37, 163840
    buffer_load_dwordx4 v6, s[44:47], s7 offen lds
    ds_read_b64_tr_b16 a[180:181], v1 offset:46208
    ds_read_b64_tr_b16 a[182:183], v1 offset:48768
    v_mfma_f32_16x16x32_bf16 v[56:59], a[184:187], a[96:99], v[56:59]
    v_mfma_f32_16x16x32_bf16 v[76:79], a[184:187], a[100:103], v[76:79]
    s_waitcnt lgkmcnt(10)
    ds_read_b64_tr_b16 a[184:185], v1 offset:51200
    ds_read_b64_tr_b16 a[186:187], v1 offset:53760
    v_mfma_f32_16x16x32_bf16 v[60:63], a[188:191], a[96:99], v[60:63]
    v_mfma_f32_16x16x32_bf16 v[80:83], a[188:191], a[100:103], v[80:83]
    s_lshl_b32 s4, s29, 3
    s_add_u32 s4, s4, s30
    s_sub_u32 s4, s4, 8
    s_max_i32 s4, s4, 0
    s_lshl_b32 s5, s4, 7
    s_add_u32 s5, s5, 9437184
    v_mov_b32 v18, 0
    s_mov_b64 exec, 1
    buffer_load_dword v19, v18, s[16:19], s5 offen sc1
    s_mov_b64 exec, -1
    ds_read_b64_tr_b16 a[188:189], v1 offset:51232
    ds_read_b64_tr_b16 a[190:191], v1 offset:53792
    v_mfma_f32_16x16x32_bf16 v[64:67], a[160:163], a[96:99], v[64:67]
    v_mfma_f32_16x16x32_bf16 v[84:87], a[160:163], a[100:103], v[84:87]
    s_waitcnt lgkmcnt(10)
    s_add_u32 m0, s42, 64512
    s_add_u32 s7, s37, 163840
    buffer_load_dwordx4 v7, s[44:47], s7 offen lds
    ds_read_b64_tr_b16 a[160:161], v1 offset:51264
    ds_read_b64_tr_b16 a[162:163], v1 offset:53824
    v_mfma_f32_16x16x32_bf16 v[48:51], a[164:167], a[104:107], v[48:51]
    v_mfma_f32_16x16x32_bf16 v[68:71], a[164:167], a[108:111], v[68:71]
    ds_read_b64_tr_b16 a[164:165], v1 offset:51296
    ds_read_b64_tr_b16 a[166:167], v1 offset:53856
    v_mfma_f32_16x16x32_bf16 v[52:55], a[168:171], a[104:107], v[52:55]
    v_mfma_f32_16x16x32_bf16 v[72:75], a[168:171], a[108:111], v[72:75]
    s_waitcnt lgkmcnt(10)
    ds_read_b64_tr_b16 a[168:169], v1 offset:51328
    ds_read_b64_tr_b16 a[170:171], v1 offset:53888
    v_mfma_f32_16x16x32_bf16 v[56:59], a[172:175], a[104:107], v[56:59]
    v_mfma_f32_16x16x32_bf16 v[76:79], a[172:175], a[108:111], v[76:79]
    ds_read_b64_tr_b16 a[172:173], v1 offset:56320
    ds_read_b64_tr_b16 a[174:175], v1 offset:58880
    v_mfma_f32_16x16x32_bf16 v[60:63], a[176:179], a[104:107], v[60:63]
    v_mfma_f32_16x16x32_bf16 v[80:83], a[176:179], a[108:111], v[80:83]
    s_waitcnt lgkmcnt(10)
    s_add_u32 m0, s42, 65536
    s_add_u32 s7, s37, 163840
    buffer_load_dwordx4 v8, s[44:47], s7 offen lds
    ds_read_b64_tr_b16 a[176:177], v1 offset:56352
    ds_read_b64_tr_b16 a[178:179], v1 offset:58912
    v_mfma_f32_16x16x32_bf16 v[64:67], a[180:183], a[104:107], v[64:67]
    v_mfma_f32_16x16x32_bf16 v[84:87], a[180:183], a[108:111], v[84:87]
    ds_read_b64_tr_b16 a[180:181], v1 offset:56384
    ds_read_b64_tr_b16 a[182:183], v1 offset:58944
    v_mfma_f32_16x16x32_bf16 v[48:51], a[184:187], a[112:115], v[48:51]
    v_mfma_f32_16x16x32_bf16 v[68:71], a[184:187], a[116:119], v[68:71]
    s_waitcnt lgkmcnt(10)
    ds_read_b64_tr_b16 a[184:185], v1 offset:56416
    ds_read_b64_tr_b16 a[186:187], v1 offset:58976
    v_mfma_f32_16x16x32_bf16 v[52:55], a[188:191], a[112:115], v[52:55]
    v_mfma_f32_16x16x32_bf16 v[72:75], a[188:191], a[116:119], v[72:75]
    ds_read_b64_tr_b16 a[188:189], v1 offset:56448
    ds_read_b64_tr_b16 a[190:191], v1 offset:59008
    v_mfma_f32_16x16x32_bf16 v[56:59], a[160:163], a[112:115], v[56:59]
    v_mfma_f32_16x16x32_bf16 v[76:79], a[160:163], a[116:119], v[76:79]
    s_waitcnt lgkmcnt(10)
    s_mov_b32 s52, 0
    s_cmp_lg_u32 s28, 0
    s_cbranch_scc1 Lnp_23
    s_waitcnt vmcnt(2)
    v_readfirstlane_b32 s3, v19
    s_cmp_lg_u32 s3, s43
    s_cbranch_scc1 Lnp_23
    s_lshl_b32 s4, s29, 3
    s_add_u32 s4, s4, s30
    s_sub_u32 s4, s4, 8
    s_max_i32 s4, s4, 0
    s_lshl_b32 s5, s4, 7
    s_add_u32 s5, s5, 9437184
    s_mul_i32 s3, s4, 5120
    s_add_u32 s3, s3, 6291456
    v_lshlrev_b32 v17, 4, v0
    buffer_load_dwordx4 v[150:153], v17, s[16:19], s3 offen offset:0 sc1
    buffer_load_dwordx4 v[154:157], v17, s[16:19], s3 offen offset:1024 sc1
    buffer_load_dwordx4 v[158:161], v17, s[16:19], s3 offen offset:2048 sc1
    buffer_load_dwordx4 v[162:165], v17, s[16:19], s3 offen offset:3072 sc1
    s_add_u32 s3, s3, 4096
    buffer_load_dwordx4 v[166:169], v17, s[16:19], s3 offen offset:0 sc1
    s_mov_b32 s52, 1
Lnp_23:
    s_waitcnt vmcnt(11)
    s_barrier
    ds_read_b64_tr_b16 a[160:161], v2 offset:20480
    ds_read_b64_tr_b16 a[162:163], v2 offset:23040
    v_mfma_f32_16x16x32_bf16 v[60:63], a[164:167], a[112:115], v[60:63]
    v_mfma_f32_16x16x32_bf16 v[80:83], a[164:167], a[116:119], v[80:83]
    ds_read_b64_tr_b16 a[164:165], v2 offset:20512
    ds_read_b64_tr_b16 a[166:167], v2 offset:23072
    v_mfma_f32_16x16x32_bf16 v[64:67], a[168:171], a[112:115], v[64:67]
    v_mfma_f32_16x16x32_bf16 v[84:87], a[168:171], a[116:119], v[84:87]
    s_waitcnt lgkmcnt(10)
    s_add_u32 m0, s42, 0
    s_add_u32 s7, s37, 327680
    buffer_load_dwordx4 v4, s[44:47], s7 offen lds
    ds_read_b64_tr_b16 a[168:169], v2 offset:20544
    ds_read_b64_tr_b16 a[170:171], v2 offset:23104
    v_mfma_f32_16x16x32_bf16 v[48:51], a[172:175], a[120:123], v[48:51]
    v_mfma_f32_16x16x32_bf16 v[68:71], a[172:175], a[124:127], v[68:71]
    ds_read_b64_tr_b16 a[172:173], v2 offset:20576
    ds_read_b64_tr_b16 a[174:175], v2 offset:23136
    v_mfma_f32_16x16x32_bf16 v[52:55], a[176:179], a[120:123], v[52:55]
    v_mfma_f32_16x16x32_bf16 v[72:75], a[176:179], a[124:127], v[72:75]
    s_waitcnt lgkmcnt(10)
    ds_read_b64_tr_b16 a[176:177], v2 offset:20608
    ds_read_b64_tr_b16 a[178:179], v2 offset:23168
    v_mfma_f32_16x16x32_bf16 v[56:59], a[180:183], a[120:123], v[56:59]
    v_mfma_f32_16x16x32_bf16 v[76:79], a[180:183], a[124:127], v[76:79]
    s_add_u32 m0, s42, 1024
    s_add_u32 s7, s37, 327680
    buffer_load_dwordx4 v5, s[44:47], s7 offen lds
    ds_read_b64_tr_b16 a[180:181], v2 offset:25600
    ds_read_b64_tr_b16 a[182:183], v2 offset:28160
    v_mfma_f32_16x16x32_bf16 v[60:63], a[184:187], a[120:123], v[60:63]
    v_mfma_f32_16x16x32_bf16 v[80:83], a[184:187], a[124:127], v[80:83]
    s_waitcnt lgkmcnt(10)
    ds_read_b64_tr_b16 a[184:185], v2 offset:25632
    ds_read_b64_tr_b16 a[186:187], v2 offset:28192
    v_mfma_f32_16x16x32_bf16 v[64:67], a[188:191], a[120:123], v[64:67]
    v_mfma_f32_16x16x32_bf16 v[84:87], a[188:191], a[124:127], v[84:87]
    ds_read_b64_tr_b16 a[188:189], v2 offset:25664
    ds_read_b64_tr_b16 a[190:191], v2 offset:28224
    v_mfma_f32_16x16x32_bf16 v[48:51], a[160:163], a[128:131], v[48:51]
    v_mfma_f32_16x16x32_bf16 v[68:71], a[160:163], a[132:135], v[68:71]
    s_waitcnt lgkmcnt(10)
    ds_read_b64_tr_b16 a[160:161], v2 offset:25696
    ds_read_b64_tr_b16 a[162:163], v2 offset:28256
    v_mfma_f32_16x16x32_bf16 v[52:55], a[164:167], a[128:131], v[52:55]
    v_mfma_f32_16x16x32_bf16 v[72:75], a[164:167], a[132:135], v[72:75]
    s_add_u32 m0, s42, 2048
    s_add_u32 s7, s37, 327680
    buffer_load_dwordx4 v6, s[44:47], s7 offen lds
    ds_read_b64_tr_b16 a[164:165], v2 offset:25728
    ds_read_b64_tr_b16 a[166:167], v2 offset:28288
    v_mfma_f32_16x16x32_bf16 v[56:59], a[168:171], a[128:131], v[56:59]
    v_mfma_f32_16x16x32_bf16 v[76:79], a[168:171], a[132:135], v[76:79]
    s_waitcnt lgkmcnt(10)
    ds_read_b64_tr_b16 a[168:169], v2 offset:30720
    ds_read_b64_tr_b16 a[170:171], v2 offset:33280
    v_mfma_f32_16x16x32_bf16 v[60:63], a[172:175], a[128:131], v[60:63]
    v_mfma_f32_16x16x32_bf16 v[80:83], a[172:175], a[132:135], v[80:83]
    ds_read_b64_tr_b16 a[172:173], v2 offset:30752
    ds_read_b64_tr_b16 a[174:175], v2 offset:33312
    v_mfma_f32_16x16x32_bf16 v[64:67], a[176:179], a[128:131], v[64:67]
    v_mfma_f32_16x16x32_bf16 v[84:87], a[176:179], a[132:135], v[84:87]
    s_waitcnt lgkmcnt(10)
    s_add_u32 m0, s42, 3072
    s_add_u32 s7, s37, 327680
    buffer_load_dwordx4 v7, s[44:47], s7 offen lds
    ds_read_b64_tr_b16 a[176:177], v2 offset:30784
    ds_read_b64_tr_b16 a[178:179], v2 offset:33344
    v_mfma_f32_16x16x32_bf16 v[48:51], a[180:183], a[136:139], v[48:51]
    v_mfma_f32_16x16x32_bf16 v[68:71], a[180:183], a[140:143], v[68:71]
    ds_read_b64_tr_b16 a[180:181], v2 offset:30816
    ds_read_b64_tr_b16 a[182:183], v2 offset:33376
    v_mfma_f32_16x16x32_bf16 v[52:55], a[184:187], a[136:139], v[52:55]
    v_mfma_f32_16x16x32_bf16 v[72:75], a[184:187], a[140:143], v[72:75]
    s_waitcnt lgkmcnt(10)
    ds_read_b64_tr_b16 a[184:185], v2 offset:30848
    ds_read_b64_tr_b16 a[186:187], v2 offset:33408
    v_mfma_f32_16x16x32_bf16 v[56:59], a[188:191], a[136:139], v[56:59]
    v_mfma_f32_16x16x32_bf16 v[76:79], a[188:191], a[140:143], v[76:79]
    ds_read_b64_tr_b16 a[188:189], v2 offset:35840
    ds_read_b64_tr_b16 a[190:191], v2 offset:38400
    v_mfma_f32_16x16x32_bf16 v[60:63], a[160:163], a[136:139], v[60:63]
    v_mfma_f32_16x16x32_bf16 v[80:83], a[160:163], a[140:143], v[80:83]
    s_waitcnt lgkmcnt(10)
    s_add_u32 m0, s42, 4096
    s_add_u32 s7, s37, 327680
    buffer_load_dwordx4 v8, s[44:47], s7 offen lds
    ds_read_b64_tr_b16 a[160:161], v2 offset:35872
    ds_read_b64_tr_b16 a[162:163], v2 offset:38432
    v_mfma_f32_16x16x32_bf16 v[64:67], a[164:167], a[136:139], v[64:67]
    v_mfma_f32_16x16x32_bf16 v[84:87], a[164:167], a[140:143], v[84:87]
    ds_read_b64_tr_b16 a[164:165], v2 offset:35904
    ds_read_b64_tr_b16 a[166:167], v2 offset:38464
    v_mfma_f32_16x16x32_bf16 v[48:51], a[168:171], a[144:147], v[48:51]
    v_mfma_f32_16x16x32_bf16 v[68:71], a[168:171], a[148:151], v[68:71]
    s_waitcnt lgkmcnt(10)
    ds_read_b64_tr_b16 a[168:169], v2 offset:35936
    ds_read_b64_tr_b16 a[170:171], v2 offset:38496
    v_mfma_f32_16x16x32_bf16 v[52:55], a[172:175], a[144:147], v[52:55]
    v_mfma_f32_16x16x32_bf16 v[72:75], a[172:175], a[148:151], v[72:75]
    ds_read_b64_tr_b16 a[172:173], v2 offset:35968
    ds_read_b64_tr_b16 a[174:175], v2 offset:38528
    v_mfma_f32_16x16x32_bf16 v[56:59], a[176:179], a[144:147], v[56:59]
    v_mfma_f32_16x16x32_bf16 v[76:79], a[176:179], a[148:151], v[76:79]
    s_waitcnt lgkmcnt(10)
    v_mfma_f32_16x16x32_bf16 v[60:63], a[180:183], a[144:147], v[60:63]
    v_mfma_f32_16x16x32_bf16 v[80:83], a[180:183], a[148:151], v[80:83]
    v_mfma_f32_16x16x32_bf16 v[64:67], a[184:187], a[144:147], v[64:67]
    v_mfma_f32_16x16x32_bf16 v[84:87], a[184:187], a[148:151], v[84:87]
    s_waitcnt lgkmcnt(6)
    v_mfma_f32_16x16x32_bf16 v[48:51], a[188:191], a[152:155], v[48:51]
    v_mfma_f32_16x16x32_bf16 v[68:71], a[188:191], a[156:159], v[68:71]
    v_mfma_f32_16x16x32_bf16 v[52:55], a[160:163], a[152:155], v[52:55]
    v_mfma_f32_16x16x32_bf16 v[72:75], a[160:163], a[156:159], v[72:75]
    s_waitcnt lgkmcnt(2)
    v_mfma_f32_16x16x32_bf16 v[56:59], a[164:167], a[152:155], v[56:59]
    v_mfma_f32_16x16x32_bf16 v[76:79], a[164:167], a[156:159], v[76:79]
    v_mfma_f32_16x16x32_bf16 v[60:63], a[168:171], a[152:155], v[60:63]
    v_mfma_f32_16x16x32_bf16 v[80:83], a[168:171], a[156:159], v[80:83]
    s_waitcnt lgkmcnt(0)
    v_mfma_f32_16x16x32_bf16 v[64:67], a[172:175], a[152:155], v[64:67]
    v_mfma_f32_16x16x32_bf16 v[84:87], a[172:175], a[156:159], v[84:87]
    s_cmp_eq_u32 s28, 0
    s_cbranch_scc1 Lw0_24
    v_subrev_u32 v16, 2560, v220
    ds_read_b64 v[150:151], v16 offset:0
    ds_read_b64 v[152:153], v16 offset:512
    ds_read_b64 v[154:155], v16 offset:1024
    ds_read_b64 v[156:157], v16 offset:1536
    ds_read_b64 v[158:159], v16 offset:2048
    s_branch Lw1_25
Lw0_24:
    s_cmp_eq_u32 s52, 1
    s_cbranch_scc1 Lgot_28
    s_cmp_eq_u32 s29, 0
    s_cbranch_scc1 Lz_26
    s_lshl_b32 s4, s29, 3
    s_add_u32 s4, s4, s30
    s_sub_u32 s4, s4, 8
    s_max_i32 s4, s4, 0
    s_lshl_b32 s5, s4, 7
    s_add_u32 s5, s5, 9437184
    v_mov_b32 v16, 0
    s_mov_b32 s68, 0x1
    s_mov_b32 s69, 0x0
    s_mov_b64 exec, s[68:69]
    s_mov_b32 s66, 0
Lpoll_29:
    buffer_load_dword v17, v16, s[16:19], s5 offen sc1
    s_waitcnt vmcnt(0)
    v_cmp_ne_u32 vcc, s43, v17
    s_cbranch_vccz Lpd_30
    s_add_u32 s66, s66, 1
    s_cmp_lt_u32 s66, 0x40000
    s_cbranch_scc1 Lpoll_29
Lpd_30:
    s_mov_b64 exec, -1
    s_mul_i32 s3, s4, 5120
    s_add_u32 s3, s3, 6291456
    v_lshlrev_b32 v17, 4, v0
    buffer_load_dwordx4 v[150:153], v17, s[16:19], s3 offen offset:0 sc1
    buffer_load_dwordx4 v[154:157], v17, s[16:19], s3 offen offset:1024 sc1
    buffer_load_dwordx4 v[158:161], v17, s[16:19], s3 offen offset:2048 sc1
    buffer_load_dwordx4 v[162:165], v17, s[16:19], s3 offen offset:3072 sc1
    s_add_u32 s3, s3, 4096
    buffer_load_dwordx4 v[166:169], v17, s[16:19], s3 offen offset:0 sc1
    s_waitcnt vmcnt(0)
Lgot_28:
    s_waitcnt vmcnt(5)
    s_cmp_lg_u32 s29, 0
    s_cbranch_scc1 Lz2_27
Lz_26:
    v_mov_b32 v150, 0
    v_mov_b32 v151, 0
    v_mov_b32 v152, 0
    v_mov_b32 v153, 0
    v_mov_b32 v154, 0
    v_mov_b32 v155, 0
    v_mov_b32 v156, 0
    v_mov_b32 v157, 0
    v_mov_b32 v158, 0
    v_mov_b32 v159, 0
    v_mov_b32 v160, 0
    v_mov_b32 v161, 0
    v_mov_b32 v162, 0
    v_mov_b32 v163, 0
    v_mov_b32 v164, 0
    v_mov_b32 v165, 0
    v_mov_b32 v166, 0
    v_mov_b32 v167, 0
    v_mov_b32 v168, 0
    v_mov_b32 v169, 0
    v_mov_b32 v236, 0xf149f2ca
    v_mov_b32 v237, 0xf149f2ca
    v_mov_b32 v238, 0xf149f2ca
    v_mov_b32 v239, 0xf149f2ca
Lz2_27:
    v_add_u32 v16, 153600, v221
    ds_write_b64 v16, v[160:161] offset:0
    ds_write_b64 v16, v[162:163] offset:32
    ds_write_b64 v16, v[164:165] offset:64
    ds_write_b64 v16, v[166:167] offset:96
    ds_write_b64 v16, v[168:169] offset:128
    s_waitcnt lgkmcnt(0)
Lw1_25:
    s_barrier
    ds_read_b64_tr_b16 a[0:1], v234 offset:0
    ds_read_b64_tr_b16 a[2:3], v235 offset:0
    ds_read_b64_tr_b16 a[4:5], v234 offset:32
    ds_read_b64_tr_b16 a[6:7], v235 offset:32
    ds_read_b64_tr_b16 a[8:9], v234 offset:64
    ds_read_b64_tr_b16 a[10:11], v235 offset:64
    ds_read_b64_tr_b16 a[12:13], v234 offset:96
    ds_read_b64_tr_b16 a[14:15], v235 offset:96
    ds_read_b64_tr_b16 a[16:17], v234 offset:128
    ds_read_b64_tr_b16 a[18:19], v235 offset:128
    v_cvt_pk_bf16_f32 v130, v48, v49
    v_cvt_pk_bf16_f32 v140, v68, v69
    v_cvt_pk_bf16_f32 v131, v50, v51
    v_cvt_pk_bf16_f32 v141, v70, v71
    v_cvt_pk_bf16_f32 v132, v52, v53
    v_cvt_pk_bf16_f32 v142, v72, v73
    v_cvt_pk_bf16_f32 v133, v54, v55
    v_cvt_pk_bf16_f32 v143, v74, v75
    v_cvt_pk_bf16_f32 v134, v56, v57
    v_cvt_pk_bf16_f32 v144, v76, v77
    v_cvt_pk_bf16_f32 v135, v58, v59
    v_cvt_pk_bf16_f32 v145, v78, v79
    v_cvt_pk_bf16_f32 v136, v60, v61
    v_cvt_pk_bf16_f32 v146, v80, v81
    v_cvt_pk_bf16_f32 v137, v62, v63
    v_cvt_pk_bf16_f32 v147, v82, v83
    v_cvt_pk_bf16_f32 v138, v64, v65
    v_cvt_pk_bf16_f32 v148, v84, v85
    v_cvt_pk_bf16_f32 v139, v66, v67
    v_cvt_pk_bf16_f32 v149, v86, v87
    ds_read_b64_tr_b16 a[20:21], v235 offset:0
    ds_read_b64_tr_b16 a[22:23], v235 offset:2560
    ds_read_b64_tr_b16 a[24:25], v235 offset:32
    ds_read_b64_tr_b16 a[26:27], v235 offset:2592
    ds_read_b64_tr_b16 a[28:29], v235 offset:64
    ds_read_b64_tr_b16 a[30:31], v235 offset:2624
    ds_read_b64_tr_b16 a[32:33], v235 offset:96
    ds_read_b64_tr_b16 a[34:35], v235 offset:2656
    ds_read_b64_tr_b16 a[36:37], v235 offset:128
    ds_read_b64_tr_b16 a[38:39], v235 offset:2688
    v_mov_b32 v170, v130
    v_mov_b32 v186, v140
    v_mov_b32 v171, v131
    v_mov_b32 v187, v141
    v_cndmask_b32_e64 v172, 0, v132, s[60:61]
    v_cndmask_b32_e64 v188, 0, v142, s[60:61]
    v_cndmask_b32_e64 v173, 0, v133, s[60:61]
    v_cndmask_b32_e64 v189, 0, v143, s[60:61]
    v_cndmask_b32_e64 v174, 0, v132, s[54:55]
    v_cndmask_b32_e64 v190, 0, v142, s[54:55]
    v_cndmask_b32_e64 v175, 0, v133, s[54:55]
    v_cndmask_b32_e64 v191, 0, v143, s[54:55]
    v_cndmask_b32_e64 v176, 0, v134, s[62:63]
    v_cndmask_b32_e64 v192, 0, v144, s[62:63]
    v_cndmask_b32_e64 v177, 0, v135, s[62:63]
    v_cndmask_b32_e64 v193, 0, v145, s[62:63]
    v_cndmask_b32_e64 v178, 0, v134, s[56:57]
    v_cndmask_b32_e64 v194, 0, v144, s[56:57]
    v_cndmask_b32_e64 v179, 0, v135, s[56:57]
    v_cndmask_b32_e64 v195, 0, v145, s[56:57]
    v_cndmask_b32_e64 v180, 0, v136, s[64:65]
    v_cndmask_b32_e64 v196, 0, v146, s[64:65]
    v_cndmask_b32_e64 v181, 0, v137, s[64:65]
    v_cndmask_b32_e64 v197, 0, v147, s[64:65]
    v_cndmask_b32_e64 v182, 0, v136, s[58:59]
    v_cndmask_b32_e64 v198, 0, v146, s[58:59]
    v_cndmask_b32_e64 v183, 0, v137, s[58:59]
    v_cndmask_b32_e64 v199, 0, v147, s[58:59]
    v_mov_b32 v184, v138
    v_mov_b32 v200, v148
    v_mov_b32 v185, v139
    v_mov_b32 v201, v149
    v_mfma_f32_16x16x32_bf16 v[48:51], v[88:91], v[170:173], v[222:225]
    v_mfma_f32_16x16x32_bf16 v[52:55], v[90:93], v[174:177], v[222:225]
    v_mfma_f32_16x16x32_bf16 v[56:59], v[92:95], v[178:181], v[222:225]
    v_mfma_f32_16x16x32_bf16 v[60:63], v[94:97], v[182:185], v[222:225]
    v_mfma_f32_16x16x32_bf16 v[68:71], v[100:103], v[186:189], v[222:225]
    v_mfma_f32_16x16x32_bf16 v[72:75], v[102:105], v[190:193], v[222:225]
    v_mfma_f32_16x16x32_bf16 v[76:79], v[104:107], v[194:197], v[222:225]
    v_mfma_f32_16x16x32_bf16 v[80:83], v[106:109], v[198:201], v[222:225]
    v_mfma_f32_16x16x32_bf16 v[120:123], v[88:91], v[186:189], v[226:229]
    v_mfma_f32_16x16x32_bf16 v[124:127], v[90:93], v[190:193], v[226:229]
    v_mfma_f32_16x16x32_bf16 v[128:131], v[92:95], v[194:197], v[226:229]
    v_mfma_f32_16x16x32_bf16 v[132:135], v[94:97], v[198:201], v[226:229]
    s_waitcnt lgkmcnt(15)
    v_mfma_f32_16x16x32_bf16 v[202:205], v[150:153], v[170:173], v[236:239]
    v_mfma_f32_16x16x32_bf16 v[206:209], v[152:155], v[174:177], v[236:239]
    v_mfma_f32_16x16x32_bf16 v[210:213], v[154:157], v[178:181], v[236:239]
    v_mfma_f32_16x16x32_bf16 v[214:217], v[156:159], v[182:185], v[236:239]
    s_mov_b32 s3, 0x3ea52b5c
    s_add_u32 m0, s42, 20480
    s_add_u32 s7, s37, 491520
    buffer_load_dwordx4 v4, s[44:47], s7 offen lds
    v_max3_f32 v32, v68, v69, v120
    v_max3_f32 v16, v48, v49, v202
    v_max3_f32 v33, v70, v71, v122
    v_max3_f32 v17, v50, v51, v204
    v_max3_f32 v34, v72, v73, v124
    v_max3_f32 v18, v52, v53, v206
    v_max3_f32 v35, v74, v75, v126
    v_max3_f32 v19, v54, v55, v208
    v_max3_f32 v36, v76, v77, v128
    v_max3_f32 v20, v56, v57, v210
    v_max3_f32 v37, v78, v79, v130
    v_max3_f32 v21, v58, v59, v212
    v_max3_f32 v38, v80, v81, v132
    v_max3_f32 v22, v60, v61, v214
    v_max3_f32 v39, v82, v83, v134
    v_max3_f32 v23, v62, v63, v216
    s_add_u32 m0, s42, 21504
    s_add_u32 s7, s37, 491520
    buffer_load_dwordx4 v5, s[44:47], s7 offen lds
    v_max_f32 v32, v32, v121
    v_max_f32 v16, v16, v203
    v_max_f32 v33, v33, v123
    v_max_f32 v17, v17, v205
    v_max_f32 v34, v34, v125
    v_max_f32 v18, v18, v207
    v_max_f32 v35, v35, v127
    v_max_f32 v19, v19, v209
    v_max_f32 v36, v36, v129
    v_max_f32 v20, v20, v211
    v_max_f32 v37, v37, v131
    v_max_f32 v21, v21, v213
    v_max_f32 v38, v38, v133
    v_max_f32 v22, v22, v215
    v_max_f32 v39, v39, v135
    v_max_f32 v23, v23, v217
    s_add_u32 m0, s42, 22528
    s_add_u32 s7, s37, 491520
    buffer_load_dwordx4 v6, s[44:47], s7 offen lds
    v_max_f32 v40, v32, v33
    v_max_f32 v24, v16, v17
    v_max_f32 v41, v34, v35
    v_max_f32 v25, v18, v19
    v_max_f32 v42, v36, v37
    v_max_f32 v26, v20, v21
    v_max_f32 v43, v38, v39
    v_max_f32 v27, v22, v23
    v_permlane32_swap_b32 v40, v42
    v_permlane32_swap_b32 v24, v26
    v_permlane32_swap_b32 v41, v43
    v_permlane32_swap_b32 v25, v27
    v_max_f32 v40, v40, v42
    v_max_f32 v24, v24, v26
    v_max_f32 v41, v41, v43
    v_max_f32 v25, v25, v27
    s_add_u32 m0, s42, 23552
    s_add_u32 s7, s37, 491520
    buffer_load_dwordx4 v7, s[44:47], s7 offen lds
    v_permlane16_swap_b32 v40, v41
    v_permlane16_swap_b32 v24, v25
    v_max_f32 v44, v40, v41
    v_max_f32 v28, v24, v25
    v_mul_f32 v44, s3, v44
    v_mul_f32 v28, s3, v28
    v_mov_b32 v84, v44
    v_mov_b32 v64, v28
    v_mov_b32 v85, v44
    v_mov_b32 v65, v28
    s_nop 0
    v_permlane16_swap_b32 v84, v85
    v_permlane16_swap_b32 v64, v65
    v_mov_b32 v86, v84
    v_mov_b32 v66, v64
    v_mov_b32 v87, v85
    v_mov_b32 v67, v65
    s_add_u32 m0, s42, 24576
    s_add_u32 s7, s37, 491520
    buffer_load_dwordx4 v8, s[44:47], s7 offen lds
    v_permlane32_swap_b32 v84, v86
    v_permlane32_swap_b32 v64, v66
    v_permlane32_swap_b32 v85, v87
    v_permlane32_swap_b32 v65, v67
    v_fma_f32 v32, v32, s3, -v84
    v_fma_f32 v16, v16, s3, -v64
    v_fma_f32 v33, v33, s3, -v84
    v_fma_f32 v17, v17, s3, -v64
    v_fma_f32 v34, v34, s3, -v85
    v_fma_f32 v18, v18, s3, -v65
    v_fma_f32 v35, v35, s3, -v85
    v_fma_f32 v19, v19, s3, -v65
    v_fma_f32 v36, v36, s3, -v86
    v_fma_f32 v20, v20, s3, -v66
    v_fma_f32 v37, v37, s3, -v86
    v_fma_f32 v21, v21, s3, -v66
    s_add_u32 m0, s42, 40960
    s_add_u32 s7, s37, 655360
    buffer_load_dwordx4 v4, s[44:47], s7 offen lds
    v_fma_f32 v38, v38, s3, -v87
    v_fma_f32 v22, v22, s3, -v67
    v_fma_f32 v39, v39, s3, -v87
    v_fma_f32 v23, v23, s3, -v67
    v_exp_f32 v32, v32
    v_exp_f32 v16, v16
    v_exp_f32 v33, v33
    v_exp_f32 v17, v17
    v_exp_f32 v34, v34
    v_exp_f32 v18, v18
    v_exp_f32 v35, v35
    v_exp_f32 v19, v19
    v_exp_f32 v36, v36
    v_exp_f32 v20, v20
    v_exp_f32 v37, v37
    v_exp_f32 v21, v21
    s_add_u32 m0, s42, 41984
    s_add_u32 s7, s37, 655360
    buffer_load_dwordx4 v5, s[44:47], s7 offen lds
    v_exp_f32 v38, v38
    v_exp_f32 v22, v22
    v_exp_f32 v39, v39
    v_exp_f32 v23, v23
    v_add_f32 v40, v32, v33
    v_add_f32 v24, v16, v17
    v_add_f32 v41, v34, v35
    v_add_f32 v25, v18, v19
    v_add_f32 v42, v36, v37
    v_add_f32 v26, v20, v21
    v_add_f32 v43, v38, v39
    v_add_f32 v27, v22, v23
    v_permlane32_swap_b32 v40, v42
    v_permlane32_swap_b32 v24, v26
    v_permlane32_swap_b32 v41, v43
    v_permlane32_swap_b32 v25, v27
    s_add_u32 m0, s42, 43008
    s_add_u32 s7, s37, 655360
    buffer_load_dwordx4 v6, s[44:47], s7 offen lds
    v_add_f32 v40, v40, v42
    v_add_f32 v24, v24, v26
    v_add_f32 v41, v41, v43
    v_add_f32 v25, v25, v27
    s_nop 0
    v_permlane16_swap_b32 v40, v41
    v_permlane16_swap_b32 v24, v25
    v_add_f32 v44, v40, v41
    v_add_f32 v28, v24, v25
    v_rcp_f32 v44, v44
    v_rcp_f32 v28, v28
    v_mov_b32 v84, v44
    v_mov_b32 v64, v28
    v_mov_b32 v85, v44
    v_mov_b32 v65, v28
    s_nop 0
    v_permlane16_swap_b32 v84, v85
    v_permlane16_swap_b32 v64, v65
    s_add_u32 m0, s42, 44032
    s_add_u32 s7, s37, 655360
    buffer_load_dwordx4 v7, s[44:47], s7 offen lds
    v_mov_b32 v86, v84
    v_mov_b32 v66, v64
    v_mov_b32 v87, v85
    v_mov_b32 v67, v65
    v_permlane32_swap_b32 v84, v86
    v_permlane32_swap_b32 v64, v66
    v_permlane32_swap_b32 v85, v87
    v_permlane32_swap_b32 v65, v67
    v_mul_f32 v32, v32, v84
    v_mul_f32 v16, v16, v64
    v_mul_f32 v33, v33, v84
    v_mul_f32 v17, v17, v64
    v_mul_f32 v34, v34, v85
    v_mul_f32 v18, v18, v65
    v_mul_f32 v35, v35, v85
    v_mul_f32 v19, v19, v65
    s_add_u32 m0, s42, 45056
    s_add_u32 s7, s37, 655360
    buffer_load_dwordx4 v8, s[44:47], s7 offen lds
    v_mul_f32 v36, v36, v86
    v_mul_f32 v20, v20, v66
    v_mul_f32 v37, v37, v86
    v_mul_f32 v21, v21, v66
    v_mul_f32 v38, v38, v87
    v_mul_f32 v22, v22, v67
    v_mul_f32 v39, v39, v87
    v_mul_f32 v23, v23, v67
    v_cvt_pk_bf16_f32 v32, v32, v32
    v_cvt_pk_bf16_f32 v16, v16, v16
    v_cvt_pk_bf16_f32 v33, v33, v33
    v_cvt_pk_bf16_f32 v17, v17, v17
    v_cvt_pk_bf16_f32 v34, v34, v34
    v_cvt_pk_bf16_f32 v18, v18, v18
    v_cvt_pk_bf16_f32 v35, v35, v35
    v_cvt_pk_bf16_f32 v19, v19, v19
    v_cvt_pk_bf16_f32 v36, v36, v36
    v_cvt_pk_bf16_f32 v20, v20, v20
    v_cvt_pk_bf16_f32 v37, v37, v37
    v_cvt_pk_bf16_f32 v21, v21, v21
    v_cvt_pk_bf16_f32 v38, v38, v38
    v_cvt_pk_bf16_f32 v22, v22, v22
    v_cvt_pk_bf16_f32 v39, v39, v39
    v_cvt_pk_bf16_f32 v23, v23, v23
    v_and_b32 v186, v230, v32
    v_and_b32 v170, v230, v16
    v_and_b32 v188, v232, v32
    v_and_b32 v172, v232, v16
    v_and_b32 v187, v231, v33
    v_and_b32 v171, v231, v17
    v_and_b32 v189, v233, v33
    v_and_b32 v173, v233, v17
    v_and_b32 v190, v230, v34
    v_and_b32 v174, v230, v18
    v_and_b32 v192, v232, v34
    v_and_b32 v176, v232, v18
    v_and_b32 v191, v231, v35
    v_and_b32 v175, v231, v19
    v_and_b32 v193, v233, v35
    v_and_b32 v177, v233, v19
    v_and_b32 v194, v230, v36
    v_and_b32 v178, v230, v20
    v_and_b32 v196, v232, v36
    v_and_b32 v180, v232, v20
    v_and_b32 v195, v231, v37
    v_and_b32 v179, v231, v21
    v_and_b32 v197, v233, v37
    v_and_b32 v181, v233, v21
    v_and_b32 v198, v230, v38
    v_and_b32 v182, v230, v22
    v_and_b32 v200, v232, v38
    v_and_b32 v184, v232, v22
    v_and_b32 v199, v231, v39
    v_and_b32 v183, v231, v23
    v_and_b32 v201, v233, v39
    v_and_b32 v185, v233, v23
    s_waitcnt lgkmcnt(0)
    v_mfma_f32_16x16x32_bf16 v[68:71], a[20:23], v[186:189], 0
    v_mfma_f32_16x16x32_bf16 v[120:123], a[24:27], v[186:189], 0
    v_mfma_f32_16x16x32_bf16 v[72:75], a[24:27], v[190:193], 0
    v_mfma_f32_16x16x32_bf16 v[124:127], a[28:31], v[190:193], 0
    v_mfma_f32_16x16x32_bf16 v[76:79], a[28:31], v[194:197], 0
    v_mfma_f32_16x16x32_bf16 v[128:131], a[32:35], v[194:197], 0
    v_mfma_f32_16x16x32_bf16 v[80:83], a[32:35], v[198:201], 0
    v_mfma_f32_16x16x32_bf16 v[132:135], a[36:39], v[198:201], 0
    v_mfma_f32_16x16x32_bf16 v[48:51], a[0:3], v[170:173], 0
    v_mfma_f32_16x16x32_bf16 v[202:205], a[4:7], v[170:173], 0
    v_mfma_f32_16x16x32_bf16 v[52:55], a[4:7], v[174:177], 0
    v_mfma_f32_16x16x32_bf16 v[206:209], a[8:11], v[174:177], 0
    v_mfma_f32_16x16x32_bf16 v[56:59], a[8:11], v[178:181], 0
    v_mfma_f32_16x16x32_bf16 v[210:213], a[12:15], v[178:181], 0
    v_mfma_f32_16x16x32_bf16 v[60:63], a[12:15], v[182:185], 0
    v_mfma_f32_16x16x32_bf16 v[214:217], a[16:19], v[182:185], 0
    s_nop 0
    v_cvt_pk_bf16_f32 v140, v48, v49
    v_cvt_pk_bf16_f32 v150, v68, v69
    v_cvt_pk_bf16_f32 v141, v50, v51
    v_cvt_pk_bf16_f32 v151, v70, v71
    s_mov_b64 exec, s[54:55]
    v_cvt_pk_bf16_f32 v142, v52, v53
    v_cvt_pk_bf16_f32 v152, v72, v73
    v_cvt_pk_bf16_f32 v143, v54, v55
    v_cvt_pk_bf16_f32 v153, v74, v75
    s_mov_b64 exec, s[60:61]
    v_cvt_pk_bf16_f32 v142, v202, v203
    v_cvt_pk_bf16_f32 v152, v120, v121
    v_cvt_pk_bf16_f32 v143, v204, v205
    v_cvt_pk_bf16_f32 v153, v122, v123
    s_mov_b64 exec, s[56:57]
    v_cvt_pk_bf16_f32 v144, v56, v57
    v_cvt_pk_bf16_f32 v154, v76, v77
    v_cvt_pk_bf16_f32 v145, v58, v59
    v_cvt_pk_bf16_f32 v155, v78, v79
    s_mov_b64 exec, s[62:63]
    v_cvt_pk_bf16_f32 v144, v206, v207
    v_cvt_pk_bf16_f32 v154, v124, v125
    v_cvt_pk_bf16_f32 v145, v208, v209
    v_cvt_pk_bf16_f32 v155, v126, v127
    s_mov_b64 exec, s[58:59]
    v_cvt_pk_bf16_f32 v146, v60, v61
    v_cvt_pk_bf16_f32 v156, v80, v81
    v_cvt_pk_bf16_f32 v147, v62, v63
    v_cvt_pk_bf16_f32 v157, v82, v83
    s_mov_b64 exec, s[64:65]
    v_cvt_pk_bf16_f32 v146, v210, v211
    v_cvt_pk_bf16_f32 v156, v128, v129
    v_cvt_pk_bf16_f32 v147, v212, v213
    v_cvt_pk_bf16_f32 v157, v130, v131
    s_mov_b64 exec, -1
    v_cvt_pk_bf16_f32 v148, v214, v215
    v_cvt_pk_bf16_f32 v158, v132, v133
    v_cvt_pk_bf16_f32 v149, v216, v217
    v_cvt_pk_bf16_f32 v159, v134, v135
    s_lshl_b32 s3, s31, 4
    s_add_u32 s3, s3, s29
    s_lshl_b32 s3, s3, 2
    s_add_u32 s3, s3, s28
    s_mul_i32 s3, s3, 40960
    s_mul_i32 s4, s30, 2560
    s_add_u32 s3, s3, s4
    s_add_u32 s4, s3, 20480
    v_lshlrev_b32 v13, 4, v0
    v_lshlrev_b32 v14, 3, v0
    buffer_store_dwordx4 v[140:143], v13, s[16:19], s3 offen sc1
    buffer_store_dwordx4 v[144:147], v13, s[16:19], s3 offen offset:1024 sc1
    buffer_store_dwordx2 v[148:149], v14, s[16:19], s3 offen offset:2048 sc1
    buffer_store_dwordx4 v[150:153], v13, s[16:19], s4 offen sc1
    buffer_store_dwordx4 v[154:157], v13, s[16:19], s4 offen offset:1024 sc1
    buffer_store_dwordx2 v[158:159], v14, s[16:19], s4 offen offset:2048 sc1
    v_add_u32 v16, 0, v0
    v_mul_u32_u24 v17, 6554, v16
    v_lshrrev_b32 v17, 16, v17
    v_mul_u32_u24 v18, 10, v17
    v_sub_u32 v18, v16, v18
    v_mul_u32_u24 v17, 2560, v17
    v_lshl_add_u32 v220, v18, 4, v17
    v_add_u32 v16, 64, v0
    v_mul_u32_u24 v17, 6554, v16
    v_lshrrev_b32 v17, 16, v17
    v_mul_u32_u24 v18, 10, v17
    v_sub_u32 v18, v16, v18
    v_mul_u32_u24 v17, 2560, v17
    v_lshl_add_u32 v221, v18, 4, v17
    v_add_u32 v16, 128, v0
    v_mul_u32_u24 v17, 6554, v16
    v_lshrrev_b32 v17, 16, v17
    v_mul_u32_u24 v18, 10, v17
    v_sub_u32 v18, v16, v18
    v_mul_u32_u24 v17, 2560, v17
    v_lshl_add_u32 v222, v18, 4, v17
    v_add_u32 v16, 192, v0
    v_mul_u32_u24 v17, 6554, v16
    v_lshrrev_b32 v17, 16, v17
    v_mul_u32_u24 v18, 10, v17
    v_sub_u32 v18, v16, v18
    v_mul_u32_u24 v17, 2560, v17
    v_lshl_add_u32 v223, v18, 4, v17
    v_add_u32 v16, 256, v0
    v_mul_u32_u24 v17, 6554, v16
    v_lshrrev_b32 v17, 16, v17
    v_mul_u32_u24 v18, 10, v17
    v_sub_u32 v18, v16, v18
    v_mul_u32_u24 v17, 2560, v17
    v_lshl_add_u32 v224, v18, 4, v17
    v_lshlrev_b32 v226, 4, v0
    v_lshlrev_b32 v227, 3, v0
    v_add_u32 v228, 2560, v226
    v_add_u32 v229, 2560, v227
    v_and_b32 v16, 15, v0
    v_mul_u32_u24 v16, 160, v16
    v_lshrrev_b32 v17, 4, v0
    v_lshl_add_u32 v16, v17, 3, v16
    s_add_u32 s3, s42, 81920
    v_add_u32 v230, s3, v16
    v_add_u32 v231, s3, v226
    s_lshl_b32 s5, s31, 4
    s_add_u32 s5, s5, s29
    s_lshl_b32 s5, s5, 10
    s_add_u32 s5, s5, 9568256
    s_lshl_b32 s4, s30, 2
    s_add_u32 s4, s4, s5
    s_lshl_b32 s3, s31, 4
    s_add_u32 s3, s3, s29
    s_lshl_b32 s3, s3, 2
    s_add_u32 s3, s3, s28
    s_mul_i32 s3, s3, 40960
    s_mov_b32 s32, s3
    s_add_u32 s33, s3, 20480
    s_waitcnt vmcnt(0)
    s_barrier
    s_cmp_lg_u32 s28, 0
    s_cbranch_scc1 Lfl_31
    v_mov_b32 v13, 0
    v_mov_b32 v14, s43
    s_mov_b64 exec, 1
    buffer_store_dword v14, v13, s[16:19], s4 offen sc1
    s_mov_b64 exec, -1
Lfl_31:
    ds_read_b64_tr_b16 a[160:161], v3 offset:0
    ds_read_b64_tr_b16 a[162:163], v3 offset:2560
    ds_read_b64_tr_b16 a[164:165], v3 offset:32
    ds_read_b64_tr_b16 a[166:167], v3 offset:2592
    ds_read_b64_tr_b16 a[168:169], v3 offset:64
    ds_read_b64_tr_b16 a[170:171], v3 offset:2624
    ds_read_b64_tr_b16 a[172:173], v3 offset:96
    ds_read_b64_tr_b16 a[174:175], v3 offset:2656
    ds_read_b64_tr_b16 a[176:177], v3 offset:128
    ds_read_b64_tr_b16 a[178:179], v3 offset:2688
    ds_read_b64_tr_b16 a[180:181], v3 offset:5120
    ds_read_b64_tr_b16 a[182:183], v3 offset:7680
    ds_read_b64_tr_b16 a[184:185], v3 offset:5152
    ds_read_b64_tr_b16 a[186:187], v3 offset:7712
    v_lshlrev_b32 v16, 2, v0
    s_mov_b32 s68, 0xff
    s_mov_b32 s69, 0x0
    s_mov_b64 exec, s[68:69]
    s_mov_b32 s66, 0
Lpoll_32:
    buffer_load_dword v17, v16, s[16:19], s5 offen sc1
    s_waitcnt vmcnt(0)
    v_cmp_ne_u32 vcc, s43, v17
    s_cbranch_vccz Lpd_33
    s_add_u32 s66, s66, 1
    s_cmp_lt_u32 s66, 0x40000
    s_cbranch_scc1 Lpoll_32
Lpd_33:
    s_mov_b64 exec, -1
    buffer_load_dwordx4 a[0:3], v226, s[16:19], s32 offen offset:0 sc1
    buffer_load_dwordx4 a[20:23], v226, s[16:19], s33 offen offset:0 sc1
    buffer_load_dwordx4 a[4:7], v226, s[16:19], s32 offen offset:1024 sc1
    buffer_load_dwordx4 a[24:27], v226, s[16:19], s33 offen offset:1024 sc1
    buffer_load_dwordx4 a[8:11], v228, s[16:19], s32 offen offset:0 sc1
    buffer_load_dwordx4 a[28:31], v228, s[16:19], s33 offen offset:0 sc1
    buffer_load_dwordx4 a[12:15], v228, s[16:19], s32 offen offset:1024 sc1
    buffer_load_dwordx4 a[32:35], v228, s[16:19], s33 offen offset:1024 sc1
    buffer_load_dwordx2 a[16:17], v227, s[16:19], s32 offen offset:2048 sc1
    buffer_load_dwordx2 a[18:19], v229, s[16:19], s32 offen offset:2048 sc1
    s_add_u32 s32, s32, 5120
    buffer_load_dwordx2 a[36:37], v227, s[16:19], s33 offen offset:2048 sc1
    buffer_load_dwordx2 a[38:39], v229, s[16:19], s33 offen offset:2048 sc1
    s_add_u32 s33, s33, 5120
    s_waitcnt vmcnt(10)
    ds_read_b64_tr_b16 a[188:189], v3 offset:5184
    ds_read_b64_tr_b16 a[190:191], v3 offset:7744
    s_waitcnt lgkmcnt(14)
    v_mfma_f32_16x16x32_bf16 v[48:51], a[160:163], a[0:3], 0
    v_mfma_f32_16x16x32_bf16 v[68:71], a[160:163], a[20:23], 0
    s_waitcnt lgkmcnt(10)
    buffer_load_dwordx4 a[40:43], v226, s[16:19], s32 offen offset:0 sc1
    ds_read_b64_tr_b16 a[160:161], v3 offset:5216
    ds_read_b64_tr_b16 a[162:163], v3 offset:7776
    v_mfma_f32_16x16x32_bf16 v[52:55], a[164:167], a[0:3], 0
    v_mfma_f32_16x16x32_bf16 v[72:75], a[164:167], a[20:23], 0
    ds_read_b64_tr_b16 a[164:165], v3 offset:5248
    ds_read_b64_tr_b16 a[166:167], v3 offset:7808
    v_mfma_f32_16x16x32_bf16 v[56:59], a[168:171], a[0:3], 0
    v_mfma_f32_16x16x32_bf16 v[76:79], a[168:171], a[20:23], 0
    s_waitcnt lgkmcnt(10)
    buffer_load_dwordx4 a[60:63], v226, s[16:19], s33 offen offset:0 sc1
    ds_read_b64_tr_b16 a[168:169], v3 offset:12800
    ds_read_b64_tr_b16 a[170:171], v3 offset:15360
    v_mfma_f32_16x16x32_bf16 v[60:63], a[172:175], a[0:3], 0
    v_mfma_f32_16x16x32_bf16 v[80:83], a[172:175], a[20:23], 0
    ds_read_b64_tr_b16 a[172:173], v3 offset:12832
    ds_read_b64_tr_b16 a[174:175], v3 offset:15392
    v_mfma_f32_16x16x32_bf16 v[64:67], a[176:179], a[0:3], 0
    v_mfma_f32_16x16x32_bf16 v[84:87], a[176:179], a[20:23], 0
    s_waitcnt lgkmcnt(10)
    buffer_load_dwordx4 a[44:47], v226, s[16:19], s32 offen offset:1024 sc1
    s_waitcnt vmcnt(11)
    ds_read_b64_tr_b16 a[176:177], v3 offset:12864
    ds_read_b64_tr_b16 a[178:179], v3 offset:15424
    v_mfma_f32_16x16x32_bf16 v[48:51], a[180:183], a[4:7], v[48:51]
    v_mfma_f32_16x16x32_bf16 v[68:71], a[180:183], a[24:27], v[68:71]
    ds_read_b64_tr_b16 a[180:181], v3 offset:12896
    ds_read_b64_tr_b16 a[182:183], v3 offset:15456
    v_mfma_f32_16x16x32_bf16 v[52:55], a[184:187], a[4:7], v[52:55]
    v_mfma_f32_16x16x32_bf16 v[72:75], a[184:187], a[24:27], v[72:75]
    s_waitcnt lgkmcnt(10)
    buffer_load_dwordx4 a[64:67], v226, s[16:19], s33 offen offset:1024 sc1
    ds_read_b64_tr_b16 a[184:185], v3 offset:12928
    ds_read_b64_tr_b16 a[186:187], v3 offset:15488
    v_mfma_f32_16x16x32_bf16 v[56:59], a[188:191], a[4:7], v[56:59]
    v_mfma_f32_16x16x32_bf16 v[76:79], a[188:191], a[24:27], v[76:79]
    ds_read_b64_tr_b16 a[188:189], v3 offset:17920
    ds_read_b64_tr_b16 a[190:191], v2 offset:0
    v_mfma_f32_16x16x32_bf16 v[60:63], a[160:163], a[4:7], v[60:63]
    v_mfma_f32_16x16x32_bf16 v[80:83], a[160:163], a[24:27], v[80:83]
    s_waitcnt lgkmcnt(10)
    buffer_load_dwordx4 a[48:51], v228, s[16:19], s32 offen offset:0 sc1
    ds_read_b64_tr_b16 a[160:161], v3 offset:17952
    ds_read_b64_tr_b16 a[162:163], v2 offset:32
    v_mfma_f32_16x16x32_bf16 v[64:67], a[164:167], a[4:7], v[64:67]
    v_mfma_f32_16x16x32_bf16 v[84:87], a[164:167], a[24:27], v[84:87]
    s_waitcnt vmcnt(11)
    ds_read_b64_tr_b16 a[164:165], v3 offset:17984
    ds_read_b64_tr_b16 a[166:167], v2 offset:64
    v_mfma_f32_16x16x32_bf16 v[48:51], a[168:171], a[8:11], v[48:51]
    v_mfma_f32_16x16x32_bf16 v[68:71], a[168:171], a[28:31], v[68:71]
    s_waitcnt lgkmcnt(10)
    buffer_load_dwordx4 a[68:71], v228, s[16:19], s33 offen offset:0 sc1
    ds_read_b64_tr_b16 a[168:169], v3 offset:18016
    ds_read_b64_tr_b16 a[170:171], v2 offset:96
    v_mfma_f32_16x16x32_bf16 v[52:55], a[172:175], a[8:11], v[52:55]
    v_mfma_f32_16x16x32_bf16 v[72:75], a[172:175], a[28:31], v[72:75]
    ds_read_b64_tr_b16 a[172:173], v3 offset:18048
    ds_read_b64_tr_b16 a[174:175], v2 offset:128
    v_mfma_f32_16x16x32_bf16 v[56:59], a[176:179], a[8:11], v[56:59]
    v_mfma_f32_16x16x32_bf16 v[76:79], a[176:179], a[28:31], v[76:79]
    s_waitcnt lgkmcnt(10)
    buffer_load_dwordx4 a[52:55], v228, s[16:19], s32 offen offset:1024 sc1
    ds_read_b64_tr_b16 a[176:177], v3 offset:10240
    ds_read_b64_tr_b16 a[178:179], v2 offset:2560
    v_mfma_f32_16x16x32_bf16 v[60:63], a[180:183], a[8:11], v[60:63]
    v_mfma_f32_16x16x32_bf16 v[80:83], a[180:183], a[28:31], v[80:83]
    ds_read_b64_tr_b16 a[180:181], v3 offset:10272
    ds_read_b64_tr_b16 a[182:183], v2 offset:2592
    v_mfma_f32_16x16x32_bf16 v[64:67], a[184:187], a[8:11], v[64:67]
    v_mfma_f32_16x16x32_bf16 v[84:87], a[184:187], a[28:31], v[84:87]
    s_waitcnt lgkmcnt(10)
    buffer_load_dwordx4 a[72:75], v228, s[16:19], s33 offen offset:1024 sc1
    s_waitcnt vmcnt(12)
    ds_read_b64_tr_b16 a[184:185], v3 offset:10304
    ds_read_b64_tr_b16 a[186:187], v2 offset:2624
    v_mfma_f32_16x16x32_bf16 v[48:51], a[188:191], a[12:15], v[48:51]
    v_mfma_f32_16x16x32_bf16 v[68:71], a[188:191], a[32:35], v[68:71]
    ds_read_b64_tr_b16 a[188:189], v3 offset:10336
    ds_read_b64_tr_b16 a[190:191], v2 offset:2656
    v_mfma_f32_16x16x32_bf16 v[52:55], a[160:163], a[12:15], v[52:55]
    v_mfma_f32_16x16x32_bf16 v[72:75], a[160:163], a[32:35], v[72:75]
    s_waitcnt lgkmcnt(10)
    buffer_load_dwordx2 a[56:57], v227, s[16:19], s32 offen offset:2048 sc1
    buffer_load_dwordx2 a[58:59], v229, s[16:19], s32 offen offset:2048 sc1
    s_add_u32 s32, s32, 5120
    ds_read_b64_tr_b16 a[160:161], v3 offset:10368
    ds_read_b64_tr_b16 a[162:163], v2 offset:2688
    v_mfma_f32_16x16x32_bf16 v[56:59], a[164:167], a[12:15], v[56:59]
    v_mfma_f32_16x16x32_bf16 v[76:79], a[164:167], a[32:35], v[76:79]
    ds_read_b64_tr_b16 a[164:165], v2 offset:5120
    ds_read_b64_tr_b16 a[166:167], v2 offset:7680
    v_mfma_f32_16x16x32_bf16 v[60:63], a[168:171], a[12:15], v[60:63]
    v_mfma_f32_16x16x32_bf16 v[80:83], a[168:171], a[32:35], v[80:83]
    s_waitcnt lgkmcnt(10)
    buffer_load_dwordx2 a[76:77], v227, s[16:19], s33 offen offset:2048 sc1
    buffer_load_dwordx2 a[78:79], v229, s[16:19], s33 offen offset:2048 sc1
    s_add_u32 s33, s33, 5120
    ds_read_b64_tr_b16 a[168:169], v2 offset:5152
    ds_read_b64_tr_b16 a[170:171], v2 offset:7712
    v_mfma_f32_16x16x32_bf16 v[64:67], a[172:175], a[12:15], v[64:67]
    v_mfma_f32_16x16x32_bf16 v[84:87], a[172:175], a[32:35], v[84:87]
    s_waitcnt vmcnt(12)
    ds_read_b64_tr_b16 a[172:173], v2 offset:5184
    ds_read_b64_tr_b16 a[174:175], v2 offset:7744
    v_mfma_f32_16x16x32_bf16 v[48:51], a[176:179], a[16:19], v[48:51]
    v_mfma_f32_16x16x32_bf16 v[68:71], a[176:179], a[36:39], v[68:71]
    s_waitcnt lgkmcnt(10)
    buffer_load_dwordx4 a[80:83], v226, s[16:19], s32 offen offset:0 sc1
    ds_read_b64_tr_b16 a[176:177], v2 offset:5216
    ds_read_b64_tr_b16 a[178:179], v2 offset:7776
    v_mfma_f32_16x16x32_bf16 v[52:55], a[180:183], a[16:19], v[52:55]
    v_mfma_f32_16x16x32_bf16 v[72:75], a[180:183], a[36:39], v[72:75]
    ds_read_b64_tr_b16 a[180:181], v2 offset:5248
    ds_read_b64_tr_b16 a[182:183], v2 offset:7808
    v_mfma_f32_16x16x32_bf16 v[56:59], a[184:187], a[16:19], v[56:59]
    v_mfma_f32_16x16x32_bf16 v[76:79], a[184:187], a[36:39], v[76:79]
    s_waitcnt lgkmcnt(10)
    buffer_load_dwordx4 a[100:103], v226, s[16:19], s33 offen offset:0 sc1
    ds_read_b64_tr_b16 a[184:185], v2 offset:10240
    ds_read_b64_tr_b16 a[186:187], v2 offset:12800
    v_mfma_f32_16x16x32_bf16 v[60:63], a[188:191], a[16:19], v[60:63]
    v_mfma_f32_16x16x32_bf16 v[80:83], a[188:191], a[36:39], v[80:83]
    ds_read_b64_tr_b16 a[188:189], v2 offset:10272
    ds_read_b64_tr_b16 a[190:191], v2 offset:12832
    v_mfma_f32_16x16x32_bf16 v[64:67], a[160:163], a[16:19], v[64:67]
    v_mfma_f32_16x16x32_bf16 v[84:87], a[160:163], a[36:39], v[84:87]
    s_waitcnt lgkmcnt(10)
    buffer_load_dwordx4 a[84:87], v226, s[16:19], s32 offen offset:1024 sc1
    s_waitcnt vmcnt(13)
    ds_read_b64_tr_b16 a[160:161], v2 offset:10304
    ds_read_b64_tr_b16 a[162:163], v2 offset:12864
    v_mfma_f32_16x16x32_bf16 v[48:51], a[164:167], a[40:43], v[48:51]
    v_mfma_f32_16x16x32_bf16 v[68:71], a[164:167], a[60:63], v[68:71]
    ds_read_b64_tr_b16 a[164:165], v2 offset:10336
    ds_read_b64_tr_b16 a[166:167], v2 offset:12896
    v_mfma_f32_16x16x32_bf16 v[52:55], a[168:171], a[40:43], v[52:55]
    v_mfma_f32_16x16x32_bf16 v[72:75], a[168:171], a[60:63], v[72:75]
    s_waitcnt lgkmcnt(10)
    buffer_load_dwordx4 a[104:107], v226, s[16:19], s33 offen offset:1024 sc1
    ds_read_b64_tr_b16 a[168:169], v2 offset:10368
    ds_read_b64_tr_b16 a[170:171], v2 offset:12928
    v_mfma_f32_16x16x32_bf16 v[56:59], a[172:175], a[40:43], v[56:59]
    v_mfma_f32_16x16x32_bf16 v[76:79], a[172:175], a[60:63], v[76:79]
    ds_read_b64_tr_b16 a[172:173], v2 offset:17920
    ds_read_b64_tr_b16 a[174:175], v1 offset:0
    v_mfma_f32_16x16x32_bf16 v[60:63], a[176:179], a[40:43], v[60:63]
    v_mfma_f32_16x16x32_bf16 v[80:83], a[176:179], a[60:63], v[80:83]
    s_waitcnt lgkmcnt(10)
    buffer_load_dwordx4 a[88:91], v228, s[16:19], s32 offen offset:0 sc1
    ds_read_b64_tr_b16 a[176:177], v2 offset:17952
    ds_read_b64_tr_b16 a[178:179], v1 offset:32
    v_mfma_f32_16x16x32_bf16 v[64:67], a[180:183], a[40:43], v[64:67]
    v_mfma_f32_16x16x32_bf16 v[84:87], a[180:183], a[60:63], v[84:87]
    s_waitcnt vmcnt(13)
    ds_read_b64_tr_b16 a[180:181], v2 offset:17984
    ds_read_b64_tr_b16 a[182:183], v1 offset:64
    v_mfma_f32_16x16x32_bf16 v[48:51], a[184:187], a[44:47], v[48:51]
    v_mfma_f32_16x16x32_bf16 v[68:71], a[184:187], a[64:67], v[68:71]
    s_waitcnt lgkmcnt(10)
    buffer_load_dwordx4 a[108:111], v228, s[16:19], s33 offen offset:0 sc1
    ds_read_b64_tr_b16 a[184:185], v2 offset:18016
    ds_read_b64_tr_b16 a[186:187], v1 offset:96
    v_mfma_f32_16x16x32_bf16 v[52:55], a[188:191], a[44:47], v[52:55]
    v_mfma_f32_16x16x32_bf16 v[72:75], a[188:191], a[64:67], v[72:75]
    ds_read_b64_tr_b16 a[188:189], v2 offset:18048
    ds_read_b64_tr_b16 a[190:191], v1 offset:128
    v_mfma_f32_16x16x32_bf16 v[56:59], a[160:163], a[44:47], v[56:59]
    v_mfma_f32_16x16x32_bf16 v[76:79], a[160:163], a[64:67], v[76:79]
    s_waitcnt lgkmcnt(10)
    buffer_load_dwordx4 a[92:95], v228, s[16:19], s32 offen offset:1024 sc1
    ds_read_b64_tr_b16 a[160:161], v1 offset:2560
    ds_read_b64_tr_b16 a[162:163], v1 offset:5120
    v_mfma_f32_16x16x32_bf16 v[60:63], a[164:167], a[44:47], v[60:63]
    v_mfma_f32_16x16x32_bf16 v[80:83], a[164:167], a[64:67], v[80:83]
    ds_read_b64_tr_b16 a[164:165], v1 offset:2592
    ds_read_b64_tr_b16 a[166:167], v1 offset:5152
    v_mfma_f32_16x16x32_bf16 v[64:67], a[168:171], a[44:47], v[64:67]
    v_mfma_f32_16x16x32_bf16 v[84:87], a[168:171], a[64:67], v[84:87]
    s_waitcnt lgkmcnt(10)
    buffer_load_dwordx4 a[112:115], v228, s[16:19], s33 offen offset:1024 sc1
    s_waitcnt vmcnt(14)
    ds_read_b64_tr_b16 a[168:169], v1 offset:2624
    ds_read_b64_tr_b16 a[170:171], v1 offset:5184
    v_mfma_f32_16x16x32_bf16 v[48:51], a[172:175], a[48:51], v[48:51]
    v_mfma_f32_16x16x32_bf16 v[68:71], a[172:175], a[68:71], v[68:71]
    ds_read_b64_tr_b16 a[172:173], v1 offset:2656
    ds_read_b64_tr_b16 a[174:175], v1 offset:5216
    v_mfma_f32_16x16x32_bf16 v[52:55], a[176:179], a[48:51], v[52:55]
    v_mfma_f32_16x16x32_bf16 v[72:75], a[176:179], a[68:71], v[72:75]
    s_waitcnt lgkmcnt(10)
    buffer_load_dwordx2 a[96:97], v227, s[16:19], s32 offen offset:2048 sc1
    buffer_load_dwordx2 a[98:99], v229, s[16:19], s32 offen offset:2048 sc1
    s_add_u32 s32, s32, 5120
    ds_read_b64_tr_b16 a[176:177], v1 offset:2688
    ds_read_b64_tr_b16 a[178:179], v1 offset:5248
    v_mfma_f32_16x16x32_bf16 v[56:59], a[180:183], a[48:51], v[56:59]
    v_mfma_f32_16x16x32_bf16 v[76:79], a[180:183], a[68:71], v[76:79]
    ds_read_b64_tr_b16 a[180:181], v2 offset:15360
    ds_read_b64_tr_b16 a[182:183], v1 offset:7680
    v_mfma_f32_16x16x32_bf16 v[60:63], a[184:187], a[48:51], v[60:63]
    v_mfma_f32_16x16x32_bf16 v[80:83], a[184:187], a[68:71], v[80:83]
    s_waitcnt lgkmcnt(10)
    buffer_load_dwordx2 a[116:117], v227, s[16:19], s33 offen offset:2048 sc1
    buffer_load_dwordx2 a[118:119], v229, s[16:19], s33 offen offset:2048 sc1
    s_add_u32 s33, s33, 5120
    ds_read_b64_tr_b16 a[184:185], v2 offset:15392
    ds_read_b64_tr_b16 a[186:187], v1 offset:7712
    v_mfma_f32_16x16x32_bf16 v[64:67], a[188:191], a[48:51], v[64:67]
    v_mfma_f32_16x16x32_bf16 v[84:87], a[188:191], a[68:71], v[84:87]
    s_waitcnt vmcnt(16)
    ds_read_b64_tr_b16 a[188:189], v2 offset:15424
    ds_read_b64_tr_b16 a[190:191], v1 offset:7744
    v_mfma_f32_16x16x32_bf16 v[48:51], a[160:163], a[52:55], v[48:51]
    v_mfma_f32_16x16x32_bf16 v[68:71], a[160:163], a[72:75], v[68:71]
    s_waitcnt lgkmcnt(10)
    buffer_load_dwordx4 a[120:123], v226, s[16:19], s32 offen offset:0 sc1
    ds_read_b64_tr_b16 a[160:161], v2 offset:15456
    ds_read_b64_tr_b16 a[162:163], v1 offset:7776
    v_mfma_f32_16x16x32_bf16 v[52:55], a[164:167], a[52:55], v[52:55]
    v_mfma_f32_16x16x32_bf16 v[72:75], a[164:167], a[72:75], v[72:75]
    ds_read_b64_tr_b16 a[164:165], v2 offset:15488
    ds_read_b64_tr_b16 a[166:167], v1 offset:7808
    v_mfma_f32_16x16x32_bf16 v[56:59], a[168:171], a[52:55], v[56:59]
    v_mfma_f32_16x16x32_bf16 v[76:79], a[168:171], a[72:75], v[76:79]
    s_waitcnt lgkmcnt(10)
    buffer_load_dwordx4 a[140:143], v226, s[16:19], s33 offen offset:0 sc1
    ds_read_b64_tr_b16 a[168:169], v1 offset:10240
    ds_read_b64_tr_b16 a[170:171], v1 offset:12800
    v_mfma_f32_16x16x32_bf16 v[60:63], a[172:175], a[52:55], v[60:63]
    v_mfma_f32_16x16x32_bf16 v[80:83], a[172:175], a[72:75], v[80:83]
    ds_read_b64_tr_b16 a[172:173], v1 offset:10272
    ds_read_b64_tr_b16 a[174:175], v1 offset:12832
    v_mfma_f32_16x16x32_bf16 v[64:67], a[176:179], a[52:55], v[64:67]
    v_mfma_f32_16x16x32_bf16 v[84:87], a[176:179], a[72:75], v[84:87]
    s_waitcnt lgkmcnt(10)
    buffer_load_dwordx4 a[124:127], v226, s[16:19], s32 offen offset:1024 sc1
    s_waitcnt vmcnt(15)
    ds_read_b64_tr_b16 a[176:177], v1 offset:10304
    ds_read_b64_tr_b16 a[178:179], v1 offset:12864
    v_mfma_f32_16x16x32_bf16 v[48:51], a[180:183], a[56:59], v[48:51]
    v_mfma_f32_16x16x32_bf16 v[68:71], a[180:183], a[76:79], v[68:71]
    ds_read_b64_tr_b16 a[180:181], v1 offset:10336
    ds_read_b64_tr_b16 a[182:183], v1 offset:12896
    v_mfma_f32_16x16x32_bf16 v[52:55], a[184:187], a[56:59], v[52:55]
    v_mfma_f32_16x16x32_bf16 v[72:75], a[184:187], a[76:79], v[72:75]
    s_waitcnt lgkmcnt(10)
    buffer_load_dwordx4 a[144:147], v226, s[16:19], s33 offen offset:1024 sc1
    ds_read_b64_tr_b16 a[184:185], v1 offset:10368
    ds_read_b64_tr_b16 a[186:187], v1 offset:12928
    v_mfma_f32_16x16x32_bf16 v[56:59], a[188:191], a[56:59], v[56:59]
    v_mfma_f32_16x16x32_bf16 v[76:79], a[188:191], a[76:79], v[76:79]
    ds_read_b64_tr_b16 a[188:189], v1 offset:15360
    ds_read_b64_tr_b16 a[190:191], v1 offset:17920
    v_mfma_f32_16x16x32_bf16 v[60:63], a[160:163], a[56:59], v[60:63]
    v_mfma_f32_16x16x32_bf16 v[80:83], a[160:163], a[76:79], v[80:83]
    s_waitcnt lgkmcnt(10)
    buffer_load_dwordx4 a[128:131], v228, s[16:19], s32 offen offset:0 sc1
    ds_read_b64_tr_b16 a[160:161], v1 offset:15392
    ds_read_b64_tr_b16 a[162:163], v1 offset:17952
    v_mfma_f32_16x16x32_bf16 v[64:67], a[164:167], a[56:59], v[64:67]
    v_mfma_f32_16x16x32_bf16 v[84:87], a[164:167], a[76:79], v[84:87]
    s_waitcnt vmcnt(15)
    ds_read_b64_tr_b16 a[164:165], v1 offset:15424
    ds_read_b64_tr_b16 a[166:167], v1 offset:17984
    v_mfma_f32_16x16x32_bf16 v[48:51], a[168:171], a[80:83], v[48:51]
    v_mfma_f32_16x16x32_bf16 v[68:71], a[168:171], a[100:103], v[68:71]
    s_waitcnt lgkmcnt(10)
    buffer_load_dwordx4 a[148:151], v228, s[16:19], s33 offen offset:0 sc1
    ds_read_b64_tr_b16 a[168:169], v1 offset:15456
    ds_read_b64_tr_b16 a[170:171], v1 offset:18016
    v_mfma_f32_16x16x32_bf16 v[52:55], a[172:175], a[80:83], v[52:55]
    v_mfma_f32_16x16x32_bf16 v[72:75], a[172:175], a[100:103], v[72:75]
    ds_read_b64_tr_b16 a[172:173], v1 offset:15488
    ds_read_b64_tr_b16 a[174:175], v1 offset:18048
    v_mfma_f32_16x16x32_bf16 v[56:59], a[176:179], a[80:83], v[56:59]
    v_mfma_f32_16x16x32_bf16 v[76:79], a[176:179], a[100:103], v[76:79]
    s_waitcnt lgkmcnt(10)
    buffer_load_dwordx4 a[132:135], v228, s[16:19], s32 offen offset:1024 sc1
    ds_read_b64_tr_b16 a[176:177], v1 offset:23040
    ds_read_b64_tr_b16 a[178:179], v1 offset:25600
    v_mfma_f32_16x16x32_bf16 v[60:63], a[180:183], a[80:83], v[60:63]
    v_mfma_f32_16x16x32_bf16 v[80:83], a[180:183], a[100:103], v[80:83]
    ds_read_b64_tr_b16 a[180:181], v1 offset:23072
    ds_read_b64_tr_b16 a[182:183], v1 offset:25632
    v_mfma_f32_16x16x32_bf16 v[64:67], a[184:187], a[80:83], v[64:67]
    v_mfma_f32_16x16x32_bf16 v[84:87], a[184:187], a[100:103], v[84:87]
    s_waitcnt lgkmcnt(10)
    buffer_load_dwordx4 a[152:155], v228, s[16:19], s33 offen offset:1024 sc1
    s_waitcnt vmcnt(16)
    ds_read_b64_tr_b16 a[184:185], v1 offset:23104
    ds_read_b64_tr_b16 a[186:187], v1 offset:25664
    v_mfma_f32_16x16x32_bf16 v[48:51], a[188:191], a[84:87], v[48:51]
    v_mfma_f32_16x16x32_bf16 v[68:71], a[188:191], a[104:107], v[68:71]
    ds_read_b64_tr_b16 a[188:189], v1 offset:23136
    ds_read_b64_tr_b16 a[190:191], v1 offset:25696
    v_mfma_f32_16x16x32_bf16 v[52:55], a[160:163], a[84:87], v[52:55]
    v_mfma_f32_16x16x32_bf16 v[72:75], a[160:163], a[104:107], v[72:75]
    s_waitcnt lgkmcnt(10)
    buffer_load_dwordx2 a[136:137], v227, s[16:19], s32 offen offset:2048 sc1
    buffer_load_dwordx2 a[138:139], v229, s[16:19], s32 offen offset:2048 sc1
    ds_read_b64_tr_b16 a[160:161], v1 offset:23168
    ds_read_b64_tr_b16 a[162:163], v1 offset:25728
    v_mfma_f32_16x16x32_bf16 v[56:59], a[164:167], a[84:87], v[56:59]
    v_mfma_f32_16x16x32_bf16 v[76:79], a[164:167], a[104:107], v[76:79]
    ds_read_b64_tr_b16 a[164:165], v1 offset:28160
    ds_read_b64_tr_b16 a[166:167], v1 offset:30720
    v_mfma_f32_16x16x32_bf16 v[60:63], a[168:171], a[84:87], v[60:63]
    v_mfma_f32_16x16x32_bf16 v[80:83], a[168:171], a[104:107], v[80:83]
    s_waitcnt lgkmcnt(10)
    buffer_load_dwordx2 a[156:157], v227, s[16:19], s33 offen offset:2048 sc1
    buffer_load_dwordx2 a[158:159], v229, s[16:19], s33 offen offset:2048 sc1
    ds_read_b64_tr_b16 a[168:169], v1 offset:28192
    ds_read_b64_tr_b16 a[170:171], v1 offset:30752
    v_mfma_f32_16x16x32_bf16 v[64:67], a[172:175], a[84:87], v[64:67]
    v_mfma_f32_16x16x32_bf16 v[84:87], a[172:175], a[104:107], v[84:87]
    s_waitcnt vmcnt(18)
    ds_read_b64_tr_b16 a[172:173], v1 offset:28224
    ds_read_b64_tr_b16 a[174:175], v1 offset:30784
    v_mfma_f32_16x16x32_bf16 v[48:51], a[176:179], a[88:91], v[48:51]
    v_mfma_f32_16x16x32_bf16 v[68:71], a[176:179], a[108:111], v[68:71]
    s_waitcnt lgkmcnt(10)
    ds_read_b64_tr_b16 a[176:177], v1 offset:28256
    ds_read_b64_tr_b16 a[178:179], v1 offset:30816
    v_mfma_f32_16x16x32_bf16 v[52:55], a[180:183], a[88:91], v[52:55]
    v_mfma_f32_16x16x32_bf16 v[72:75], a[180:183], a[108:111], v[72:75]
    ds_read_b64_tr_b16 a[180:181], v1 offset:28288
    ds_read_b64_tr_b16 a[182:183], v1 offset:30848
    v_mfma_f32_16x16x32_bf16 v[56:59], a[184:187], a[88:91], v[56:59]
    v_mfma_f32_16x16x32_bf16 v[76:79], a[184:187], a[108:111], v[76:79]
    s_waitcnt lgkmcnt(10)
    ds_read_b64_tr_b16 a[184:185], v1 offset:20480
    ds_read_b64_tr_b16 a[186:187], v1 offset:33280
    v_mfma_f32_16x16x32_bf16 v[60:63], a[188:191], a[88:91], v[60:63]
    v_mfma_f32_16x16x32_bf16 v[80:83], a[188:191], a[108:111], v[80:83]
    ds_read_b64_tr_b16 a[188:189], v1 offset:20512
    ds_read_b64_tr_b16 a[190:191], v1 offset:33312
    v_mfma_f32_16x16x32_bf16 v[64:67], a[160:163], a[88:91], v[64:67]
    v_mfma_f32_16x16x32_bf16 v[84:87], a[160:163], a[108:111], v[84:87]
    s_waitcnt lgkmcnt(10)
    s_waitcnt vmcnt(16)
    ds_read_b64_tr_b16 a[160:161], v1 offset:20544
    ds_read_b64_tr_b16 a[162:163], v1 offset:33344
    v_mfma_f32_16x16x32_bf16 v[48:51], a[164:167], a[92:95], v[48:51]
    v_mfma_f32_16x16x32_bf16 v[68:71], a[164:167], a[112:115], v[68:71]
    ds_read_b64_tr_b16 a[164:165], v1 offset:20576
    ds_read_b64_tr_b16 a[166:167], v1 offset:33376
    v_mfma_f32_16x16x32_bf16 v[52:55], a[168:171], a[92:95], v[52:55]
    v_mfma_f32_16x16x32_bf16 v[72:75], a[168:171], a[112:115], v[72:75]
    s_waitcnt lgkmcnt(10)
    ds_read_b64_tr_b16 a[168:169], v1 offset:20608
    ds_read_b64_tr_b16 a[170:171], v1 offset:33408
    v_mfma_f32_16x16x32_bf16 v[56:59], a[172:175], a[92:95], v[56:59]
    v_mfma_f32_16x16x32_bf16 v[76:79], a[172:175], a[112:115], v[76:79]
    ds_read_b64_tr_b16 a[172:173], v1 offset:35840
    ds_read_b64_tr_b16 a[174:175], v1 offset:38400
    v_mfma_f32_16x16x32_bf16 v[60:63], a[176:179], a[92:95], v[60:63]
    v_mfma_f32_16x16x32_bf16 v[80:83], a[176:179], a[112:115], v[80:83]
    s_waitcnt lgkmcnt(10)
    ds_read_b64_tr_b16 a[176:177], v1 offset:35872
    ds_read_b64_tr_b16 a[178:179], v1 offset:38432
    v_mfma_f32_16x16x32_bf16 v[64:67], a[180:183], a[92:95], v[64:67]
    v_mfma_f32_16x16x32_bf16 v[84:87], a[180:183], a[112:115], v[84:87]
    s_waitcnt vmcnt(12)
    ds_read_b64_tr_b16 a[180:181], v1 offset:35904
    ds_read_b64_tr_b16 a[182:183], v1 offset:38464
    v_mfma_f32_16x16x32_bf16 v[48:51], a[184:187], a[96:99], v[48:51]
    v_mfma_f32_16x16x32_bf16 v[68:71], a[184:187], a[116:119], v[68:71]
    s_waitcnt lgkmcnt(10)
    ds_read_b64_tr_b16 a[184:185], v1 offset:35936
    ds_read_b64_tr_b16 a[186:187], v1 offset:38496
    v_mfma_f32_16x16x32_bf16 v[52:55], a[188:191], a[96:99], v[52:55]
    v_mfma_f32_16x16x32_bf16 v[72:75], a[188:191], a[116:119], v[72:75]
    ds_read_b64_tr_b16 a[188:189], v1 offset:35968
    ds_read_b64_tr_b16 a[190:191], v1 offset:38528
    v_mfma_f32_16x16x32_bf16 v[56:59], a[160:163], a[96:99], v[56:59]
    v_mfma_f32_16x16x32_bf16 v[76:79], a[160:163], a[116:119], v[76:79]
    s_waitcnt lgkmcnt(10)
    ds_read_b64_tr_b16 a[160:161], v1 offset:40960
    ds_read_b64_tr_b16 a[162:163], v1 offset:43520
    v_mfma_f32_16x16x32_bf16 v[60:63], a[164:167], a[96:99], v[60:63]
    v_mfma_f32_16x16x32_bf16 v[80:83], a[164:167], a[116:119], v[80:83]
    ds_read_b64_tr_b16 a[164:165], v1 offset:40992
    ds_read_b64_tr_b16 a[166:167], v1 offset:43552
    v_mfma_f32_16x16x32_bf16 v[64:67], a[168:171], a[96:99], v[64:67]
    v_mfma_f32_16x16x32_bf16 v[84:87], a[168:171], a[116:119], v[84:87]
    s_waitcnt lgkmcnt(10)
    s_waitcnt vmcnt(10)
    ds_read_b64_tr_b16 a[168:169], v1 offset:41024
    ds_read_b64_tr_b16 a[170:171], v1 offset:43584
    v_mfma_f32_16x16x32_bf16 v[48:51], a[172:175], a[120:123], v[48:51]
    v_mfma_f32_16x16x32_bf16 v[68:71], a[172:175], a[140:143], v[68:71]
    ds_read_b64_tr_b16 a[172:173], v1 offset:41056
    ds_read_b64_tr_b16 a[174:175], v1 offset:43616
    v_mfma_f32_16x16x32_bf16 v[52:55], a[176:179], a[120:123], v[52:55]
    v_mfma_f32_16x16x32_bf16 v[72:75], a[176:179], a[140:143], v[72:75]
    s_waitcnt lgkmcnt(10)
    ds_read_b64_tr_b16 a[176:177], v1 offset:41088
    ds_read_b64_tr_b16 a[178:179], v1 offset:43648
    v_mfma_f32_16x16x32_bf16 v[56:59], a[180:183], a[120:123], v[56:59]
    v_mfma_f32_16x16x32_bf16 v[76:79], a[180:183], a[140:143], v[76:79]
    ds_read_b64_tr_b16 a[180:181], v1 offset:48640
    ds_read_b64_tr_b16 a[182:183], v1 offset:51200
    v_mfma_f32_16x16x32_bf16 v[60:63], a[184:187], a[120:123], v[60:63]
    v_mfma_f32_16x16x32_bf16 v[80:83], a[184:187], a[140:143], v[80:83]
    s_waitcnt lgkmcnt(10)
    ds_read_b64_tr_b16 a[184:185], v1 offset:48672
    ds_read_b64_tr_b16 a[186:187], v1 offset:51232
    v_mfma_f32_16x16x32_bf16 v[64:67], a[188:191], a[120:123], v[64:67]
    v_mfma_f32_16x16x32_bf16 v[84:87], a[188:191], a[140:143], v[84:87]
    s_waitcnt vmcnt(8)
    ds_read_b64_tr_b16 a[188:189], v1 offset:48704
    ds_read_b64_tr_b16 a[190:191], v1 offset:51264
    v_mfma_f32_16x16x32_bf16 v[48:51], a[160:163], a[124:127], v[48:51]
    v_mfma_f32_16x16x32_bf16 v[68:71], a[160:163], a[144:147], v[68:71]
    s_waitcnt lgkmcnt(10)
    ds_read_b64_tr_b16 a[160:161], v1 offset:48736
    ds_read_b64_tr_b16 a[162:163], v1 offset:51296
    v_mfma_f32_16x16x32_bf16 v[52:55], a[164:167], a[124:127], v[52:55]
    v_mfma_f32_16x16x32_bf16 v[72:75], a[164:167], a[144:147], v[72:75]
    ds_read_b64_tr_b16 a[164:165], v1 offset:48768
    ds_read_b64_tr_b16 a[166:167], v1 offset:51328
    v_mfma_f32_16x16x32_bf16 v[56:59], a[168:171], a[124:127], v[56:59]
    v_mfma_f32_16x16x32_bf16 v[76:79], a[168:171], a[144:147], v[76:79]
    s_waitcnt lgkmcnt(10)
    ds_read_b64_tr_b16 a[168:169], v1 offset:53760
    ds_read_b64_tr_b16 a[170:171], v1 offset:56320
    v_mfma_f32_16x16x32_bf16 v[60:63], a[172:175], a[124:127], v[60:63]
    v_mfma_f32_16x16x32_bf16 v[80:83], a[172:175], a[144:147], v[80:83]
    ds_read_b64_tr_b16 a[172:173], v1 offset:53792
    ds_read_b64_tr_b16 a[174:175], v1 offset:56352
    v_mfma_f32_16x16x32_bf16 v[64:67], a[176:179], a[124:127], v[64:67]
    v_mfma_f32_16x16x32_bf16 v[84:87], a[176:179], a[144:147], v[84:87]
    s_waitcnt lgkmcnt(10)
    s_waitcnt vmcnt(6)
    ds_read_b64_tr_b16 a[176:177], v1 offset:53824
    ds_read_b64_tr_b16 a[178:179], v1 offset:56384
    v_mfma_f32_16x16x32_bf16 v[48:51], a[180:183], a[128:131], v[48:51]
    v_mfma_f32_16x16x32_bf16 v[68:71], a[180:183], a[148:151], v[68:71]
    ds_read_b64_tr_b16 a[180:181], v1 offset:53856
    ds_read_b64_tr_b16 a[182:183], v1 offset:56416
    v_mfma_f32_16x16x32_bf16 v[52:55], a[184:187], a[128:131], v[52:55]
    v_mfma_f32_16x16x32_bf16 v[72:75], a[184:187], a[148:151], v[72:75]
    s_waitcnt lgkmcnt(10)
    ds_read_b64_tr_b16 a[184:185], v1 offset:53888
    ds_read_b64_tr_b16 a[186:187], v1 offset:56448
    v_mfma_f32_16x16x32_bf16 v[56:59], a[188:191], a[128:131], v[56:59]
    v_mfma_f32_16x16x32_bf16 v[76:79], a[188:191], a[148:151], v[76:79]
    ds_read_b64_tr_b16 a[188:189], v1 offset:46080
    ds_read_b64_tr_b16 a[190:191], v1 offset:58880
    v_mfma_f32_16x16x32_bf16 v[60:63], a[160:163], a[128:131], v[60:63]
    v_mfma_f32_16x16x32_bf16 v[80:83], a[160:163], a[148:151], v[80:83]
    s_waitcnt lgkmcnt(10)
    ds_read_b64_tr_b16 a[160:161], v1 offset:46112
    ds_read_b64_tr_b16 a[162:163], v1 offset:58912
    v_mfma_f32_16x16x32_bf16 v[64:67], a[164:167], a[128:131], v[64:67]
    v_mfma_f32_16x16x32_bf16 v[84:87], a[164:167], a[148:151], v[84:87]
    s_waitcnt vmcnt(4)
    ds_read_b64_tr_b16 a[164:165], v1 offset:46144
    ds_read_b64_tr_b16 a[166:167], v1 offset:58944
    v_mfma_f32_16x16x32_bf16 v[48:51], a[168:171], a[132:135], v[48:51]
    v_mfma_f32_16x16x32_bf16 v[68:71], a[168:171], a[152:155], v[68:71]
    s_waitcnt lgkmcnt(10)
    ds_read_b64_tr_b16 a[168:169], v1 offset:46176
    ds_read_b64_tr_b16 a[170:171], v1 offset:58976
    v_mfma_f32_16x16x32_bf16 v[52:55], a[172:175], a[132:135], v[52:55]
    v_mfma_f32_16x16x32_bf16 v[72:75], a[172:175], a[152:155], v[72:75]
    s_waitcnt vmcnt(0)
    ds_read_b64_tr_b16 a[172:173], v1 offset:46208
    ds_read_b64_tr_b16 a[174:175], v1 offset:59008
    v_mfma_f32_16x16x32_bf16 v[56:59], a[176:179], a[132:135], v[56:59]
    v_mfma_f32_16x16x32_bf16 v[76:79], a[176:179], a[152:155], v[76:79]
    s_waitcnt lgkmcnt(10)
    v_mfma_f32_16x16x32_bf16 v[60:63], a[180:183], a[132:135], v[60:63]
    v_mfma_f32_16x16x32_bf16 v[80:83], a[180:183], a[152:155], v[80:83]
    v_mfma_f32_16x16x32_bf16 v[64:67], a[184:187], a[132:135], v[64:67]
    v_mfma_f32_16x16x32_bf16 v[84:87], a[184:187], a[152:155], v[84:87]
    s_waitcnt lgkmcnt(6)
    v_mfma_f32_16x16x32_bf16 v[48:51], a[188:191], a[136:139], v[48:51]
    v_mfma_f32_16x16x32_bf16 v[68:71], a[188:191], a[156:159], v[68:71]
    v_mfma_f32_16x16x32_bf16 v[52:55], a[160:163], a[136:139], v[52:55]
    v_mfma_f32_16x16x32_bf16 v[72:75], a[160:163], a[156:159], v[72:75]
    s_waitcnt lgkmcnt(2)
    v_mfma_f32_16x16x32_bf16 v[56:59], a[164:167], a[136:139], v[56:59]
    v_mfma_f32_16x16x32_bf16 v[76:79], a[164:167], a[156:159], v[76:79]
    v_mfma_f32_16x16x32_bf16 v[60:63], a[168:171], a[136:139], v[60:63]
    v_mfma_f32_16x16x32_bf16 v[80:83], a[168:171], a[156:159], v[80:83]
    s_waitcnt lgkmcnt(0)
    v_mfma_f32_16x16x32_bf16 v[64:67], a[172:175], a[136:139], v[64:67]
    v_mfma_f32_16x16x32_bf16 v[84:87], a[172:175], a[156:159], v[84:87]
    v_cvt_pk_bf16_f32 v88, v48, v49
    v_cvt_pk_bf16_f32 v100, v68, v69
    v_cvt_pk_bf16_f32 v89, v50, v51
    v_cvt_pk_bf16_f32 v101, v70, v71
    v_cvt_pk_bf16_f32 v90, v52, v53
    v_cvt_pk_bf16_f32 v102, v72, v73
    v_cvt_pk_bf16_f32 v91, v54, v55
    v_cvt_pk_bf16_f32 v103, v74, v75
    v_cvt_pk_bf16_f32 v92, v56, v57
    v_cvt_pk_bf16_f32 v104, v76, v77
    v_cvt_pk_bf16_f32 v93, v58, v59
    v_cvt_pk_bf16_f32 v105, v78, v79
    v_cvt_pk_bf16_f32 v94, v60, v61
    v_cvt_pk_bf16_f32 v106, v80, v81
    v_cvt_pk_bf16_f32 v95, v62, v63
    v_cvt_pk_bf16_f32 v107, v82, v83
    v_cvt_pk_bf16_f32 v96, v64, v65
    v_cvt_pk_bf16_f32 v108, v84, v85
    v_cvt_pk_bf16_f32 v97, v66, v67
    v_cvt_pk_bf16_f32 v109, v86, v87
    ds_write_b64 v230, v[88:89] offset:0
    ds_write_b64 v230, v[90:91] offset:32
    ds_write_b64 v230, v[92:93] offset:64
    ds_write_b64 v230, v[94:95] offset:96
    ds_write_b64 v230, v[96:97] offset:128
    ds_write_b64 v230, v[100:101] offset:2560
    ds_write_b64 v230, v[102:103] offset:2592
    ds_write_b64 v230, v[104:105] offset:2624
    ds_write_b64 v230, v[106:107] offset:2656
    ds_write_b64 v230, v[108:109] offset:2688
    s_lshl_b32 s3, s29, 2
    s_add_u32 s3, s3, s28
    s_mul_i32 s3, s3, 81920
    s_mul_i32 s4, s31, 1280
    s_add_u32 s3, s3, s4
    s_mul_i32 s4, s30, 160
    s_add_u32 s3, s3, s4
    s_waitcnt lgkmcnt(0)
    ds_read_b128 v[48:51], v231 offset:0
    ds_read_b128 v[52:55], v231 offset:1024
    ds_read_b128 v[56:59], v231 offset:2048
    ds_read_b128 v[60:63], v231 offset:3072
    ds_read_b128 v[64:67], v231 offset:4096
    s_waitcnt lgkmcnt(4)
    buffer_store_dwordx4 v[48:51], v220, s[96:99], s3 offen sc1
    s_waitcnt lgkmcnt(3)
    buffer_store_dwordx4 v[52:55], v221, s[96:99], s3 offen sc1
    s_waitcnt lgkmcnt(2)
    buffer_store_dwordx4 v[56:59], v222, s[96:99], s3 offen sc1
    s_waitcnt lgkmcnt(1)
    buffer_store_dwordx4 v[60:63], v223, s[96:99], s3 offen sc1
    s_waitcnt lgkmcnt(0)
    buffer_store_dwordx4 v[64:67], v224, s[96:99], s3 offen sc1
L_END:
    s_endpgm
L_CODE_END:
.section .rodata,"a"
.p2align 6
.amdhsa_kernel concat_heads__sliding_local_dilated__linear_kernel_hedgehog__prompt_kernel
  .amdhsa_next_free_vgpr 448
  .amdhsa_next_free_sgpr 102
  .amdhsa_accum_offset 256
  .amdhsa_group_segment_fixed_size 0
  .amdhsa_kernarg_size 80
  .amdhsa_user_sgpr_count 2
  .amdhsa_user_sgpr_kernarg_segment_ptr 1
  .amdhsa_system_sgpr_workgroup_id_x 1
.end_amdhsa_kernel
.text
```
